```python
import torch

def _softmax(x, axis=-1):
    return torch.softmax(x, dim=axis)
def _gelu(x):
    return torch.nn.functional.gelu(x, approximate="tanh")
def _silu(x):
    return torch.nn.functional.silu(x)
def _sigmoid(x):
    return torch.sigmoid(x)
def _layernorm(x, axis=-1, eps=1e-5):
    m = x.mean(dim=axis, keepdim=True)
    v = x.var(dim=axis, keepdim=True, unbiased=False)
    return (x - m) / torch.sqrt(v + eps)
def _scatter_add(tgt, idx, src, axis=0):
    return tgt.clone().index_add_(axis, idx, src)
def _segment_sum(src, seg, n):
    out = torch.zeros((n,) + src.shape[1:], dtype=src.dtype)
    return out.index_add_(0, seg, src)
def _pad(x, pw):
    flat = tuple(v for pair in reversed(pw) for v in pair)
    return torch.nn.functional.pad(x, flat)

kernel_name = 'sequential_preLN__linear_kernel_hedgehog__dense_activation_squared_relu__prompt'

def setup_inputs():

    _w = (lambda a: (lambda t: t.to(torch.bfloat16) if t.is_floating_point() else t)(torch.as_tensor(a)))
    def _A_setup():
        B, S, D, H = 1, 2048, 1024, 32
        Dh = D // H
        return {
            "x": _w((lambda *s: torch.randn(*s, dtype=torch.bfloat16) * 0.05)(B, S, D)),
            "wqkv": _w((lambda *s: torch.randn(*s, dtype=torch.bfloat16) * 0.2)(D, 3 * D)),
            "w_phi": _w((lambda *s: torch.randn(*s, dtype=torch.bfloat16) * 0.2)(H, Dh, Dh) * (Dh ** -0.5)),
            "wo": _w((lambda *s: torch.randn(*s, dtype=torch.bfloat16) * 0.05)(D, D)),
        }
    _A_in = _A_setup()

    def _B_setup():
        B, S, D, F = 1, 2048, 1024, 3584
        return {
            "x": _w((lambda *s: torch.randn(*s, dtype=torch.bfloat16) * 0.05)(B, S, D)),
            "w1": _w((lambda *s: torch.randn(*s, dtype=torch.bfloat16) * 0.05)(D, F)),
            "b1": _w((lambda *s: torch.randn(*s, dtype=torch.bfloat16) * 0.4)(F)),
            "w2": _w((lambda *s: torch.randn(*s, dtype=torch.bfloat16) * 0.05)(F, D)),
            "b2": _w((lambda *s: torch.randn(*s, dtype=torch.bfloat16) * 3.2)(D)),
        }
    _B_in = _B_setup()

    return {
        "A_x": _A_in["x"],
        "A_wqkv": _A_in["wqkv"],
        "A_w_phi": _A_in["w_phi"],
        "A_wo": _A_in["wo"],
        "B_x": _B_in["x"],
        "B_w1": _B_in["w1"],
        "B_b1": _B_in["b1"],
        "B_w2": _B_in["w2"],
        "B_b2": _B_in["b2"],
    }

def reference(A_x, A_wqkv, A_w_phi, A_wo, B_x, B_w1, B_b1, B_w2, B_b2):
    def _A_ref(x, wqkv, w_phi, wo):
        B, S, D = x.shape
        H = 32; Dh = D // H
        qkv = (lambda x, *d: x.permute(*d))((x @ wqkv).reshape(B, S, 3, H, Dh), 2, 0, 3, 1, 4)
        q, k, v = qkv[0], qkv[1], qkv[2]
        pq = torch.einsum("bhsd,hdf->bhsf", q, w_phi)
        pk = torch.einsum("bhsd,hdf->bhsf", k, w_phi)
        phi_q = torch.concatenate([_softmax(pq, axis=-1), _softmax(-pq, axis=-1)], axis=-1)
        phi_k = torch.concatenate([_softmax(pk, axis=-1), _softmax(-pk, axis=-1)], axis=-1)
        kv = torch.einsum("bhsf,bhsd->bhfd", phi_k, v)
        z  = torch.einsum("bhsf->bhf", phi_k)
        num = torch.einsum("bhqf,bhfd->bhqd", phi_q, kv)
        den = torch.einsum("bhqf,bhf->bhq", phi_q, z)[..., None] + 1e-6
        o = num / den
        return (lambda x, *d: x.permute(*d))(o, 0, 2, 1, 3).reshape(B, S, D) @ wo

    def _B_ref(x, w1, b1, w2, b2):
        h = torch.einsum("bsd,df->bsf", x, w1) + b1
        zero = torch.zeros_like(h)
        r = torch.where(h > zero, h, zero)
        h = r * r
        out = torch.einsum("bsf,fd->bsd", h, w2) + b2
        return out

    x = A_x
    h = x + _A_ref(_layernorm(x, axis=-1), A_wqkv, A_w_phi, A_wo)
    h2 = h + _B_ref(_layernorm(h, axis=-1), B_w1, B_b1, B_w2, B_b2)
    return h2
```

```asm
; @launch kernel=kp_kernel grid=(256,1,1) block=(512,1,1) lds=163840
.amdgcn_target "amdgcn-amd-amdhsa--gfx950"
.text
.globl kp_kernel
.p2align 8
.type kp_kernel,@function
kp_kernel:
s_cmp_ge_u32 s2, 256
s_cbranch_scc1 kp_end
s_load_dwordx2 s[8:9], s[0:1], 88
s_load_dwordx2 s[10:11], s[0:1], 0
s_load_dwordx2 s[12:13], s[0:1], 8
s_load_dwordx2 s[14:15], s[0:1], 16
s_load_dwordx2 s[16:17], s[0:1], 24
s_load_dwordx2 s[18:19], s[0:1], 40
s_load_dwordx2 s[20:21], s[0:1], 48
s_load_dwordx2 s[22:23], s[0:1], 56
s_load_dwordx2 s[24:25], s[0:1], 64
s_load_dwordx2 s[26:27], s[0:1], 72
s_load_dwordx2 s[84:85], s[0:1], 80
s_and_b32 s30, s2, 7
s_lshr_b32 s31, s2, 3
v_lshrrev_b32 v2, 6, v0
v_and_b32 v1, 63, v0
v_readfirstlane_b32 s3, v2
s_waitcnt lgkmcnt(0)
s_nop 2
s_cmp_lt_u32 s3, 4
s_cbranch_scc1 kp_compute
s_cmp_ge_u32 s3, 6
s_cbranch_scc1 kp_helper
s_sub_u32 s7, s3, 4
s_and_b32 s4, s30, 1
s_lshr_b32 s5, s30, 1
s_mul_i32 s4, s4, 8
s_mul_i32 s5, s5, 4
s_and_b32 s64, s31, 7
s_add_u32 s4, s4, s64
s_lshr_b32 s64, s31, 3
s_add_u32 s5, s5, s64
s_mov_b32 s32, s10
s_mov_b32 s33, s11
s_mov_b32 s34, 0x400000
s_mov_b32 s35, 0x20000
s_mov_b32 s36, s12
s_mov_b32 s37, s13
s_mov_b32 s38, 0x600000
s_mov_b32 s39, 0x20000
s_mov_b32 s40, s14
s_mov_b32 s41, s15
s_mov_b32 s42, 0x10000
s_mov_b32 s43, 0x20000
v_lshrrev_b32 v10, 3, v1
v_mul_u32_u24 v10, 2048, v10
v_and_b32 v11, 7, v1
v_lshrrev_b32 v12, 4, v1
v_xor_b32 v13, v11, v12
v_lshl_add_u32 v2, v13, 4, v10
v_xor_b32 v13, 4, v13
v_lshl_add_u32 v3, v13, 4, v10
s_lshl_b32 s60, s4, 7
s_lshl_b32 s64, s7, 6
s_add_u32 s60, s60, s64
s_mul_i32 s60, s60, 2048
v_lshrrev_b32 v10, 5, v1
v_lshlrev_b32 v10, 2, v10
v_bfe_u32 v11, v1, 2, 2
v_add_u32 v10, v10, v11
v_mul_u32_u24 v10, 6144, v10
v_bfe_u32 v11, v1, 4, 1
v_lshl_add_u32 v10, v11, 6, v10
v_and_b32 v11, 3, v1
v_lshl_add_u32 v4, v11, 4, v10
v_xor_b32 v11, 2, v11
v_lshl_add_u32 v5, v11, 4, v10
s_mul_i32 s61, s7, 196608
s_mul_i32 s64, s5, 128
s_add_u32 s61, s61, s64
s_mul_i32 s63, s7, 12288
s_add_u32 s63, s63, 16384
s_lshl_b32 s62, s7, 13
s_mov_b32 s68, 40960
s_mov_b32 s69, 0xfffec000
v_lshlrev_b32 v20, 4, v1
s_lshl_b32 s70, s5, 12
s_lshl_b32 s71, s7, 11
s_add_u32 s70, s70, s71
s_add_u32 m0, s71, 122880
s_nop 0
buffer_load_dwordx4 v20, s[40:43], s70 offen lds
buffer_load_dwordx4 v20, s[40:43], s70 offen offset:1024 lds
s_add_u32 s86, s4, s5
s_and_b32 s86, s86, 15
s_mul_i32 s64, s86, 128
s_add_u32 s92, s60, s64
s_mul_i32 s64, s86, 393216
s_add_u32 s93, s61, s64
s_mov_b32 s90, 0
s_mov_b32 s91, 0
s_cmp_eq_u32 s90, s86
s_cselect_b32 s64, 128, 0
s_add_u32 s60, s60, s64
s_add_u32 s90, s90, 1
s_add_u32 m0, s62, 0
s_add_u32 s64, s60, 0
buffer_load_dwordx4 v2, s[32:35], s64 offen sc1 lds
s_add_u32 m0, s62, 1024
s_add_u32 s64, s60, 16384
buffer_load_dwordx4 v3, s[32:35], s64 offen sc1 lds
s_add_u32 m0, s62, 2048
s_add_u32 s64, s60, 32768
buffer_load_dwordx4 v2, s[32:35], s64 offen sc1 lds
s_add_u32 m0, s62, 3072
s_add_u32 s64, s60, 49152
buffer_load_dwordx4 v3, s[32:35], s64 offen sc1 lds
s_add_u32 m0, s62, 4096
s_add_u32 s64, s60, 65536
buffer_load_dwordx4 v2, s[32:35], s64 offen sc1 lds
s_add_u32 m0, s62, 5120
s_add_u32 s64, s60, 81920
buffer_load_dwordx4 v3, s[32:35], s64 offen sc1 lds
s_add_u32 m0, s62, 6144
s_add_u32 s64, s60, 98304
buffer_load_dwordx4 v2, s[32:35], s64 offen sc1 lds
s_add_u32 m0, s62, 7168
s_add_u32 s64, s60, 114688
buffer_load_dwordx4 v3, s[32:35], s64 offen sc1 lds
s_add_u32 s60, s60, 128
s_cmp_eq_u32 s91, s86
s_cselect_b32 s64, 393216, 0
s_add_u32 s61, s61, s64
s_add_u32 s91, s91, 1
s_add_u32 m0, s63, 0
s_add_u32 s64, s61, 0
buffer_load_dwordx4 v4, s[36:39], s64 offen lds
s_add_u32 m0, s63, 1024
s_add_u32 s64, s61, 2048
buffer_load_dwordx4 v4, s[36:39], s64 offen lds
s_add_u32 m0, s63, 2048
s_add_u32 s64, s61, 4096
buffer_load_dwordx4 v4, s[36:39], s64 offen lds
s_add_u32 m0, s63, 3072
s_add_u32 s64, s61, 49152
buffer_load_dwordx4 v5, s[36:39], s64 offen lds
s_add_u32 m0, s63, 4096
s_add_u32 s64, s61, 51200
buffer_load_dwordx4 v5, s[36:39], s64 offen lds
s_add_u32 m0, s63, 5120
s_add_u32 s64, s61, 53248
buffer_load_dwordx4 v5, s[36:39], s64 offen lds
s_add_u32 m0, s63, 6144
s_add_u32 s64, s61, 98304
buffer_load_dwordx4 v4, s[36:39], s64 offen lds
s_add_u32 m0, s63, 7168
s_add_u32 s64, s61, 100352
buffer_load_dwordx4 v4, s[36:39], s64 offen lds
s_add_u32 m0, s63, 8192
s_add_u32 s64, s61, 102400
buffer_load_dwordx4 v4, s[36:39], s64 offen lds
s_add_u32 m0, s63, 9216
s_add_u32 s64, s61, 147456
buffer_load_dwordx4 v5, s[36:39], s64 offen lds
s_add_u32 m0, s63, 10240
s_add_u32 s64, s61, 149504
buffer_load_dwordx4 v5, s[36:39], s64 offen lds
s_add_u32 m0, s63, 11264
s_add_u32 s64, s61, 151552
buffer_load_dwordx4 v5, s[36:39], s64 offen lds
s_add_u32 s61, s61, 393216
s_cmp_eq_u32 s90, s86
s_cselect_b32 s64, 128, 0
s_add_u32 s60, s60, s64
s_add_u32 s90, s90, 1
s_add_u32 m0, s62, 40960
s_add_u32 s64, s60, 0
buffer_load_dwordx4 v2, s[32:35], s64 offen sc1 lds
s_add_u32 m0, s62, 41984
s_add_u32 s64, s60, 16384
buffer_load_dwordx4 v3, s[32:35], s64 offen sc1 lds
s_add_u32 m0, s62, 43008
s_add_u32 s64, s60, 32768
buffer_load_dwordx4 v2, s[32:35], s64 offen sc1 lds
s_add_u32 m0, s62, 44032
s_add_u32 s64, s60, 49152
buffer_load_dwordx4 v3, s[32:35], s64 offen sc1 lds
s_add_u32 m0, s62, 45056
s_add_u32 s64, s60, 65536
buffer_load_dwordx4 v2, s[32:35], s64 offen sc1 lds
s_add_u32 m0, s62, 46080
s_add_u32 s64, s60, 81920
buffer_load_dwordx4 v3, s[32:35], s64 offen sc1 lds
s_add_u32 m0, s62, 47104
s_add_u32 s64, s60, 98304
buffer_load_dwordx4 v2, s[32:35], s64 offen sc1 lds
s_add_u32 m0, s62, 48128
s_add_u32 s64, s60, 114688
buffer_load_dwordx4 v3, s[32:35], s64 offen sc1 lds
s_add_u32 s60, s60, 128
s_cmp_eq_u32 s91, s86
s_cselect_b32 s64, 393216, 0
s_add_u32 s61, s61, s64
s_add_u32 s91, s91, 1
s_add_u32 m0, s63, 40960
s_add_u32 s64, s61, 0
buffer_load_dwordx4 v4, s[36:39], s64 offen lds
s_add_u32 m0, s63, 41984
s_add_u32 s64, s61, 2048
buffer_load_dwordx4 v4, s[36:39], s64 offen lds
s_add_u32 m0, s63, 43008
s_add_u32 s64, s61, 4096
buffer_load_dwordx4 v4, s[36:39], s64 offen lds
s_add_u32 m0, s63, 44032
s_add_u32 s64, s61, 49152
buffer_load_dwordx4 v5, s[36:39], s64 offen lds
s_add_u32 m0, s63, 45056
s_add_u32 s64, s61, 51200
buffer_load_dwordx4 v5, s[36:39], s64 offen lds
s_add_u32 m0, s63, 46080
s_add_u32 s64, s61, 53248
buffer_load_dwordx4 v5, s[36:39], s64 offen lds
s_add_u32 m0, s63, 47104
s_add_u32 s64, s61, 98304
buffer_load_dwordx4 v4, s[36:39], s64 offen lds
s_add_u32 m0, s63, 48128
s_add_u32 s64, s61, 100352
buffer_load_dwordx4 v4, s[36:39], s64 offen lds
s_add_u32 m0, s63, 49152
s_add_u32 s64, s61, 102400
buffer_load_dwordx4 v4, s[36:39], s64 offen lds
s_add_u32 m0, s63, 50176
s_add_u32 s64, s61, 147456
buffer_load_dwordx4 v5, s[36:39], s64 offen lds
s_add_u32 m0, s63, 51200
s_add_u32 s64, s61, 149504
buffer_load_dwordx4 v5, s[36:39], s64 offen lds
s_add_u32 m0, s63, 52224
s_add_u32 s64, s61, 151552
buffer_load_dwordx4 v5, s[36:39], s64 offen lds
s_add_u32 s61, s61, 393216
s_waitcnt vmcnt(20)
s_barrier
s_cmp_eq_u32 s90, s86
s_cselect_b32 s64, 128, 0
s_add_u32 s60, s60, s64
s_add_u32 s90, s90, 1
s_add_u32 m0, s62, 81920
s_add_u32 s64, s60, 0
buffer_load_dwordx4 v2, s[32:35], s64 offen sc1 lds
s_add_u32 m0, s62, 82944
s_add_u32 s64, s60, 16384
buffer_load_dwordx4 v3, s[32:35], s64 offen sc1 lds
s_add_u32 m0, s62, 83968
s_add_u32 s64, s60, 32768
buffer_load_dwordx4 v2, s[32:35], s64 offen sc1 lds
s_add_u32 m0, s62, 84992
s_add_u32 s64, s60, 49152
buffer_load_dwordx4 v3, s[32:35], s64 offen sc1 lds
s_add_u32 m0, s62, 86016
s_add_u32 s64, s60, 65536
buffer_load_dwordx4 v2, s[32:35], s64 offen sc1 lds
s_add_u32 m0, s62, 87040
s_add_u32 s64, s60, 81920
buffer_load_dwordx4 v3, s[32:35], s64 offen sc1 lds
s_add_u32 m0, s62, 88064
s_add_u32 s64, s60, 98304
buffer_load_dwordx4 v2, s[32:35], s64 offen sc1 lds
s_add_u32 m0, s62, 89088
s_add_u32 s64, s60, 114688
buffer_load_dwordx4 v3, s[32:35], s64 offen sc1 lds
s_add_u32 s60, s60, 128
s_cmp_eq_u32 s91, s86
s_cselect_b32 s64, 393216, 0
s_add_u32 s61, s61, s64
s_add_u32 s91, s91, 1
s_add_u32 m0, s63, 81920
s_add_u32 s64, s61, 0
buffer_load_dwordx4 v4, s[36:39], s64 offen lds
s_add_u32 m0, s63, 82944
s_add_u32 s64, s61, 2048
buffer_load_dwordx4 v4, s[36:39], s64 offen lds
s_add_u32 m0, s63, 83968
s_add_u32 s64, s61, 4096
buffer_load_dwordx4 v4, s[36:39], s64 offen lds
s_add_u32 m0, s63, 84992
s_add_u32 s64, s61, 49152
buffer_load_dwordx4 v5, s[36:39], s64 offen lds
s_add_u32 m0, s63, 86016
s_add_u32 s64, s61, 51200
buffer_load_dwordx4 v5, s[36:39], s64 offen lds
s_add_u32 m0, s63, 87040
s_add_u32 s64, s61, 53248
buffer_load_dwordx4 v5, s[36:39], s64 offen lds
s_add_u32 m0, s63, 88064
s_add_u32 s64, s61, 98304
buffer_load_dwordx4 v4, s[36:39], s64 offen lds
s_add_u32 m0, s63, 89088
s_add_u32 s64, s61, 100352
buffer_load_dwordx4 v4, s[36:39], s64 offen lds
s_add_u32 m0, s63, 90112
s_add_u32 s64, s61, 102400
buffer_load_dwordx4 v4, s[36:39], s64 offen lds
s_add_u32 m0, s63, 91136
s_add_u32 s64, s61, 147456
buffer_load_dwordx4 v5, s[36:39], s64 offen lds
s_add_u32 m0, s63, 92160
s_add_u32 s64, s61, 149504
buffer_load_dwordx4 v5, s[36:39], s64 offen lds
s_add_u32 m0, s63, 93184
s_add_u32 s64, s61, 151552
buffer_load_dwordx4 v5, s[36:39], s64 offen lds
s_add_u32 s61, s61, 393216
s_mov_b32 s67, 0
s_mov_b32 s65, 0
p1_ld_loop:
s_waitcnt vmcnt(20)
s_barrier
s_cmp_lg_u32 s65, 1
s_cbranch_scc1 p1_ld_nat
s_mov_b32 s89, s60
s_mov_b32 s60, s92
s_add_u32 m0, s62, 0
s_add_u32 s64, s60, 0
buffer_load_dwordx4 v2, s[32:35], s64 offen sc1 lds
s_add_u32 m0, s62, 1024
s_add_u32 s64, s60, 16384
buffer_load_dwordx4 v3, s[32:35], s64 offen sc1 lds
s_add_u32 m0, s62, 2048
s_add_u32 s64, s60, 32768
buffer_load_dwordx4 v2, s[32:35], s64 offen sc1 lds
s_add_u32 m0, s62, 3072
s_add_u32 s64, s60, 49152
buffer_load_dwordx4 v3, s[32:35], s64 offen sc1 lds
s_add_u32 m0, s62, 4096
s_add_u32 s64, s60, 65536
buffer_load_dwordx4 v2, s[32:35], s64 offen sc1 lds
s_add_u32 m0, s62, 5120
s_add_u32 s64, s60, 81920
buffer_load_dwordx4 v3, s[32:35], s64 offen sc1 lds
s_add_u32 m0, s62, 6144
s_add_u32 s64, s60, 98304
buffer_load_dwordx4 v2, s[32:35], s64 offen sc1 lds
s_add_u32 m0, s62, 7168
s_add_u32 s64, s60, 114688
buffer_load_dwordx4 v3, s[32:35], s64 offen sc1 lds
s_add_u32 s60, s60, 128
s_mov_b32 s60, s89
s_mov_b32 s89, s61
s_mov_b32 s61, s93
s_add_u32 m0, s63, 0
s_add_u32 s64, s61, 0
buffer_load_dwordx4 v4, s[36:39], s64 offen lds
s_add_u32 m0, s63, 1024
s_add_u32 s64, s61, 2048
buffer_load_dwordx4 v4, s[36:39], s64 offen lds
s_add_u32 m0, s63, 2048
s_add_u32 s64, s61, 4096
buffer_load_dwordx4 v4, s[36:39], s64 offen lds
s_add_u32 m0, s63, 3072
s_add_u32 s64, s61, 49152
buffer_load_dwordx4 v5, s[36:39], s64 offen lds
s_add_u32 m0, s63, 4096
s_add_u32 s64, s61, 51200
buffer_load_dwordx4 v5, s[36:39], s64 offen lds
s_add_u32 m0, s63, 5120
s_add_u32 s64, s61, 53248
buffer_load_dwordx4 v5, s[36:39], s64 offen lds
s_add_u32 m0, s63, 6144
s_add_u32 s64, s61, 98304
buffer_load_dwordx4 v4, s[36:39], s64 offen lds
s_add_u32 m0, s63, 7168
s_add_u32 s64, s61, 100352
buffer_load_dwordx4 v4, s[36:39], s64 offen lds
s_add_u32 m0, s63, 8192
s_add_u32 s64, s61, 102400
buffer_load_dwordx4 v4, s[36:39], s64 offen lds
s_add_u32 m0, s63, 9216
s_add_u32 s64, s61, 147456
buffer_load_dwordx4 v5, s[36:39], s64 offen lds
s_add_u32 m0, s63, 10240
s_add_u32 s64, s61, 149504
buffer_load_dwordx4 v5, s[36:39], s64 offen lds
s_add_u32 m0, s63, 11264
s_add_u32 s64, s61, 151552
buffer_load_dwordx4 v5, s[36:39], s64 offen lds
s_add_u32 s61, s61, 393216
s_mov_b32 s61, s89
s_branch p1_ld_adv
p1_ld_nat:
s_cmp_eq_u32 s90, s86
s_cselect_b32 s64, 128, 0
s_add_u32 s60, s60, s64
s_add_u32 s90, s90, 1
s_add_u32 m0, s62, 0
s_add_u32 s64, s60, 0
buffer_load_dwordx4 v2, s[32:35], s64 offen sc1 lds
s_add_u32 m0, s62, 1024
s_add_u32 s64, s60, 16384
buffer_load_dwordx4 v3, s[32:35], s64 offen sc1 lds
s_add_u32 m0, s62, 2048
s_add_u32 s64, s60, 32768
buffer_load_dwordx4 v2, s[32:35], s64 offen sc1 lds
s_add_u32 m0, s62, 3072
s_add_u32 s64, s60, 49152
buffer_load_dwordx4 v3, s[32:35], s64 offen sc1 lds
s_add_u32 m0, s62, 4096
s_add_u32 s64, s60, 65536
buffer_load_dwordx4 v2, s[32:35], s64 offen sc1 lds
s_add_u32 m0, s62, 5120
s_add_u32 s64, s60, 81920
buffer_load_dwordx4 v3, s[32:35], s64 offen sc1 lds
s_add_u32 m0, s62, 6144
s_add_u32 s64, s60, 98304
buffer_load_dwordx4 v2, s[32:35], s64 offen sc1 lds
s_add_u32 m0, s62, 7168
s_add_u32 s64, s60, 114688
buffer_load_dwordx4 v3, s[32:35], s64 offen sc1 lds
s_add_u32 s60, s60, 128
s_cmp_eq_u32 s91, s86
s_cselect_b32 s64, 393216, 0
s_add_u32 s61, s61, s64
s_add_u32 s91, s91, 1
s_add_u32 m0, s63, 0
s_add_u32 s64, s61, 0
buffer_load_dwordx4 v4, s[36:39], s64 offen lds
s_add_u32 m0, s63, 1024
s_add_u32 s64, s61, 2048
buffer_load_dwordx4 v4, s[36:39], s64 offen lds
s_add_u32 m0, s63, 2048
s_add_u32 s64, s61, 4096
buffer_load_dwordx4 v4, s[36:39], s64 offen lds
s_add_u32 m0, s63, 3072
s_add_u32 s64, s61, 49152
buffer_load_dwordx4 v5, s[36:39], s64 offen lds
s_add_u32 m0, s63, 4096
s_add_u32 s64, s61, 51200
buffer_load_dwordx4 v5, s[36:39], s64 offen lds
s_add_u32 m0, s63, 5120
s_add_u32 s64, s61, 53248
buffer_load_dwordx4 v5, s[36:39], s64 offen lds
s_add_u32 m0, s63, 6144
s_add_u32 s64, s61, 98304
buffer_load_dwordx4 v4, s[36:39], s64 offen lds
s_add_u32 m0, s63, 7168
s_add_u32 s64, s61, 100352
buffer_load_dwordx4 v4, s[36:39], s64 offen lds
s_add_u32 m0, s63, 8192
s_add_u32 s64, s61, 102400
buffer_load_dwordx4 v4, s[36:39], s64 offen lds
s_add_u32 m0, s63, 9216
s_add_u32 s64, s61, 147456
buffer_load_dwordx4 v5, s[36:39], s64 offen lds
s_add_u32 m0, s63, 10240
s_add_u32 s64, s61, 149504
buffer_load_dwordx4 v5, s[36:39], s64 offen lds
s_add_u32 m0, s63, 11264
s_add_u32 s64, s61, 151552
buffer_load_dwordx4 v5, s[36:39], s64 offen lds
s_add_u32 s61, s61, 393216
p1_ld_adv:
s_add_u32 s67, s67, 1
s_cmp_eq_u32 s67, 3
s_cselect_b32 s66, s69, s68
s_cselect_b32 s67, 0, s67
s_add_u32 s62, s62, s66
s_add_u32 s63, s63, s66
s_add_u32 s65, s65, 1
s_cmp_lt_u32 s65, 13
s_cbranch_scc1 p1_ld_loop
s_lshl_b32 s70, s2, 1
s_add_u32 s70, s70, s7
s_lshl_b32 s70, s70, 13
v_lshlrev_b32 v16, 7, v1
s_mov_b32 s44, s16
s_mov_b32 s45, s17
s_mov_b32 s46, 0x200000
s_mov_b32 s47, 0x20000
s_mov_b32 s71, s70
buffer_load_dword v200, v16, s[44:47], s71 offen
s_mov_b32 s44, s18
s_mov_b32 s45, s19
s_mov_b32 s46, 0x380000
s_mov_b32 s47, 0x20000
s_mov_b32 s71, s70
buffer_load_dword v201, v16, s[44:47], s71 offen
s_waitcnt vmcnt(22)
s_barrier
s_waitcnt vmcnt(2)
s_barrier
s_barrier
s_barrier
s_sub_u32 s77, s3, 4
s_and_b32 s93, s77, 1
s_lshr_b32 s92, s77, 1
v_lshlrev_b32 v5, 4, v1
s_lshl_b32 s70, s77, 13
s_add_u32 s70, s70, 65536
v_add_u32 v5, s70, v5
ds_read_b128 v[160:163], v5 offset:0
ds_read_b128 v[164:167], v5 offset:1024
v_lshrrev_b32 v11, 4, v1
v_bfe_u32 v12, v1, 2, 2
v_and_b32 v13, 3, v1
v_lshlrev_b32 v14, 8, v11
v_lshl_add_u32 v14, v12, 6, v14
v_lshl_add_u32 v14, v13, 3, v14
s_lshl_b32 s70, s93, 11
s_add_u32 s70, s70, 122880
v_add_u32 v14, s70, v14
ds_read_b64_tr_b16 v[112:113], v14 offset:0
ds_read_b64_tr_b16 v[114:115], v14 offset:1024
ds_read_b64_tr_b16 v[116:117], v14 offset:32
ds_read_b64_tr_b16 v[118:119], v14 offset:1056
s_mov_b32 s94, 0x3fb8aa3b
s_mov_b32 s95, 0x3fb8aa3b
v_and_b32 v10, 15, v1
s_lshl_b32 s70, s77, 13
v_bfe_u32 v14, v10, 1, 2
v_bfe_u32 v15, v10, 2, 1
v_lshl_or_b32 v14, v15, 2, v14
v_xor_b32 v14, v14, v11
v_lshlrev_b32 v15, 6, v10
v_lshl_add_u32 v15, v14, 3, v15
v_add_u32 v8, s70, v15
v_xor_b32 v9, 32, v8
s_waitcnt lgkmcnt(0)
v_mfma_f32_16x16x32_bf16 v[16:19], v[112:115], v[160:163], 0
v_mfma_f32_16x16x32_bf16 v[20:23], v[116:119], v[160:163], 0
v_mfma_f32_16x16x32_bf16 v[48:51], v[112:115], v[164:167], 0
v_mfma_f32_16x16x32_bf16 v[52:55], v[116:119], v[164:167], 0
s_nop 4
v_max3_f32 v32, v16, v17, v18
s_nop 0
v_max3_f32 v64, v48, v49, v50
v_min3_f32 v34, v16, v17, v18
v_min3_f32 v66, v48, v49, v50
v_max3_f32 v32, v32, v19, v20
v_max3_f32 v64, v64, v51, v52
v_min3_f32 v34, v34, v19, v20
v_min3_f32 v66, v66, v51, v52
v_max3_f32 v32, v32, v21, v22
v_max3_f32 v64, v64, v53, v54
v_min3_f32 v34, v34, v21, v22
v_min3_f32 v66, v66, v53, v54
v_max_f32 v32, v32, v23
v_max_f32 v64, v64, v55
v_min_f32 v34, v34, v23
v_min_f32 v66, v66, v55
v_mov_b32 v36, v32
v_mov_b32 v68, v64
v_mov_b32 v37, v34
v_mov_b32 v69, v66
v_permlane16_swap_b32 v32, v36
v_permlane16_swap_b32 v64, v68
v_permlane16_swap_b32 v34, v37
v_permlane16_swap_b32 v66, v69
v_max_f32 v32, v32, v36
v_max_f32 v64, v64, v68
v_min_f32 v34, v34, v37
v_min_f32 v66, v66, v69
v_mov_b32 v36, v32
v_mov_b32 v68, v64
v_mov_b32 v37, v34
v_mov_b32 v69, v66
v_permlane32_swap_b32 v32, v36
v_permlane32_swap_b32 v64, v68
v_permlane32_swap_b32 v34, v37
v_permlane32_swap_b32 v66, v69
v_max_f32 v32, v32, v36
v_max_f32 v64, v64, v68
v_min_f32 v34, v34, v37
v_min_f32 v66, v66, v69
v_mul_f32 v32, s94, v32
v_mul_f32 v64, s94, v64
v_mul_f32 v34, s94, v34
v_mul_f32 v66, s94, v66
v_pk_fma_f32 v[24:25], v[16:17], s[94:95], v[32:33] op_sel_hi:[1,1,0] neg_lo:[0,0,1] neg_hi:[0,0,1]
v_pk_fma_f32 v[56:57], v[48:49], s[94:95], v[64:65] op_sel_hi:[1,1,0] neg_lo:[0,0,1] neg_hi:[0,0,1]
v_pk_fma_f32 v[16:17], v[16:17], s[94:95], v[34:35] op_sel_hi:[1,1,0] neg_lo:[1,0,0] neg_hi:[1,0,0]
v_pk_fma_f32 v[48:49], v[48:49], s[94:95], v[66:67] op_sel_hi:[1,1,0] neg_lo:[1,0,0] neg_hi:[1,0,0]
v_pk_fma_f32 v[26:27], v[18:19], s[94:95], v[32:33] op_sel_hi:[1,1,0] neg_lo:[0,0,1] neg_hi:[0,0,1]
v_pk_fma_f32 v[58:59], v[50:51], s[94:95], v[64:65] op_sel_hi:[1,1,0] neg_lo:[0,0,1] neg_hi:[0,0,1]
v_pk_fma_f32 v[18:19], v[18:19], s[94:95], v[34:35] op_sel_hi:[1,1,0] neg_lo:[1,0,0] neg_hi:[1,0,0]
v_pk_fma_f32 v[50:51], v[50:51], s[94:95], v[66:67] op_sel_hi:[1,1,0] neg_lo:[1,0,0] neg_hi:[1,0,0]
v_pk_fma_f32 v[28:29], v[20:21], s[94:95], v[32:33] op_sel_hi:[1,1,0] neg_lo:[0,0,1] neg_hi:[0,0,1]
v_pk_fma_f32 v[60:61], v[52:53], s[94:95], v[64:65] op_sel_hi:[1,1,0] neg_lo:[0,0,1] neg_hi:[0,0,1]
v_pk_fma_f32 v[20:21], v[20:21], s[94:95], v[34:35] op_sel_hi:[1,1,0] neg_lo:[1,0,0] neg_hi:[1,0,0]
v_pk_fma_f32 v[52:53], v[52:53], s[94:95], v[66:67] op_sel_hi:[1,1,0] neg_lo:[1,0,0] neg_hi:[1,0,0]
v_pk_fma_f32 v[30:31], v[22:23], s[94:95], v[32:33] op_sel_hi:[1,1,0] neg_lo:[0,0,1] neg_hi:[0,0,1]
v_pk_fma_f32 v[62:63], v[54:55], s[94:95], v[64:65] op_sel_hi:[1,1,0] neg_lo:[0,0,1] neg_hi:[0,0,1]
v_pk_fma_f32 v[22:23], v[22:23], s[94:95], v[34:35] op_sel_hi:[1,1,0] neg_lo:[1,0,0] neg_hi:[1,0,0]
v_pk_fma_f32 v[54:55], v[54:55], s[94:95], v[66:67] op_sel_hi:[1,1,0] neg_lo:[1,0,0] neg_hi:[1,0,0]
v_exp_f32 v24, v24
v_exp_f32 v56, v56
v_exp_f32 v16, v16
v_exp_f32 v48, v48
v_exp_f32 v25, v25
v_exp_f32 v57, v57
v_exp_f32 v17, v17
v_exp_f32 v49, v49
v_exp_f32 v26, v26
v_exp_f32 v58, v58
v_exp_f32 v18, v18
v_exp_f32 v50, v50
v_exp_f32 v27, v27
v_exp_f32 v59, v59
v_exp_f32 v19, v19
v_exp_f32 v51, v51
v_exp_f32 v28, v28
v_exp_f32 v60, v60
v_exp_f32 v20, v20
v_exp_f32 v52, v52
v_exp_f32 v29, v29
v_exp_f32 v61, v61
v_exp_f32 v21, v21
v_exp_f32 v53, v53
v_exp_f32 v30, v30
v_exp_f32 v62, v62
v_exp_f32 v22, v22
v_exp_f32 v54, v54
v_exp_f32 v31, v31
v_exp_f32 v63, v63
v_exp_f32 v23, v23
v_exp_f32 v55, v55
v_pk_add_f32 v[32:33], v[24:25], v[26:27]
v_pk_add_f32 v[64:65], v[56:57], v[58:59]
v_pk_add_f32 v[34:35], v[16:17], v[18:19]
v_pk_add_f32 v[66:67], v[48:49], v[50:51]
v_pk_add_f32 v[32:33], v[32:33], v[28:29]
v_pk_add_f32 v[64:65], v[64:65], v[60:61]
v_pk_add_f32 v[34:35], v[34:35], v[20:21]
v_pk_add_f32 v[66:67], v[66:67], v[52:53]
v_pk_add_f32 v[32:33], v[32:33], v[30:31]
v_pk_add_f32 v[64:65], v[64:65], v[62:63]
v_pk_add_f32 v[34:35], v[34:35], v[22:23]
v_pk_add_f32 v[66:67], v[66:67], v[54:55]
v_add_f32 v38, v32, v33
v_add_f32 v70, v64, v65
v_add_f32 v39, v34, v35
v_add_f32 v71, v66, v67
v_mov_b32 v36, v38
v_mov_b32 v68, v70
v_mov_b32 v37, v39
v_mov_b32 v69, v71
v_permlane16_swap_b32 v38, v36
v_permlane16_swap_b32 v70, v68
v_permlane16_swap_b32 v39, v37
v_permlane16_swap_b32 v71, v69
v_add_f32 v38, v38, v36
v_add_f32 v70, v70, v68
v_add_f32 v39, v39, v37
v_add_f32 v71, v71, v69
v_mov_b32 v36, v38
v_mov_b32 v68, v70
v_mov_b32 v37, v39
v_mov_b32 v69, v71
v_permlane32_swap_b32 v38, v36
v_permlane32_swap_b32 v70, v68
v_permlane32_swap_b32 v39, v37
v_permlane32_swap_b32 v71, v69
v_add_f32 v38, v38, v36
v_add_f32 v70, v70, v68
v_add_f32 v39, v39, v37
v_add_f32 v71, v71, v69
v_rcp_f32 v32, v38
v_rcp_f32 v64, v70
v_rcp_f32 v34, v39
v_rcp_f32 v66, v71
v_pk_mul_f32 v[24:25], v[24:25], v[32:33] op_sel_hi:[1,0]
v_pk_mul_f32 v[56:57], v[56:57], v[64:65] op_sel_hi:[1,0]
v_pk_mul_f32 v[16:17], v[16:17], v[34:35] op_sel_hi:[1,0]
v_pk_mul_f32 v[48:49], v[48:49], v[66:67] op_sel_hi:[1,0]
v_pk_mul_f32 v[26:27], v[26:27], v[32:33] op_sel_hi:[1,0]
v_pk_mul_f32 v[58:59], v[58:59], v[64:65] op_sel_hi:[1,0]
v_pk_mul_f32 v[18:19], v[18:19], v[34:35] op_sel_hi:[1,0]
v_pk_mul_f32 v[50:51], v[50:51], v[66:67] op_sel_hi:[1,0]
v_pk_mul_f32 v[28:29], v[28:29], v[32:33] op_sel_hi:[1,0]
v_pk_mul_f32 v[60:61], v[60:61], v[64:65] op_sel_hi:[1,0]
v_pk_mul_f32 v[20:21], v[20:21], v[34:35] op_sel_hi:[1,0]
v_pk_mul_f32 v[52:53], v[52:53], v[66:67] op_sel_hi:[1,0]
v_pk_mul_f32 v[30:31], v[30:31], v[32:33] op_sel_hi:[1,0]
v_pk_mul_f32 v[62:63], v[62:63], v[64:65] op_sel_hi:[1,0]
v_pk_mul_f32 v[22:23], v[22:23], v[34:35] op_sel_hi:[1,0]
v_pk_mul_f32 v[54:55], v[54:55], v[66:67] op_sel_hi:[1,0]
v_cvt_pk_bf16_f32 v144, v24, v25
v_cvt_pk_bf16_f32 v152, v56, v57
v_cvt_pk_bf16_f32 v145, v26, v27
v_cvt_pk_bf16_f32 v153, v58, v59
v_cvt_pk_bf16_f32 v146, v28, v29
v_cvt_pk_bf16_f32 v154, v60, v61
v_cvt_pk_bf16_f32 v147, v30, v31
v_cvt_pk_bf16_f32 v155, v62, v63
v_cvt_pk_bf16_f32 v148, v16, v17
v_cvt_pk_bf16_f32 v156, v48, v49
v_cvt_pk_bf16_f32 v149, v18, v19
v_cvt_pk_bf16_f32 v157, v50, v51
v_cvt_pk_bf16_f32 v150, v20, v21
v_cvt_pk_bf16_f32 v158, v52, v53
v_cvt_pk_bf16_f32 v151, v22, v23
v_cvt_pk_bf16_f32 v159, v54, v55
ds_write_b64 v8, v[144:145] offset:2048
ds_write_b64 v9, v[146:147] offset:2048
ds_write_b64 v8, v[148:149] offset:6144
ds_write_b64 v9, v[150:151] offset:6144
ds_write_b64 v8, v[152:153] offset:3072
ds_write_b64 v9, v[154:155] offset:3072
ds_write_b64 v8, v[156:157] offset:7168
ds_write_b64 v9, v[158:159] offset:7168
ds_read_b128 v[80:83], v5 offset:2048
ds_read_b128 v[84:87], v5 offset:3072
ds_read_b128 v[88:91], v5 offset:4096
ds_read_b128 v[92:95], v5 offset:5120
s_lshl_b32 s70, s92, 9
s_add_u32 s70, s70, 135424
v_lshlrev_b32 v14, 3, v10
v_add_u32 v14, s70, v14
ds_read_b64 v[96:97], v14 offset:256
ds_read_b64 v[98:99], v14 offset:384
s_lshl_b32 s71, s93, 7
s_add_u32 s71, s71, 136448
v_lshlrev_b32 v14, 4, v11
v_add_u32 v14, s71, v14
ds_read_b128 v[104:107], v14 offset:0
ds_read_b128 v[108:111], v14 offset:64
v_mov_b32 v14, 163776
ds_read_b64 v[6:7], v14
s_waitcnt lgkmcnt(0)
s_barrier
s_barrier
v_readfirstlane_b32 s28, v6
v_readfirstlane_b32 s29, v7
v_pk_mul_f32 v[100:101], v[104:105], v[96:97] op_sel:[0,1] op_sel_hi:[1,1]
v_pk_mul_f32 v[102:103], v[106:107], v[96:97] op_sel:[0,1] op_sel_hi:[1,1]
v_pk_fma_f32 v[80:81], v[80:81], v[96:97], v[100:101] op_sel:[0,0,0] op_sel_hi:[1,0,1]
v_pk_fma_f32 v[82:83], v[82:83], v[96:97], v[102:103] op_sel:[0,0,0] op_sel_hi:[1,0,1]
v_pk_mul_f32 v[100:101], v[108:109], v[96:97] op_sel:[0,1] op_sel_hi:[1,1]
v_pk_mul_f32 v[102:103], v[110:111], v[96:97] op_sel:[0,1] op_sel_hi:[1,1]
v_pk_fma_f32 v[84:85], v[84:85], v[96:97], v[100:101] op_sel:[0,0,0] op_sel_hi:[1,0,1]
v_pk_fma_f32 v[86:87], v[86:87], v[96:97], v[102:103] op_sel:[0,0,0] op_sel_hi:[1,0,1]
v_cvt_pk_bf16_f32 v160, v80, v81
v_cvt_pk_bf16_f32 v161, v82, v83
v_cvt_pk_bf16_f32 v162, v84, v85
v_cvt_pk_bf16_f32 v163, v86, v87
v_pk_mul_f32 v[100:101], v[104:105], v[98:99] op_sel:[0,1] op_sel_hi:[1,1]
v_pk_mul_f32 v[102:103], v[106:107], v[98:99] op_sel:[0,1] op_sel_hi:[1,1]
v_pk_fma_f32 v[88:89], v[88:89], v[98:99], v[100:101] op_sel:[0,0,0] op_sel_hi:[1,0,1]
v_pk_fma_f32 v[90:91], v[90:91], v[98:99], v[102:103] op_sel:[0,0,0] op_sel_hi:[1,0,1]
v_pk_mul_f32 v[100:101], v[108:109], v[98:99] op_sel:[0,1] op_sel_hi:[1,1]
v_pk_mul_f32 v[102:103], v[110:111], v[98:99] op_sel:[0,1] op_sel_hi:[1,1]
v_pk_fma_f32 v[92:93], v[92:93], v[98:99], v[100:101] op_sel:[0,0,0] op_sel_hi:[1,0,1]
v_pk_fma_f32 v[94:95], v[94:95], v[98:99], v[102:103] op_sel:[0,0,0] op_sel_hi:[1,0,1]
v_cvt_pk_bf16_f32 v164, v88, v89
v_cvt_pk_bf16_f32 v165, v90, v91
v_cvt_pk_bf16_f32 v166, v92, v93
v_cvt_pk_bf16_f32 v167, v94, v95
v_mfma_f32_16x16x32_bf16 v[16:19], v[112:115], v[160:163], 0
v_mfma_f32_16x16x32_bf16 v[20:23], v[116:119], v[160:163], 0
v_mfma_f32_16x16x32_bf16 v[48:51], v[112:115], v[164:167], 0
v_mfma_f32_16x16x32_bf16 v[52:55], v[116:119], v[164:167], 0
s_nop 4
v_max3_f32 v32, v16, v17, v18
s_nop 0
v_max3_f32 v64, v48, v49, v50
v_min3_f32 v34, v16, v17, v18
v_min3_f32 v66, v48, v49, v50
v_max3_f32 v32, v32, v19, v20
v_max3_f32 v64, v64, v51, v52
v_min3_f32 v34, v34, v19, v20
v_min3_f32 v66, v66, v51, v52
v_max3_f32 v32, v32, v21, v22
v_max3_f32 v64, v64, v53, v54
v_min3_f32 v34, v34, v21, v22
v_min3_f32 v66, v66, v53, v54
v_max_f32 v32, v32, v23
v_max_f32 v64, v64, v55
v_min_f32 v34, v34, v23
v_min_f32 v66, v66, v55
v_mov_b32 v36, v32
v_mov_b32 v68, v64
v_mov_b32 v37, v34
v_mov_b32 v69, v66
v_permlane16_swap_b32 v32, v36
v_permlane16_swap_b32 v64, v68
v_permlane16_swap_b32 v34, v37
v_permlane16_swap_b32 v66, v69
v_max_f32 v32, v32, v36
v_max_f32 v64, v64, v68
v_min_f32 v34, v34, v37
v_min_f32 v66, v66, v69
v_mov_b32 v36, v32
v_mov_b32 v68, v64
v_mov_b32 v37, v34
v_mov_b32 v69, v66
v_permlane32_swap_b32 v32, v36
v_permlane32_swap_b32 v64, v68
v_permlane32_swap_b32 v34, v37
v_permlane32_swap_b32 v66, v69
v_max_f32 v32, v32, v36
v_max_f32 v64, v64, v68
v_min_f32 v34, v34, v37
v_min_f32 v66, v66, v69
v_mul_f32 v32, s94, v32
v_mul_f32 v64, s94, v64
v_mul_f32 v34, s94, v34
v_mul_f32 v66, s94, v66
v_pk_fma_f32 v[24:25], v[16:17], s[94:95], v[32:33] op_sel_hi:[1,1,0] neg_lo:[0,0,1] neg_hi:[0,0,1]
v_pk_fma_f32 v[56:57], v[48:49], s[94:95], v[64:65] op_sel_hi:[1,1,0] neg_lo:[0,0,1] neg_hi:[0,0,1]
v_pk_fma_f32 v[16:17], v[16:17], s[94:95], v[34:35] op_sel_hi:[1,1,0] neg_lo:[1,0,0] neg_hi:[1,0,0]
v_pk_fma_f32 v[48:49], v[48:49], s[94:95], v[66:67] op_sel_hi:[1,1,0] neg_lo:[1,0,0] neg_hi:[1,0,0]
v_pk_fma_f32 v[26:27], v[18:19], s[94:95], v[32:33] op_sel_hi:[1,1,0] neg_lo:[0,0,1] neg_hi:[0,0,1]
v_pk_fma_f32 v[58:59], v[50:51], s[94:95], v[64:65] op_sel_hi:[1,1,0] neg_lo:[0,0,1] neg_hi:[0,0,1]
v_pk_fma_f32 v[18:19], v[18:19], s[94:95], v[34:35] op_sel_hi:[1,1,0] neg_lo:[1,0,0] neg_hi:[1,0,0]
v_pk_fma_f32 v[50:51], v[50:51], s[94:95], v[66:67] op_sel_hi:[1,1,0] neg_lo:[1,0,0] neg_hi:[1,0,0]
v_pk_fma_f32 v[28:29], v[20:21], s[94:95], v[32:33] op_sel_hi:[1,1,0] neg_lo:[0,0,1] neg_hi:[0,0,1]
v_pk_fma_f32 v[60:61], v[52:53], s[94:95], v[64:65] op_sel_hi:[1,1,0] neg_lo:[0,0,1] neg_hi:[0,0,1]
v_pk_fma_f32 v[20:21], v[20:21], s[94:95], v[34:35] op_sel_hi:[1,1,0] neg_lo:[1,0,0] neg_hi:[1,0,0]
v_pk_fma_f32 v[52:53], v[52:53], s[94:95], v[66:67] op_sel_hi:[1,1,0] neg_lo:[1,0,0] neg_hi:[1,0,0]
v_pk_fma_f32 v[30:31], v[22:23], s[94:95], v[32:33] op_sel_hi:[1,1,0] neg_lo:[0,0,1] neg_hi:[0,0,1]
v_pk_fma_f32 v[62:63], v[54:55], s[94:95], v[64:65] op_sel_hi:[1,1,0] neg_lo:[0,0,1] neg_hi:[0,0,1]
v_pk_fma_f32 v[22:23], v[22:23], s[94:95], v[34:35] op_sel_hi:[1,1,0] neg_lo:[1,0,0] neg_hi:[1,0,0]
v_pk_fma_f32 v[54:55], v[54:55], s[94:95], v[66:67] op_sel_hi:[1,1,0] neg_lo:[1,0,0] neg_hi:[1,0,0]
v_exp_f32 v24, v24
v_exp_f32 v56, v56
v_exp_f32 v16, v16
v_exp_f32 v48, v48
v_exp_f32 v25, v25
v_exp_f32 v57, v57
v_exp_f32 v17, v17
v_exp_f32 v49, v49
v_exp_f32 v26, v26
v_exp_f32 v58, v58
v_exp_f32 v18, v18
v_exp_f32 v50, v50
v_exp_f32 v27, v27
v_exp_f32 v59, v59
v_exp_f32 v19, v19
v_exp_f32 v51, v51
v_exp_f32 v28, v28
v_exp_f32 v60, v60
v_exp_f32 v20, v20
v_exp_f32 v52, v52
v_exp_f32 v29, v29
v_exp_f32 v61, v61
v_exp_f32 v21, v21
v_exp_f32 v53, v53
v_exp_f32 v30, v30
v_exp_f32 v62, v62
v_exp_f32 v22, v22
v_exp_f32 v54, v54
v_exp_f32 v31, v31
v_exp_f32 v63, v63
v_exp_f32 v23, v23
v_exp_f32 v55, v55
v_pk_add_f32 v[32:33], v[24:25], v[26:27]
v_pk_add_f32 v[64:65], v[56:57], v[58:59]
v_pk_add_f32 v[34:35], v[16:17], v[18:19]
v_pk_add_f32 v[66:67], v[48:49], v[50:51]
v_pk_add_f32 v[32:33], v[32:33], v[28:29]
v_pk_add_f32 v[64:65], v[64:65], v[60:61]
v_pk_add_f32 v[34:35], v[34:35], v[20:21]
v_pk_add_f32 v[66:67], v[66:67], v[52:53]
v_pk_add_f32 v[32:33], v[32:33], v[30:31]
v_pk_add_f32 v[64:65], v[64:65], v[62:63]
v_pk_add_f32 v[34:35], v[34:35], v[22:23]
v_pk_add_f32 v[66:67], v[66:67], v[54:55]
v_add_f32 v38, v32, v33
v_add_f32 v70, v64, v65
v_add_f32 v39, v34, v35
v_add_f32 v71, v66, v67
v_mov_b32 v36, v38
v_mov_b32 v68, v70
v_mov_b32 v37, v39
v_mov_b32 v69, v71
v_permlane16_swap_b32 v38, v36
v_permlane16_swap_b32 v70, v68
v_permlane16_swap_b32 v39, v37
v_permlane16_swap_b32 v71, v69
v_add_f32 v38, v38, v36
v_add_f32 v70, v70, v68
v_add_f32 v39, v39, v37
v_add_f32 v71, v71, v69
v_mov_b32 v36, v38
v_mov_b32 v68, v70
v_mov_b32 v37, v39
v_mov_b32 v69, v71
v_permlane32_swap_b32 v38, v36
v_permlane32_swap_b32 v70, v68
v_permlane32_swap_b32 v39, v37
v_permlane32_swap_b32 v71, v69
v_add_f32 v38, v38, v36
v_add_f32 v70, v70, v68
v_add_f32 v39, v39, v37
v_add_f32 v71, v71, v69
v_rcp_f32 v32, v38
v_rcp_f32 v64, v70
v_rcp_f32 v34, v39
v_rcp_f32 v66, v71
v_pk_mul_f32 v[24:25], v[24:25], v[32:33] op_sel_hi:[1,0]
v_pk_mul_f32 v[56:57], v[56:57], v[64:65] op_sel_hi:[1,0]
v_pk_mul_f32 v[16:17], v[16:17], v[34:35] op_sel_hi:[1,0]
v_pk_mul_f32 v[48:49], v[48:49], v[66:67] op_sel_hi:[1,0]
v_pk_mul_f32 v[26:27], v[26:27], v[32:33] op_sel_hi:[1,0]
v_pk_mul_f32 v[58:59], v[58:59], v[64:65] op_sel_hi:[1,0]
v_pk_mul_f32 v[18:19], v[18:19], v[34:35] op_sel_hi:[1,0]
v_pk_mul_f32 v[50:51], v[50:51], v[66:67] op_sel_hi:[1,0]
v_pk_mul_f32 v[28:29], v[28:29], v[32:33] op_sel_hi:[1,0]
v_pk_mul_f32 v[60:61], v[60:61], v[64:65] op_sel_hi:[1,0]
v_pk_mul_f32 v[20:21], v[20:21], v[34:35] op_sel_hi:[1,0]
v_pk_mul_f32 v[52:53], v[52:53], v[66:67] op_sel_hi:[1,0]
v_pk_mul_f32 v[30:31], v[30:31], v[32:33] op_sel_hi:[1,0]
v_pk_mul_f32 v[62:63], v[62:63], v[64:65] op_sel_hi:[1,0]
v_pk_mul_f32 v[22:23], v[22:23], v[34:35] op_sel_hi:[1,0]
v_pk_mul_f32 v[54:55], v[54:55], v[66:67] op_sel_hi:[1,0]
v_cvt_pk_bf16_f32 v128, v24, v25
v_cvt_pk_bf16_f32 v136, v56, v57
v_cvt_pk_bf16_f32 v129, v26, v27
v_cvt_pk_bf16_f32 v137, v58, v59
v_cvt_pk_bf16_f32 v130, v28, v29
v_cvt_pk_bf16_f32 v138, v60, v61
v_cvt_pk_bf16_f32 v131, v30, v31
v_cvt_pk_bf16_f32 v139, v62, v63
v_cvt_pk_bf16_f32 v132, v16, v17
v_cvt_pk_bf16_f32 v140, v48, v49
v_cvt_pk_bf16_f32 v133, v18, v19
v_cvt_pk_bf16_f32 v141, v50, v51
v_cvt_pk_bf16_f32 v134, v20, v21
v_cvt_pk_bf16_f32 v142, v52, v53
v_cvt_pk_bf16_f32 v135, v22, v23
v_cvt_pk_bf16_f32 v143, v54, v55
s_barrier
s_add_u32 s40, s8, 0x400000
s_addc_u32 s41, s9, 0
s_mov_b32 s42, 0x200000
s_mov_b32 s43, 0x20000
v_lshlrev_b32 v8, 4, v1
s_lshl_b32 s70, s5, 17
s_lshl_b32 s71, s3, 10
s_add_u32 s70, s70, s71
buffer_load_dwordx4 v[32:35], v8, s[40:43], s70 offen sc1
s_add_u32 s70, s70, 8192
buffer_load_dwordx4 v[36:39], v8, s[40:43], s70 offen sc1
s_add_u32 s70, s70, 8192
buffer_load_dwordx4 v[40:43], v8, s[40:43], s70 offen sc1
s_add_u32 s70, s70, 8192
buffer_load_dwordx4 v[44:47], v8, s[40:43], s70 offen sc1
s_add_u32 s70, s70, 8192
buffer_load_dwordx4 v[48:51], v8, s[40:43], s70 offen sc1
s_add_u32 s70, s70, 8192
buffer_load_dwordx4 v[52:55], v8, s[40:43], s70 offen sc1
s_add_u32 s70, s70, 8192
buffer_load_dwordx4 v[56:59], v8, s[40:43], s70 offen sc1
s_add_u32 s70, s70, 8192
buffer_load_dwordx4 v[60:63], v8, s[40:43], s70 offen sc1
s_add_u32 s70, s70, 8192
buffer_load_dwordx4 v[64:67], v8, s[40:43], s70 offen sc1
s_add_u32 s70, s70, 8192
buffer_load_dwordx4 v[68:71], v8, s[40:43], s70 offen sc1
s_add_u32 s70, s70, 8192
buffer_load_dwordx4 v[72:75], v8, s[40:43], s70 offen sc1
s_add_u32 s70, s70, 8192
buffer_load_dwordx4 v[76:79], v8, s[40:43], s70 offen sc1
s_add_u32 s70, s70, 8192
buffer_load_dwordx4 v[80:83], v8, s[40:43], s70 offen sc1
s_add_u32 s70, s70, 8192
buffer_load_dwordx4 v[84:87], v8, s[40:43], s70 offen sc1
s_add_u32 s70, s70, 8192
buffer_load_dwordx4 v[88:91], v8, s[40:43], s70 offen sc1
s_add_u32 s70, s70, 8192
buffer_load_dwordx4 v[92:95], v8, s[40:43], s70 offen sc1
s_mov_b32 s74, 0x00003f80
s_mov_b32 s75, 0x3f800000
v_mov_b32 v16, 0
v_mov_b32 v17, 0
v_mov_b32 v18, 0
v_mov_b32 v19, 0
v_mov_b32 v20, 0
v_mov_b32 v21, 0
v_mov_b32 v22, 0
v_mov_b32 v23, 0
v_mov_b32 v24, s74
v_mov_b32 v25, s75
s_waitcnt vmcnt(0)
v_dot2c_f32_bf16 v16, v32, v24
v_dot2c_f32_bf16 v17, v32, v25
v_dot2c_f32_bf16 v18, v33, v24
v_dot2c_f32_bf16 v19, v33, v25
v_dot2c_f32_bf16 v20, v34, v24
v_dot2c_f32_bf16 v21, v34, v25
v_dot2c_f32_bf16 v22, v35, v24
v_dot2c_f32_bf16 v23, v35, v25
v_dot2c_f32_bf16 v16, v36, v24
v_dot2c_f32_bf16 v17, v36, v25
v_dot2c_f32_bf16 v18, v37, v24
v_dot2c_f32_bf16 v19, v37, v25
v_dot2c_f32_bf16 v20, v38, v24
v_dot2c_f32_bf16 v21, v38, v25
v_dot2c_f32_bf16 v22, v39, v24
v_dot2c_f32_bf16 v23, v39, v25
v_dot2c_f32_bf16 v16, v40, v24
v_dot2c_f32_bf16 v17, v40, v25
v_dot2c_f32_bf16 v18, v41, v24
v_dot2c_f32_bf16 v19, v41, v25
v_dot2c_f32_bf16 v20, v42, v24
v_dot2c_f32_bf16 v21, v42, v25
v_dot2c_f32_bf16 v22, v43, v24
v_dot2c_f32_bf16 v23, v43, v25
v_dot2c_f32_bf16 v16, v44, v24
v_dot2c_f32_bf16 v17, v44, v25
v_dot2c_f32_bf16 v18, v45, v24
v_dot2c_f32_bf16 v19, v45, v25
v_dot2c_f32_bf16 v20, v46, v24
v_dot2c_f32_bf16 v21, v46, v25
v_dot2c_f32_bf16 v22, v47, v24
v_dot2c_f32_bf16 v23, v47, v25
v_dot2c_f32_bf16 v16, v48, v24
v_dot2c_f32_bf16 v17, v48, v25
v_dot2c_f32_bf16 v18, v49, v24
v_dot2c_f32_bf16 v19, v49, v25
v_dot2c_f32_bf16 v20, v50, v24
v_dot2c_f32_bf16 v21, v50, v25
v_dot2c_f32_bf16 v22, v51, v24
v_dot2c_f32_bf16 v23, v51, v25
v_dot2c_f32_bf16 v16, v52, v24
v_dot2c_f32_bf16 v17, v52, v25
v_dot2c_f32_bf16 v18, v53, v24
v_dot2c_f32_bf16 v19, v53, v25
v_dot2c_f32_bf16 v20, v54, v24
v_dot2c_f32_bf16 v21, v54, v25
v_dot2c_f32_bf16 v22, v55, v24
v_dot2c_f32_bf16 v23, v55, v25
v_dot2c_f32_bf16 v16, v56, v24
v_dot2c_f32_bf16 v17, v56, v25
v_dot2c_f32_bf16 v18, v57, v24
v_dot2c_f32_bf16 v19, v57, v25
v_dot2c_f32_bf16 v20, v58, v24
v_dot2c_f32_bf16 v21, v58, v25
v_dot2c_f32_bf16 v22, v59, v24
v_dot2c_f32_bf16 v23, v59, v25
v_dot2c_f32_bf16 v16, v60, v24
v_dot2c_f32_bf16 v17, v60, v25
v_dot2c_f32_bf16 v18, v61, v24
v_dot2c_f32_bf16 v19, v61, v25
v_dot2c_f32_bf16 v20, v62, v24
v_dot2c_f32_bf16 v21, v62, v25
v_dot2c_f32_bf16 v22, v63, v24
v_dot2c_f32_bf16 v23, v63, v25
v_dot2c_f32_bf16 v16, v64, v24
v_dot2c_f32_bf16 v17, v64, v25
v_dot2c_f32_bf16 v18, v65, v24
v_dot2c_f32_bf16 v19, v65, v25
v_dot2c_f32_bf16 v20, v66, v24
v_dot2c_f32_bf16 v21, v66, v25
v_dot2c_f32_bf16 v22, v67, v24
v_dot2c_f32_bf16 v23, v67, v25
v_dot2c_f32_bf16 v16, v68, v24
v_dot2c_f32_bf16 v17, v68, v25
v_dot2c_f32_bf16 v18, v69, v24
v_dot2c_f32_bf16 v19, v69, v25
v_dot2c_f32_bf16 v20, v70, v24
v_dot2c_f32_bf16 v21, v70, v25
v_dot2c_f32_bf16 v22, v71, v24
v_dot2c_f32_bf16 v23, v71, v25
v_dot2c_f32_bf16 v16, v72, v24
v_dot2c_f32_bf16 v17, v72, v25
v_dot2c_f32_bf16 v18, v73, v24
v_dot2c_f32_bf16 v19, v73, v25
v_dot2c_f32_bf16 v20, v74, v24
v_dot2c_f32_bf16 v21, v74, v25
v_dot2c_f32_bf16 v22, v75, v24
v_dot2c_f32_bf16 v23, v75, v25
v_dot2c_f32_bf16 v16, v76, v24
v_dot2c_f32_bf16 v17, v76, v25
v_dot2c_f32_bf16 v18, v77, v24
v_dot2c_f32_bf16 v19, v77, v25
v_dot2c_f32_bf16 v20, v78, v24
v_dot2c_f32_bf16 v21, v78, v25
v_dot2c_f32_bf16 v22, v79, v24
v_dot2c_f32_bf16 v23, v79, v25
v_dot2c_f32_bf16 v16, v80, v24
v_dot2c_f32_bf16 v17, v80, v25
v_dot2c_f32_bf16 v18, v81, v24
v_dot2c_f32_bf16 v19, v81, v25
v_dot2c_f32_bf16 v20, v82, v24
v_dot2c_f32_bf16 v21, v82, v25
v_dot2c_f32_bf16 v22, v83, v24
v_dot2c_f32_bf16 v23, v83, v25
v_dot2c_f32_bf16 v16, v84, v24
v_dot2c_f32_bf16 v17, v84, v25
v_dot2c_f32_bf16 v18, v85, v24
v_dot2c_f32_bf16 v19, v85, v25
v_dot2c_f32_bf16 v20, v86, v24
v_dot2c_f32_bf16 v21, v86, v25
v_dot2c_f32_bf16 v22, v87, v24
v_dot2c_f32_bf16 v23, v87, v25
v_dot2c_f32_bf16 v16, v88, v24
v_dot2c_f32_bf16 v17, v88, v25
v_dot2c_f32_bf16 v18, v89, v24
v_dot2c_f32_bf16 v19, v89, v25
v_dot2c_f32_bf16 v20, v90, v24
v_dot2c_f32_bf16 v21, v90, v25
v_dot2c_f32_bf16 v22, v91, v24
v_dot2c_f32_bf16 v23, v91, v25
v_dot2c_f32_bf16 v16, v92, v24
v_dot2c_f32_bf16 v17, v92, v25
v_dot2c_f32_bf16 v18, v93, v24
v_dot2c_f32_bf16 v19, v93, v25
v_dot2c_f32_bf16 v20, v94, v24
v_dot2c_f32_bf16 v21, v94, v25
v_dot2c_f32_bf16 v22, v95, v24
v_dot2c_f32_bf16 v23, v95, v25
v_cvt_pk_bf16_f32 v28, v16, v17
v_cvt_pk_bf16_f32 v29, v18, v19
v_cvt_pk_bf16_f32 v30, v20, v21
v_cvt_pk_bf16_f32 v31, v22, v23
s_lshl_b32 s71, s3, 10
s_add_u32 s71, s71, 126976
v_add_u32 v8, s71, v8
ds_write_b128 v8, v[28:31]
s_waitcnt lgkmcnt(0)
s_barrier
s_add_u32 s48, s8, 0x800000
s_addc_u32 s49, s9, 0
s_mov_b32 s50, 0x400000
s_mov_b32 s51, 0x20000
v_lshrrev_b32 v11, 4, v1
v_lshlrev_b32 v12, 4, v1
s_lshl_b32 s70, s93, 12
s_add_u32 s70, s70, 126976
v_add_u32 v13, s70, v12
ds_read_b128 v[112:115], v13 offset:0
ds_read_b128 v[116:119], v13 offset:1024
ds_read_b128 v[120:123], v13 offset:2048
ds_read_b128 v[124:127], v13 offset:3072
s_lshl_b32 s70, s93, 7
s_add_u32 s70, s70, 135168
v_lshlrev_b32 v14, 4, v11
v_add_u32 v14, s70, v14
ds_read_b128 v[160:163], v14 offset:0
ds_read_b128 v[164:167], v14 offset:64
s_lshl_b32 s70, s4, 2
s_lshl_b32 s71, s92, 1
s_add_u32 s70, s70, s71
s_add_u32 s70, s70, 1
s_lshl_b32 s70, s70, 7
s_lshl_b32 s71, s5, 3
s_add_u32 s70, s70, s71
s_lshl_b32 s71, s93, 2
s_add_u32 s70, s70, s71
s_lshl_b32 s70, s70, 9
s_lshl_b32 s88, s4, 7
s_lshl_b32 s71, s5, 3
s_add_u32 s88, s88, s71
s_waitcnt lgkmcnt(0)
v_mfma_f32_16x16x32_bf16 v[48:51], v[160:163], v[128:131], 0
v_mfma_f32_16x16x32_bf16 v[48:51], v[164:167], v[132:135], v[48:51]
v_mfma_f32_16x16x32_bf16 v[52:55], v[160:163], v[136:139], 0
v_mfma_f32_16x16x32_bf16 v[52:55], v[164:167], v[140:143], v[52:55]
v_mfma_f32_16x16x32_bf16 v[16:19], v[112:115], v[128:131], 0
v_mfma_f32_16x16x32_bf16 v[16:19], v[120:123], v[132:135], v[16:19]
v_mfma_f32_16x16x32_bf16 v[20:23], v[116:119], v[128:131], 0
v_mfma_f32_16x16x32_bf16 v[20:23], v[124:127], v[132:135], v[20:23]
v_mfma_f32_16x16x32_bf16 v[24:27], v[112:115], v[136:139], 0
v_mfma_f32_16x16x32_bf16 v[24:27], v[120:123], v[140:143], v[24:27]
v_mfma_f32_16x16x32_bf16 v[28:31], v[116:119], v[136:139], 0
v_mfma_f32_16x16x32_bf16 v[28:31], v[124:127], v[140:143], v[28:31]
v_add_f32 v64, 0x358637bd, v48
v_add_f32 v66, 0x358637bd, v52
v_rcp_f32 v64, v64
v_rcp_f32 v66, v66
v_pk_mul_f32 v[16:17], v[16:17], v[64:65] op_sel_hi:[1,0]
v_pk_mul_f32 v[18:19], v[18:19], v[64:65] op_sel_hi:[1,0]
v_pk_mul_f32 v[20:21], v[20:21], v[64:65] op_sel_hi:[1,0]
v_pk_mul_f32 v[22:23], v[22:23], v[64:65] op_sel_hi:[1,0]
v_pk_mul_f32 v[24:25], v[24:25], v[66:67] op_sel_hi:[1,0]
v_pk_mul_f32 v[26:27], v[26:27], v[66:67] op_sel_hi:[1,0]
v_pk_mul_f32 v[28:29], v[28:29], v[66:67] op_sel_hi:[1,0]
v_pk_mul_f32 v[30:31], v[30:31], v[66:67] op_sel_hi:[1,0]
v_cvt_pk_bf16_f32 v72, v16, v17
v_cvt_pk_bf16_f32 v73, v18, v19
v_cvt_pk_bf16_f32 v74, v24, v25
v_cvt_pk_bf16_f32 v75, v26, v27
s_nop 0
v_permlane16_swap_b32 v72, v74
v_permlane16_swap_b32 v73, v75
buffer_store_dwordx4 v[72:75], v12, s[48:51], s70 offen offset:0 sc1
v_cvt_pk_bf16_f32 v76, v20, v21
v_cvt_pk_bf16_f32 v77, v22, v23
v_cvt_pk_bf16_f32 v78, v28, v29
v_cvt_pk_bf16_f32 v79, v30, v31
s_nop 0
v_permlane16_swap_b32 v76, v78
v_permlane16_swap_b32 v77, v79
buffer_store_dwordx4 v[76:79], v12, s[48:51], s70 offen offset:1024 sc1
s_sub_u32 s7, s3, 4
s_and_b32 s4, s30, 3
s_lshr_b32 s5, s30, 2
s_mul_i32 s4, s4, 4
s_mul_i32 s5, s5, 8
s_and_b32 s64, s31, 3
s_add_u32 s4, s4, s64
s_lshr_b32 s64, s31, 2
s_add_u32 s5, s5, s64
s_add_u32 s32, s8, 0x800000
s_addc_u32 s33, s9, 0
s_mov_b32 s34, 0x400000
s_mov_b32 s35, 0x20000
s_mov_b32 s36, s16
s_mov_b32 s37, s17
s_mov_b32 s38, 0x200000
s_mov_b32 s39, 0x20000
s_mov_b32 s40, s10
s_mov_b32 s41, s11
s_mov_b32 s42, 0x400000
s_mov_b32 s43, 0x20000
v_lshlrev_b32 v2, 4, v1
s_lshl_b32 s60, s4, 2
s_lshl_b32 s64, s7, 1
s_add_u32 s60, s60, s64
s_mul_i32 s60, s60, 65536
v_lshrrev_b32 v10, 5, v1
v_lshlrev_b32 v10, 2, v10
v_bfe_u32 v11, v1, 2, 2
v_add_u32 v10, v10, v11
v_mul_u32_u24 v10, 2048, v10
v_bfe_u32 v11, v1, 4, 1
v_lshl_add_u32 v10, v11, 6, v10
v_and_b32 v11, 3, v1
v_lshl_add_u32 v4, v11, 4, v10
v_xor_b32 v11, 2, v11
v_lshl_add_u32 v5, v11, 4, v10
s_mul_i32 s61, s7, 65536
s_mul_i32 s64, s5, 128
s_add_u32 s61, s61, s64
s_mul_i32 s63, s7, 4096
s_add_u32 s63, s63, 16384
s_lshl_b32 s62, s7, 13
s_mov_b32 s68, 24576
s_mov_b32 s69, 0xfffe8000
v_lshrrev_b32 v10, 3, v1
v_lshlrev_b32 v10, 11, v10
v_and_b32 v11, 7, v1
v_lshrrev_b32 v12, 4, v1
v_xor_b32 v13, v11, v12
v_lshl_add_u32 v20, v13, 4, v10
v_xor_b32 v13, 4, v13
v_lshl_add_u32 v21, v13, 4, v10
s_lshl_b32 s70, s4, 7
s_lshl_b32 s71, s7, 6
s_add_u32 s70, s70, s71
s_lshl_b32 s70, s70, 11
s_lshl_b32 s71, s5, 7
s_add_u32 s70, s70, s71
s_lshl_b32 s71, s7, 13
s_add_u32 s71, s71, 139264
s_add_u32 m0, s71, 0
s_add_u32 s64, s70, 0
buffer_load_dwordx4 v20, s[40:43], s64 offen lds
s_add_u32 m0, s71, 1024
s_add_u32 s64, s70, 16384
buffer_load_dwordx4 v21, s[40:43], s64 offen lds
s_add_u32 m0, s71, 2048
s_add_u32 s64, s70, 32768
buffer_load_dwordx4 v20, s[40:43], s64 offen lds
s_add_u32 m0, s71, 3072
s_add_u32 s64, s70, 49152
buffer_load_dwordx4 v21, s[40:43], s64 offen lds
s_add_u32 m0, s71, 4096
s_add_u32 s64, s70, 65536
buffer_load_dwordx4 v20, s[40:43], s64 offen lds
s_add_u32 m0, s71, 5120
s_add_u32 s64, s70, 81920
buffer_load_dwordx4 v21, s[40:43], s64 offen lds
s_add_u32 m0, s71, 6144
s_add_u32 s64, s70, 98304
buffer_load_dwordx4 v20, s[40:43], s64 offen lds
s_add_u32 m0, s71, 7168
s_add_u32 s64, s70, 114688
buffer_load_dwordx4 v21, s[40:43], s64 offen lds
s_barrier
s_waitcnt vmcnt(8)
v_mov_b32 v8, 163796
v_mov_b32 v9, 1
s_mov_b64 exec, 1
ds_add_rtn_u32 v9, v8, v9
s_waitcnt lgkmcnt(0)
s_nop 1
v_readfirstlane_b32 s72, v9
s_mov_b64 exec, -1
s_nop 2
s_cmp_lg_u32 s72, 7
s_cbranch_scc1 pub1
s_add_u32 s56, s8, 0x1200000
s_addc_u32 s57, s9, 0
s_mov_b32 s58, 0x8000
s_mov_b32 s59, 0x20000
s_mov_b32 s71, s88
v_mov_b32 v8, s28
v_mov_b32 v9, s29
v_mov_b32 v10, 4096
s_mov_b64 exec, 1
buffer_store_dwordx2 v[8:9], v10, s[56:59], s71 offen sc1
s_mov_b64 exec, -1
pub1:
s_add_u32 m0, s63, 0
s_add_u32 s64, s61, 0
buffer_load_dwordx4 v4, s[36:39], s64 offen lds
s_add_u32 m0, s63, 1024
s_add_u32 s64, s61, 16384
buffer_load_dwordx4 v5, s[36:39], s64 offen lds
s_add_u32 m0, s63, 2048
s_add_u32 s64, s61, 32768
buffer_load_dwordx4 v4, s[36:39], s64 offen lds
s_add_u32 m0, s63, 3072
s_add_u32 s64, s61, 49152
buffer_load_dwordx4 v5, s[36:39], s64 offen lds
s_add_u32 s61, s61, 131072
s_add_u32 m0, s63, 24576
s_add_u32 s64, s61, 0
buffer_load_dwordx4 v4, s[36:39], s64 offen lds
s_add_u32 m0, s63, 25600
s_add_u32 s64, s61, 16384
buffer_load_dwordx4 v5, s[36:39], s64 offen lds
s_add_u32 m0, s63, 26624
s_add_u32 s64, s61, 32768
buffer_load_dwordx4 v4, s[36:39], s64 offen lds
s_add_u32 m0, s63, 27648
s_add_u32 s64, s61, 49152
buffer_load_dwordx4 v5, s[36:39], s64 offen lds
s_add_u32 s61, s61, 131072
s_add_u32 m0, s63, 49152
s_add_u32 s64, s61, 0
buffer_load_dwordx4 v4, s[36:39], s64 offen lds
s_add_u32 m0, s63, 50176
s_add_u32 s64, s61, 16384
buffer_load_dwordx4 v5, s[36:39], s64 offen lds
s_add_u32 m0, s63, 51200
s_add_u32 s64, s61, 32768
buffer_load_dwordx4 v4, s[36:39], s64 offen lds
s_add_u32 m0, s63, 52224
s_add_u32 s64, s61, 49152
buffer_load_dwordx4 v5, s[36:39], s64 offen lds
s_add_u32 s61, s61, 131072
s_add_u32 m0, s63, 73728
s_add_u32 s64, s61, 0
buffer_load_dwordx4 v4, s[36:39], s64 offen lds
s_add_u32 m0, s63, 74752
s_add_u32 s64, s61, 16384
buffer_load_dwordx4 v5, s[36:39], s64 offen lds
s_add_u32 m0, s63, 75776
s_add_u32 s64, s61, 32768
buffer_load_dwordx4 v4, s[36:39], s64 offen lds
s_add_u32 m0, s63, 76800
s_add_u32 s64, s61, 49152
buffer_load_dwordx4 v5, s[36:39], s64 offen lds
s_add_u32 s61, s61, 131072
s_add_u32 m0, s63, 98304
s_add_u32 s64, s61, 0
buffer_load_dwordx4 v4, s[36:39], s64 offen lds
s_add_u32 m0, s63, 99328
s_add_u32 s64, s61, 16384
buffer_load_dwordx4 v5, s[36:39], s64 offen lds
s_add_u32 m0, s63, 100352
s_add_u32 s64, s61, 32768
buffer_load_dwordx4 v4, s[36:39], s64 offen lds
s_add_u32 m0, s63, 101376
s_add_u32 s64, s61, 49152
buffer_load_dwordx4 v5, s[36:39], s64 offen lds
s_add_u32 s61, s61, 131072
s_barrier
s_add_u32 m0, s62, 0
s_add_u32 s64, s60, 65536
buffer_load_dwordx4 v2, s[32:35], s60 offen offset:0 sc1 lds
buffer_load_dwordx4 v2, s[32:35], s60 offen offset:1024 sc1 lds
buffer_load_dwordx4 v2, s[32:35], s60 offen offset:2048 sc1 lds
buffer_load_dwordx4 v2, s[32:35], s60 offen offset:3072 sc1 lds
s_add_u32 m0, s62, 4096
s_add_u32 s60, s60, 4096
buffer_load_dwordx4 v2, s[32:35], s64 offen offset:0 sc1 lds
buffer_load_dwordx4 v2, s[32:35], s64 offen offset:1024 sc1 lds
buffer_load_dwordx4 v2, s[32:35], s64 offen offset:2048 sc1 lds
buffer_load_dwordx4 v2, s[32:35], s64 offen offset:3072 sc1 lds
s_add_u32 m0, s62, 24576
s_add_u32 s64, s60, 65536
buffer_load_dwordx4 v2, s[32:35], s60 offen offset:0 sc1 lds
buffer_load_dwordx4 v2, s[32:35], s60 offen offset:1024 sc1 lds
buffer_load_dwordx4 v2, s[32:35], s60 offen offset:2048 sc1 lds
buffer_load_dwordx4 v2, s[32:35], s60 offen offset:3072 sc1 lds
s_add_u32 m0, s62, 28672
s_add_u32 s60, s60, 4096
buffer_load_dwordx4 v2, s[32:35], s64 offen offset:0 sc1 lds
buffer_load_dwordx4 v2, s[32:35], s64 offen offset:1024 sc1 lds
buffer_load_dwordx4 v2, s[32:35], s64 offen offset:2048 sc1 lds
buffer_load_dwordx4 v2, s[32:35], s64 offen offset:3072 sc1 lds
s_waitcnt vmcnt(8)
s_barrier
s_add_u32 m0, s62, 49152
s_add_u32 s64, s60, 65536
buffer_load_dwordx4 v2, s[32:35], s60 offen offset:0 sc1 lds
buffer_load_dwordx4 v2, s[32:35], s60 offen offset:1024 sc1 lds
buffer_load_dwordx4 v2, s[32:35], s60 offen offset:2048 sc1 lds
buffer_load_dwordx4 v2, s[32:35], s60 offen offset:3072 sc1 lds
s_add_u32 m0, s62, 53248
s_add_u32 s60, s60, 4096
buffer_load_dwordx4 v2, s[32:35], s64 offen offset:0 sc1 lds
buffer_load_dwordx4 v2, s[32:35], s64 offen offset:1024 sc1 lds
buffer_load_dwordx4 v2, s[32:35], s64 offen offset:2048 sc1 lds
buffer_load_dwordx4 v2, s[32:35], s64 offen offset:3072 sc1 lds
s_add_u32 m0, s62, 73728
s_add_u32 s64, s60, 65536
buffer_load_dwordx4 v2, s[32:35], s60 offen offset:0 sc1 lds
buffer_load_dwordx4 v2, s[32:35], s60 offen offset:1024 sc1 lds
buffer_load_dwordx4 v2, s[32:35], s60 offen offset:2048 sc1 lds
buffer_load_dwordx4 v2, s[32:35], s60 offen offset:3072 sc1 lds
s_add_u32 m0, s62, 77824
s_add_u32 s60, s60, 4096
buffer_load_dwordx4 v2, s[32:35], s64 offen offset:0 sc1 lds
buffer_load_dwordx4 v2, s[32:35], s64 offen offset:1024 sc1 lds
buffer_load_dwordx4 v2, s[32:35], s64 offen offset:2048 sc1 lds
buffer_load_dwordx4 v2, s[32:35], s64 offen offset:3072 sc1 lds
s_add_u32 m0, s62, 98304
s_add_u32 s64, s60, 65536
buffer_load_dwordx4 v2, s[32:35], s60 offen offset:0 sc1 lds
buffer_load_dwordx4 v2, s[32:35], s60 offen offset:1024 sc1 lds
buffer_load_dwordx4 v2, s[32:35], s60 offen offset:2048 sc1 lds
buffer_load_dwordx4 v2, s[32:35], s60 offen offset:3072 sc1 lds
s_add_u32 m0, s62, 102400
s_add_u32 s60, s60, 4096
buffer_load_dwordx4 v2, s[32:35], s64 offen offset:0 sc1 lds
buffer_load_dwordx4 v2, s[32:35], s64 offen offset:1024 sc1 lds
buffer_load_dwordx4 v2, s[32:35], s64 offen offset:2048 sc1 lds
buffer_load_dwordx4 v2, s[32:35], s64 offen offset:3072 sc1 lds
s_mov_b32 s67, 0
s_waitcnt vmcnt(24)
s_barrier
s_add_u32 m0, s62, 0
s_add_u32 s64, s60, 65536
buffer_load_dwordx4 v2, s[32:35], s60 offen offset:0 sc1 lds
buffer_load_dwordx4 v2, s[32:35], s60 offen offset:1024 sc1 lds
buffer_load_dwordx4 v2, s[32:35], s60 offen offset:2048 sc1 lds
buffer_load_dwordx4 v2, s[32:35], s60 offen offset:3072 sc1 lds
s_add_u32 m0, s62, 4096
s_add_u32 s60, s60, 4096
buffer_load_dwordx4 v2, s[32:35], s64 offen offset:0 sc1 lds
buffer_load_dwordx4 v2, s[32:35], s64 offen offset:1024 sc1 lds
buffer_load_dwordx4 v2, s[32:35], s64 offen offset:2048 sc1 lds
buffer_load_dwordx4 v2, s[32:35], s64 offen offset:3072 sc1 lds
s_add_u32 m0, s63, 0
s_add_u32 s64, s61, 0
buffer_load_dwordx4 v4, s[36:39], s64 offen lds
s_add_u32 m0, s63, 1024
s_add_u32 s64, s61, 16384
buffer_load_dwordx4 v5, s[36:39], s64 offen lds
s_add_u32 m0, s63, 2048
s_add_u32 s64, s61, 32768
buffer_load_dwordx4 v4, s[36:39], s64 offen lds
s_add_u32 m0, s63, 3072
s_add_u32 s64, s61, 49152
buffer_load_dwordx4 v5, s[36:39], s64 offen lds
s_add_u32 s61, s61, 131072
s_add_u32 s67, s67, 1
s_cmp_eq_u32 s67, 5
s_cselect_b32 s66, s69, s68
s_cselect_b32 s67, 0, s67
s_add_u32 s62, s62, s66
s_add_u32 s63, s63, s66
s_waitcnt vmcnt(28)
s_barrier
s_add_u32 m0, s62, 0
s_add_u32 s64, s60, 65536
buffer_load_dwordx4 v2, s[32:35], s60 offen offset:0 sc1 lds
buffer_load_dwordx4 v2, s[32:35], s60 offen offset:1024 sc1 lds
buffer_load_dwordx4 v2, s[32:35], s60 offen offset:2048 sc1 lds
buffer_load_dwordx4 v2, s[32:35], s60 offen offset:3072 sc1 lds
s_add_u32 m0, s62, 4096
s_add_u32 s60, s60, 4096
buffer_load_dwordx4 v2, s[32:35], s64 offen offset:0 sc1 lds
buffer_load_dwordx4 v2, s[32:35], s64 offen offset:1024 sc1 lds
buffer_load_dwordx4 v2, s[32:35], s64 offen offset:2048 sc1 lds
buffer_load_dwordx4 v2, s[32:35], s64 offen offset:3072 sc1 lds
s_add_u32 m0, s63, 0
s_add_u32 s64, s61, 0
buffer_load_dwordx4 v4, s[36:39], s64 offen lds
s_add_u32 m0, s63, 1024
s_add_u32 s64, s61, 16384
buffer_load_dwordx4 v5, s[36:39], s64 offen lds
s_add_u32 m0, s63, 2048
s_add_u32 s64, s61, 32768
buffer_load_dwordx4 v4, s[36:39], s64 offen lds
s_add_u32 m0, s63, 3072
s_add_u32 s64, s61, 49152
buffer_load_dwordx4 v5, s[36:39], s64 offen lds
s_add_u32 s61, s61, 131072
s_add_u32 s67, s67, 1
s_cmp_eq_u32 s67, 5
s_cselect_b32 s66, s69, s68
s_cselect_b32 s67, 0, s67
s_add_u32 s62, s62, s66
s_add_u32 s63, s63, s66
s_waitcnt vmcnt(32)
s_barrier
s_add_u32 m0, s62, 0
s_add_u32 s64, s60, 65536
buffer_load_dwordx4 v2, s[32:35], s60 offen offset:0 sc1 lds
buffer_load_dwordx4 v2, s[32:35], s60 offen offset:1024 sc1 lds
buffer_load_dwordx4 v2, s[32:35], s60 offen offset:2048 sc1 lds
buffer_load_dwordx4 v2, s[32:35], s60 offen offset:3072 sc1 lds
s_add_u32 m0, s62, 4096
s_add_u32 s60, s60, 4096
buffer_load_dwordx4 v2, s[32:35], s64 offen offset:0 sc1 lds
buffer_load_dwordx4 v2, s[32:35], s64 offen offset:1024 sc1 lds
buffer_load_dwordx4 v2, s[32:35], s64 offen offset:2048 sc1 lds
buffer_load_dwordx4 v2, s[32:35], s64 offen offset:3072 sc1 lds
s_add_u32 m0, s63, 0
s_add_u32 s64, s61, 0
buffer_load_dwordx4 v4, s[36:39], s64 offen lds
s_add_u32 m0, s63, 1024
s_add_u32 s64, s61, 16384
buffer_load_dwordx4 v5, s[36:39], s64 offen lds
s_add_u32 m0, s63, 2048
s_add_u32 s64, s61, 32768
buffer_load_dwordx4 v4, s[36:39], s64 offen lds
s_add_u32 m0, s63, 3072
s_add_u32 s64, s61, 49152
buffer_load_dwordx4 v5, s[36:39], s64 offen lds
s_add_u32 s61, s61, 131072
s_add_u32 s67, s67, 1
s_cmp_eq_u32 s67, 5
s_cselect_b32 s66, s69, s68
s_cselect_b32 s67, 0, s67
s_add_u32 s62, s62, s66
s_add_u32 s63, s63, s66
s_mov_b32 s65, 3
p3_ld_loop:
s_waitcnt vmcnt(36)
s_barrier
s_add_u32 m0, s62, 0
s_add_u32 s64, s60, 65536
buffer_load_dwordx4 v2, s[32:35], s60 offen offset:0 sc1 lds
buffer_load_dwordx4 v2, s[32:35], s60 offen offset:1024 sc1 lds
buffer_load_dwordx4 v2, s[32:35], s60 offen offset:2048 sc1 lds
buffer_load_dwordx4 v2, s[32:35], s60 offen offset:3072 sc1 lds
s_add_u32 m0, s62, 4096
s_add_u32 s60, s60, 4096
buffer_load_dwordx4 v2, s[32:35], s64 offen offset:0 sc1 lds
buffer_load_dwordx4 v2, s[32:35], s64 offen offset:1024 sc1 lds
buffer_load_dwordx4 v2, s[32:35], s64 offen offset:2048 sc1 lds
buffer_load_dwordx4 v2, s[32:35], s64 offen offset:3072 sc1 lds
s_add_u32 m0, s63, 0
s_add_u32 s64, s61, 0
buffer_load_dwordx4 v4, s[36:39], s64 offen lds
s_add_u32 m0, s63, 1024
s_add_u32 s64, s61, 16384
buffer_load_dwordx4 v5, s[36:39], s64 offen lds
s_add_u32 m0, s63, 2048
s_add_u32 s64, s61, 32768
buffer_load_dwordx4 v4, s[36:39], s64 offen lds
s_add_u32 m0, s63, 3072
s_add_u32 s64, s61, 49152
buffer_load_dwordx4 v5, s[36:39], s64 offen lds
s_add_u32 s61, s61, 131072
s_add_u32 s67, s67, 1
s_cmp_eq_u32 s67, 5
s_cselect_b32 s66, s69, s68
s_cselect_b32 s67, 0, s67
s_add_u32 s62, s62, s66
s_add_u32 s63, s63, s66
s_add_u32 s65, s65, 1
s_cmp_lt_u32 s65, 11
s_cbranch_scc1 p3_ld_loop
s_add_u32 s76, s18, 3670016
s_addc_u32 s77, s19, 0
s_lshl_b32 s70, s2, 1
s_add_u32 s70, s70, s7
s_lshl_b32 s70, s70, 13
v_lshlrev_b32 v16, 7, v1
s_mov_b32 s44, s76
s_mov_b32 s45, s77
s_mov_b32 s46, 0x380000
s_mov_b32 s47, 0x20000
s_mov_b32 s71, s70
buffer_load_dword v200, v16, s[44:47], s71 offen
s_mov_b32 s44, s22
s_mov_b32 s45, s23
s_mov_b32 s46, 0x380000
s_mov_b32 s47, 0x20000
s_mov_b32 s71, s70
buffer_load_dword v201, v16, s[44:47], s71 offen
s_waitcnt vmcnt(38)
s_barrier
s_waitcnt vmcnt(26)
s_barrier
s_waitcnt vmcnt(14)
s_barrier
s_waitcnt vmcnt(2)
s_barrier
s_barrier
s_and_b32 s4, s30, 1
s_lshr_b32 s5, s30, 1
s_mul_i32 s4, s4, 8
s_mul_i32 s5, s5, 4
s_and_b32 s64, s31, 7
s_add_u32 s4, s4, s64
s_lshr_b32 s64, s31, 3
s_add_u32 s5, s5, s64
s_add_u32 s32, s8, 0xc00000
s_addc_u32 s33, s9, 0
s_mov_b32 s34, 0x400000
s_mov_b32 s35, 0x20000
s_mov_b32 s36, s18
s_mov_b32 s37, s19
s_mov_b32 s38, 0x700000
s_mov_b32 s39, 0x20000
v_lshlrev_b32 v2, 4, v1
s_lshl_b32 s60, s4, 2
s_lshl_b32 s64, s7, 1
s_add_u32 s60, s60, s64
s_mul_i32 s60, s60, 65536
v_lshrrev_b32 v12, 4, v1
v_bfe_u32 v13, v1, 2, 2
v_and_b32 v14, 3, v1
v_add_u32 v15, 0, v12
v_mul_u32_u24 v16, 37, v15
v_lshrrev_b32 v16, 8, v16
v_mul_u32_u24 v17, 7, v16
v_sub_u32 v17, v15, v17
v_and_b32 v18, 2, v16
v_xor_b32 v18, v18, v14
v_lshl_add_u32 v16, v16, 2, v13
v_mul_u32_u24 v16, 7168, v16
v_lshl_add_u32 v16, v17, 6, v16
v_lshl_add_u32 v4, v18, 4, v16
v_add_u32 v15, 4, v12
v_mul_u32_u24 v16, 37, v15
v_lshrrev_b32 v16, 8, v16
v_mul_u32_u24 v17, 7, v16
v_sub_u32 v17, v15, v17
v_and_b32 v18, 2, v16
v_xor_b32 v18, v18, v14
v_lshl_add_u32 v16, v16, 2, v13
v_mul_u32_u24 v16, 7168, v16
v_lshl_add_u32 v16, v17, 6, v16
v_lshl_add_u32 v5, v18, 4, v16
v_add_u32 v15, 8, v12
v_mul_u32_u24 v16, 37, v15
v_lshrrev_b32 v16, 8, v16
v_mul_u32_u24 v17, 7, v16
v_sub_u32 v17, v15, v17
v_and_b32 v18, 2, v16
v_xor_b32 v18, v18, v14
v_lshl_add_u32 v16, v16, 2, v13
v_mul_u32_u24 v16, 7168, v16
v_lshl_add_u32 v16, v17, 6, v16
v_lshl_add_u32 v6, v18, 4, v16
v_add_u32 v15, 12, v12
v_mul_u32_u24 v16, 37, v15
v_lshrrev_b32 v16, 8, v16
v_mul_u32_u24 v17, 7, v16
v_sub_u32 v17, v15, v17
v_and_b32 v18, 2, v16
v_xor_b32 v18, v18, v14
v_lshl_add_u32 v16, v16, 2, v13
v_mul_u32_u24 v16, 7168, v16
v_lshl_add_u32 v16, v17, 6, v16
v_lshl_add_u32 v7, v18, 4, v16
v_add_u32 v15, 16, v12
v_mul_u32_u24 v16, 37, v15
v_lshrrev_b32 v16, 8, v16
v_mul_u32_u24 v17, 7, v16
v_sub_u32 v17, v15, v17
v_and_b32 v18, 2, v16
v_xor_b32 v18, v18, v14
v_lshl_add_u32 v16, v16, 2, v13
v_mul_u32_u24 v16, 7168, v16
v_lshl_add_u32 v16, v17, 6, v16
v_lshl_add_u32 v8, v18, 4, v16
v_add_u32 v15, 20, v12
v_mul_u32_u24 v16, 37, v15
v_lshrrev_b32 v16, 8, v16
v_mul_u32_u24 v17, 7, v16
v_sub_u32 v17, v15, v17
v_and_b32 v18, 2, v16
v_xor_b32 v18, v18, v14
v_lshl_add_u32 v16, v16, 2, v13
v_mul_u32_u24 v16, 7168, v16
v_lshl_add_u32 v16, v17, 6, v16
v_lshl_add_u32 v9, v18, 4, v16
v_add_u32 v15, 24, v12
v_mul_u32_u24 v16, 37, v15
v_lshrrev_b32 v16, 8, v16
v_mul_u32_u24 v17, 7, v16
v_sub_u32 v17, v15, v17
v_and_b32 v18, 2, v16
v_xor_b32 v18, v18, v14
v_lshl_add_u32 v16, v16, 2, v13
v_mul_u32_u24 v16, 7168, v16
v_lshl_add_u32 v16, v17, 6, v16
v_lshl_add_u32 v10, v18, 4, v16
s_mul_i32 s61, s7, 229376
s_mul_i32 s64, s5, 448
s_add_u32 s61, s61, s64
s_mul_i32 s63, s7, 14336
s_add_u32 s63, s63, 16384
s_lshl_b32 s62, s7, 13
s_mov_b32 s68, 45056
s_mov_b32 s69, 0xfffea000
s_mov_b32 s86, s4
s_mul_i32 s64, s86, 4096
s_add_u32 s92, s60, s64
s_mul_i32 s64, s86, 458752
s_add_u32 s93, s61, s64
s_mov_b32 s90, 0
s_mov_b32 s91, 0
s_barrier
s_mov_b32 s89, s61
s_mov_b32 s61, s93
s_add_u32 m0, s63, 0
s_nop 0
buffer_load_dwordx4 v4, s[36:39], s61 offen lds
s_add_u32 m0, s63, 1024
s_nop 0
buffer_load_dwordx4 v5, s[36:39], s61 offen lds
s_add_u32 m0, s63, 2048
s_nop 0
buffer_load_dwordx4 v6, s[36:39], s61 offen lds
s_add_u32 m0, s63, 3072
s_nop 0
buffer_load_dwordx4 v7, s[36:39], s61 offen lds
s_add_u32 m0, s63, 4096
s_nop 0
buffer_load_dwordx4 v8, s[36:39], s61 offen lds
s_add_u32 m0, s63, 5120
s_nop 0
buffer_load_dwordx4 v9, s[36:39], s61 offen lds
s_add_u32 m0, s63, 6144
s_nop 0
buffer_load_dwordx4 v10, s[36:39], s61 offen lds
s_add_u32 s64, s61, 114688
s_add_u32 m0, s63, 7168
s_nop 0
buffer_load_dwordx4 v4, s[36:39], s64 offen lds
s_add_u32 m0, s63, 8192
s_nop 0
buffer_load_dwordx4 v5, s[36:39], s64 offen lds
s_add_u32 m0, s63, 9216
s_nop 0
buffer_load_dwordx4 v6, s[36:39], s64 offen lds
s_add_u32 m0, s63, 10240
s_nop 0
buffer_load_dwordx4 v7, s[36:39], s64 offen lds
s_add_u32 m0, s63, 11264
s_nop 0
buffer_load_dwordx4 v8, s[36:39], s64 offen lds
s_add_u32 m0, s63, 12288
s_nop 0
buffer_load_dwordx4 v9, s[36:39], s64 offen lds
s_add_u32 m0, s63, 13312
s_nop 0
buffer_load_dwordx4 v10, s[36:39], s64 offen lds
s_add_u32 s61, s61, 458752
s_mov_b32 s61, s89
s_cmp_eq_u32 s91, s86
s_cselect_b32 s64, 458752, 0
s_add_u32 s61, s61, s64
s_add_u32 s91, s91, 1
s_add_u32 m0, s63, 45056
s_nop 0
buffer_load_dwordx4 v4, s[36:39], s61 offen lds
s_add_u32 m0, s63, 46080
s_nop 0
buffer_load_dwordx4 v5, s[36:39], s61 offen lds
s_add_u32 m0, s63, 47104
s_nop 0
buffer_load_dwordx4 v6, s[36:39], s61 offen lds
s_add_u32 m0, s63, 48128
s_nop 0
buffer_load_dwordx4 v7, s[36:39], s61 offen lds
s_add_u32 m0, s63, 49152
s_nop 0
buffer_load_dwordx4 v8, s[36:39], s61 offen lds
s_add_u32 m0, s63, 50176
s_nop 0
buffer_load_dwordx4 v9, s[36:39], s61 offen lds
s_add_u32 m0, s63, 51200
s_nop 0
buffer_load_dwordx4 v10, s[36:39], s61 offen lds
s_add_u32 s64, s61, 114688
s_add_u32 m0, s63, 52224
s_nop 0
buffer_load_dwordx4 v4, s[36:39], s64 offen lds
s_add_u32 m0, s63, 53248
s_nop 0
buffer_load_dwordx4 v5, s[36:39], s64 offen lds
s_add_u32 m0, s63, 54272
s_nop 0
buffer_load_dwordx4 v6, s[36:39], s64 offen lds
s_add_u32 m0, s63, 55296
s_nop 0
buffer_load_dwordx4 v7, s[36:39], s64 offen lds
s_add_u32 m0, s63, 56320
s_nop 0
buffer_load_dwordx4 v8, s[36:39], s64 offen lds
s_add_u32 m0, s63, 57344
s_nop 0
buffer_load_dwordx4 v9, s[36:39], s64 offen lds
s_add_u32 m0, s63, 58368
s_nop 0
buffer_load_dwordx4 v10, s[36:39], s64 offen lds
s_add_u32 s61, s61, 458752
s_cmp_eq_u32 s91, s86
s_cselect_b32 s64, 458752, 0
s_add_u32 s61, s61, s64
s_add_u32 s91, s91, 1
s_add_u32 m0, s63, 90112
s_nop 0
buffer_load_dwordx4 v4, s[36:39], s61 offen lds
s_add_u32 m0, s63, 91136
s_nop 0
buffer_load_dwordx4 v5, s[36:39], s61 offen lds
s_add_u32 m0, s63, 92160
s_nop 0
buffer_load_dwordx4 v6, s[36:39], s61 offen lds
s_add_u32 m0, s63, 93184
s_nop 0
buffer_load_dwordx4 v7, s[36:39], s61 offen lds
s_add_u32 m0, s63, 94208
s_nop 0
buffer_load_dwordx4 v8, s[36:39], s61 offen lds
s_add_u32 m0, s63, 95232
s_nop 0
buffer_load_dwordx4 v9, s[36:39], s61 offen lds
s_add_u32 m0, s63, 96256
s_nop 0
buffer_load_dwordx4 v10, s[36:39], s61 offen lds
s_add_u32 s64, s61, 114688
s_add_u32 m0, s63, 97280
s_nop 0
buffer_load_dwordx4 v4, s[36:39], s64 offen lds
s_add_u32 m0, s63, 98304
s_nop 0
buffer_load_dwordx4 v5, s[36:39], s64 offen lds
s_add_u32 m0, s63, 99328
s_nop 0
buffer_load_dwordx4 v6, s[36:39], s64 offen lds
s_add_u32 m0, s63, 100352
s_nop 0
buffer_load_dwordx4 v7, s[36:39], s64 offen lds
s_add_u32 m0, s63, 101376
s_nop 0
buffer_load_dwordx4 v8, s[36:39], s64 offen lds
s_add_u32 m0, s63, 102400
s_nop 0
buffer_load_dwordx4 v9, s[36:39], s64 offen lds
s_add_u32 m0, s63, 103424
s_nop 0
buffer_load_dwordx4 v10, s[36:39], s64 offen lds
s_add_u32 s61, s61, 458752
s_barrier
s_mov_b32 s89, s60
s_mov_b32 s60, s92
s_add_u32 m0, s62, 0
s_add_u32 s64, s60, 65536
buffer_load_dwordx4 v2, s[32:35], s60 offen offset:0 sc1 lds
buffer_load_dwordx4 v2, s[32:35], s60 offen offset:1024 sc1 lds
buffer_load_dwordx4 v2, s[32:35], s60 offen offset:2048 sc1 lds
buffer_load_dwordx4 v2, s[32:35], s60 offen offset:3072 sc1 lds
s_add_u32 m0, s62, 4096
s_add_u32 s60, s60, 4096
buffer_load_dwordx4 v2, s[32:35], s64 offen offset:0 sc1 lds
buffer_load_dwordx4 v2, s[32:35], s64 offen offset:1024 sc1 lds
buffer_load_dwordx4 v2, s[32:35], s64 offen offset:2048 sc1 lds
buffer_load_dwordx4 v2, s[32:35], s64 offen offset:3072 sc1 lds
s_mov_b32 s60, s89
s_cmp_eq_u32 s90, s86
s_cselect_b32 s64, 4096, 0
s_add_u32 s60, s60, s64
s_add_u32 s90, s90, 1
s_add_u32 m0, s62, 45056
s_add_u32 s64, s60, 65536
buffer_load_dwordx4 v2, s[32:35], s60 offen offset:0 sc1 lds
buffer_load_dwordx4 v2, s[32:35], s60 offen offset:1024 sc1 lds
buffer_load_dwordx4 v2, s[32:35], s60 offen offset:2048 sc1 lds
buffer_load_dwordx4 v2, s[32:35], s60 offen offset:3072 sc1 lds
s_add_u32 m0, s62, 49152
s_add_u32 s60, s60, 4096
buffer_load_dwordx4 v2, s[32:35], s64 offen offset:0 sc1 lds
buffer_load_dwordx4 v2, s[32:35], s64 offen offset:1024 sc1 lds
buffer_load_dwordx4 v2, s[32:35], s64 offen offset:2048 sc1 lds
buffer_load_dwordx4 v2, s[32:35], s64 offen offset:3072 sc1 lds
s_waitcnt vmcnt(8)
s_barrier
s_cmp_eq_u32 s90, s86
s_cselect_b32 s64, 4096, 0
s_add_u32 s60, s60, s64
s_add_u32 s90, s90, 1
s_add_u32 m0, s62, 90112
s_add_u32 s64, s60, 65536
buffer_load_dwordx4 v2, s[32:35], s60 offen offset:0 sc1 lds
buffer_load_dwordx4 v2, s[32:35], s60 offen offset:1024 sc1 lds
buffer_load_dwordx4 v2, s[32:35], s60 offen offset:2048 sc1 lds
buffer_load_dwordx4 v2, s[32:35], s60 offen offset:3072 sc1 lds
s_add_u32 m0, s62, 94208
s_add_u32 s60, s60, 4096
buffer_load_dwordx4 v2, s[32:35], s64 offen offset:0 sc1 lds
buffer_load_dwordx4 v2, s[32:35], s64 offen offset:1024 sc1 lds
buffer_load_dwordx4 v2, s[32:35], s64 offen offset:2048 sc1 lds
buffer_load_dwordx4 v2, s[32:35], s64 offen offset:3072 sc1 lds
s_mov_b32 s67, 0
s_waitcnt vmcnt(8)
s_barrier
s_cmp_eq_u32 s90, s86
s_cselect_b32 s64, 4096, 0
s_add_u32 s60, s60, s64
s_add_u32 s90, s90, 1
s_add_u32 m0, s62, 0
s_add_u32 s64, s60, 65536
buffer_load_dwordx4 v2, s[32:35], s60 offen offset:0 sc1 lds
buffer_load_dwordx4 v2, s[32:35], s60 offen offset:1024 sc1 lds
buffer_load_dwordx4 v2, s[32:35], s60 offen offset:2048 sc1 lds
buffer_load_dwordx4 v2, s[32:35], s60 offen offset:3072 sc1 lds
s_add_u32 m0, s62, 4096
s_add_u32 s60, s60, 4096
buffer_load_dwordx4 v2, s[32:35], s64 offen offset:0 sc1 lds
buffer_load_dwordx4 v2, s[32:35], s64 offen offset:1024 sc1 lds
buffer_load_dwordx4 v2, s[32:35], s64 offen offset:2048 sc1 lds
buffer_load_dwordx4 v2, s[32:35], s64 offen offset:3072 sc1 lds
s_cmp_eq_u32 s91, s86
s_cselect_b32 s64, 458752, 0
s_add_u32 s61, s61, s64
s_add_u32 s91, s91, 1
s_add_u32 m0, s63, 0
s_nop 0
buffer_load_dwordx4 v4, s[36:39], s61 offen lds
s_add_u32 m0, s63, 1024
s_nop 0
buffer_load_dwordx4 v5, s[36:39], s61 offen lds
s_add_u32 m0, s63, 2048
s_nop 0
buffer_load_dwordx4 v6, s[36:39], s61 offen lds
s_add_u32 m0, s63, 3072
s_nop 0
buffer_load_dwordx4 v7, s[36:39], s61 offen lds
s_add_u32 m0, s63, 4096
s_nop 0
buffer_load_dwordx4 v8, s[36:39], s61 offen lds
s_add_u32 m0, s63, 5120
s_nop 0
buffer_load_dwordx4 v9, s[36:39], s61 offen lds
s_add_u32 m0, s63, 6144
s_nop 0
buffer_load_dwordx4 v10, s[36:39], s61 offen lds
s_add_u32 s64, s61, 114688
s_add_u32 m0, s63, 7168
s_nop 0
buffer_load_dwordx4 v4, s[36:39], s64 offen lds
s_add_u32 m0, s63, 8192
s_nop 0
buffer_load_dwordx4 v5, s[36:39], s64 offen lds
s_add_u32 m0, s63, 9216
s_nop 0
buffer_load_dwordx4 v6, s[36:39], s64 offen lds
s_add_u32 m0, s63, 10240
s_nop 0
buffer_load_dwordx4 v7, s[36:39], s64 offen lds
s_add_u32 m0, s63, 11264
s_nop 0
buffer_load_dwordx4 v8, s[36:39], s64 offen lds
s_add_u32 m0, s63, 12288
s_nop 0
buffer_load_dwordx4 v9, s[36:39], s64 offen lds
s_add_u32 m0, s63, 13312
s_nop 0
buffer_load_dwordx4 v10, s[36:39], s64 offen lds
s_add_u32 s61, s61, 458752
s_add_u32 s67, s67, 1
s_cmp_eq_u32 s67, 3
s_cselect_b32 s66, s69, s68
s_cselect_b32 s67, 0, s67
s_add_u32 s62, s62, s66
s_add_u32 s63, s63, s66
s_mov_b32 s65, 1
p4_ld_loop:
s_waitcnt vmcnt(22)
s_barrier
s_cmp_eq_u32 s90, s86
s_cselect_b32 s64, 4096, 0
s_add_u32 s60, s60, s64
s_add_u32 s90, s90, 1
s_add_u32 m0, s62, 0
s_add_u32 s64, s60, 65536
buffer_load_dwordx4 v2, s[32:35], s60 offen offset:0 sc1 lds
buffer_load_dwordx4 v2, s[32:35], s60 offen offset:1024 sc1 lds
buffer_load_dwordx4 v2, s[32:35], s60 offen offset:2048 sc1 lds
buffer_load_dwordx4 v2, s[32:35], s60 offen offset:3072 sc1 lds
s_add_u32 m0, s62, 4096
s_add_u32 s60, s60, 4096
buffer_load_dwordx4 v2, s[32:35], s64 offen offset:0 sc1 lds
buffer_load_dwordx4 v2, s[32:35], s64 offen offset:1024 sc1 lds
buffer_load_dwordx4 v2, s[32:35], s64 offen offset:2048 sc1 lds
buffer_load_dwordx4 v2, s[32:35], s64 offen offset:3072 sc1 lds
s_cmp_eq_u32 s91, s86
s_cselect_b32 s64, 458752, 0
s_add_u32 s61, s61, s64
s_add_u32 s91, s91, 1
s_add_u32 m0, s63, 0
s_nop 0
buffer_load_dwordx4 v4, s[36:39], s61 offen lds
s_add_u32 m0, s63, 1024
s_nop 0
buffer_load_dwordx4 v5, s[36:39], s61 offen lds
s_add_u32 m0, s63, 2048
s_nop 0
buffer_load_dwordx4 v6, s[36:39], s61 offen lds
s_add_u32 m0, s63, 3072
s_nop 0
buffer_load_dwordx4 v7, s[36:39], s61 offen lds
s_add_u32 m0, s63, 4096
s_nop 0
buffer_load_dwordx4 v8, s[36:39], s61 offen lds
s_add_u32 m0, s63, 5120
s_nop 0
buffer_load_dwordx4 v9, s[36:39], s61 offen lds
s_add_u32 m0, s63, 6144
s_nop 0
buffer_load_dwordx4 v10, s[36:39], s61 offen lds
s_add_u32 s64, s61, 114688
s_add_u32 m0, s63, 7168
s_nop 0
buffer_load_dwordx4 v4, s[36:39], s64 offen lds
s_add_u32 m0, s63, 8192
s_nop 0
buffer_load_dwordx4 v5, s[36:39], s64 offen lds
s_add_u32 m0, s63, 9216
s_nop 0
buffer_load_dwordx4 v6, s[36:39], s64 offen lds
s_add_u32 m0, s63, 10240
s_nop 0
buffer_load_dwordx4 v7, s[36:39], s64 offen lds
s_add_u32 m0, s63, 11264
s_nop 0
buffer_load_dwordx4 v8, s[36:39], s64 offen lds
s_add_u32 m0, s63, 12288
s_nop 0
buffer_load_dwordx4 v9, s[36:39], s64 offen lds
s_add_u32 m0, s63, 13312
s_nop 0
buffer_load_dwordx4 v10, s[36:39], s64 offen lds
s_add_u32 s61, s61, 458752
s_add_u32 s67, s67, 1
s_cmp_eq_u32 s67, 3
s_cselect_b32 s66, s69, s68
s_cselect_b32 s67, 0, s67
s_add_u32 s62, s62, s66
s_add_u32 s63, s63, s66
s_add_u32 s65, s65, 1
s_cmp_lt_u32 s65, 13
s_cbranch_scc1 p4_ld_loop
s_add_u32 s76, s22, 3670016
s_addc_u32 s77, s23, 0
s_lshl_b32 s70, s2, 1
s_add_u32 s70, s70, s7
s_lshl_b32 s70, s70, 13
v_lshlrev_b32 v16, 7, v1
s_mov_b32 s44, s76
s_mov_b32 s45, s77
s_mov_b32 s46, 0x380000
s_mov_b32 s47, 0x20000
s_mov_b32 s71, s70
buffer_load_dword v200, v16, s[44:47], s71 offen
s_waitcnt vmcnt(23)
s_barrier
s_waitcnt vmcnt(1)
s_barrier
s_barrier
s_and_b32 s82, s30, 1
s_lshr_b32 s4, s30, 1
s_lshl_b32 s4, s4, 2
s_and_b32 s64, s31, 3
s_add_u32 s4, s4, s64
s_lshr_b32 s5, s31, 2
s_add_u32 s32, s8, 0x1400000
s_addc_u32 s33, s9, 0
s_mov_b32 s34, 0xe00000
s_mov_b32 s35, 0x20000
s_mov_b32 s36, s22
s_mov_b32 s37, s23
s_mov_b32 s38, 0x700000
s_mov_b32 s39, 0x20000
v_lshlrev_b32 v2, 4, v1
s_lshl_b32 s60, s4, 2
s_lshl_b32 s64, s7, 1
s_add_u32 s60, s60, s64
s_mul_i32 s60, s60, 229376
v_lshrrev_b32 v10, 5, v1
v_lshlrev_b32 v10, 2, v10
v_bfe_u32 v11, v1, 2, 2
v_add_u32 v10, v10, v11
v_mul_u32_u24 v10, 2048, v10
v_bfe_u32 v11, v1, 4, 1
v_lshl_add_u32 v10, v11, 6, v10
v_and_b32 v11, 3, v1
v_lshl_add_u32 v4, v11, 4, v10
v_xor_b32 v11, 2, v11
v_lshl_add_u32 v5, v11, 4, v10
s_mul_i32 s61, s7, 65536
s_mul_i32 s64, s5, 256
s_add_u32 s61, s61, s64
s_mul_i32 s63, s7, 8192
s_mul_i32 s64, s82, 131072
s_add_u32 s60, s60, s64
s_mul_i32 s64, s82, 4194304
s_add_u32 s61, s61, s64
s_add_u32 s63, s63, 16384
s_lshl_b32 s62, s7, 13
s_mov_b32 s68, 32768
s_mov_b32 s69, 0xfffe8000
s_barrier
s_add_u32 m0, s63, 0
s_add_u32 s64, s61, 0
buffer_load_dwordx4 v4, s[36:39], s64 offen lds
s_add_u32 m0, s63, 1024
s_add_u32 s64, s61, 128
buffer_load_dwordx4 v4, s[36:39], s64 offen lds
s_add_u32 m0, s63, 2048
s_add_u32 s64, s61, 16384
buffer_load_dwordx4 v5, s[36:39], s64 offen lds
s_add_u32 m0, s63, 3072
s_add_u32 s64, s61, 16512
buffer_load_dwordx4 v5, s[36:39], s64 offen lds
s_add_u32 m0, s63, 4096
s_add_u32 s64, s61, 32768
buffer_load_dwordx4 v4, s[36:39], s64 offen lds
s_add_u32 m0, s63, 5120
s_add_u32 s64, s61, 32896
buffer_load_dwordx4 v4, s[36:39], s64 offen lds
s_add_u32 m0, s63, 6144
s_add_u32 s64, s61, 49152
buffer_load_dwordx4 v5, s[36:39], s64 offen lds
s_add_u32 m0, s63, 7168
s_add_u32 s64, s61, 49280
buffer_load_dwordx4 v5, s[36:39], s64 offen lds
s_add_u32 s61, s61, 131072
s_add_u32 m0, s63, 32768
s_add_u32 s64, s61, 0
buffer_load_dwordx4 v4, s[36:39], s64 offen lds
s_add_u32 m0, s63, 33792
s_add_u32 s64, s61, 128
buffer_load_dwordx4 v4, s[36:39], s64 offen lds
s_add_u32 m0, s63, 34816
s_add_u32 s64, s61, 16384
buffer_load_dwordx4 v5, s[36:39], s64 offen lds
s_add_u32 m0, s63, 35840
s_add_u32 s64, s61, 16512
buffer_load_dwordx4 v5, s[36:39], s64 offen lds
s_add_u32 m0, s63, 36864
s_add_u32 s64, s61, 32768
buffer_load_dwordx4 v4, s[36:39], s64 offen lds
s_add_u32 m0, s63, 37888
s_add_u32 s64, s61, 32896
buffer_load_dwordx4 v4, s[36:39], s64 offen lds
s_add_u32 m0, s63, 38912
s_add_u32 s64, s61, 49152
buffer_load_dwordx4 v5, s[36:39], s64 offen lds
s_add_u32 m0, s63, 39936
s_add_u32 s64, s61, 49280
buffer_load_dwordx4 v5, s[36:39], s64 offen lds
s_add_u32 s61, s61, 131072
s_add_u32 m0, s63, 65536
s_add_u32 s64, s61, 0
buffer_load_dwordx4 v4, s[36:39], s64 offen lds
s_add_u32 m0, s63, 66560
s_add_u32 s64, s61, 128
buffer_load_dwordx4 v4, s[36:39], s64 offen lds
s_add_u32 m0, s63, 67584
s_add_u32 s64, s61, 16384
buffer_load_dwordx4 v5, s[36:39], s64 offen lds
s_add_u32 m0, s63, 68608
s_add_u32 s64, s61, 16512
buffer_load_dwordx4 v5, s[36:39], s64 offen lds
s_add_u32 m0, s63, 69632
s_add_u32 s64, s61, 32768
buffer_load_dwordx4 v4, s[36:39], s64 offen lds
s_add_u32 m0, s63, 70656
s_add_u32 s64, s61, 32896
buffer_load_dwordx4 v4, s[36:39], s64 offen lds
s_add_u32 m0, s63, 71680
s_add_u32 s64, s61, 49152
buffer_load_dwordx4 v5, s[36:39], s64 offen lds
s_add_u32 m0, s63, 72704
s_add_u32 s64, s61, 49280
buffer_load_dwordx4 v5, s[36:39], s64 offen lds
s_add_u32 s61, s61, 131072
s_add_u32 m0, s63, 98304
s_add_u32 s64, s61, 0
buffer_load_dwordx4 v4, s[36:39], s64 offen lds
s_add_u32 m0, s63, 99328
s_add_u32 s64, s61, 128
buffer_load_dwordx4 v4, s[36:39], s64 offen lds
s_add_u32 m0, s63, 100352
s_add_u32 s64, s61, 16384
buffer_load_dwordx4 v5, s[36:39], s64 offen lds
s_add_u32 m0, s63, 101376
s_add_u32 s64, s61, 16512
buffer_load_dwordx4 v5, s[36:39], s64 offen lds
s_add_u32 m0, s63, 102400
s_add_u32 s64, s61, 32768
buffer_load_dwordx4 v4, s[36:39], s64 offen lds
s_add_u32 m0, s63, 103424
s_add_u32 s64, s61, 32896
buffer_load_dwordx4 v4, s[36:39], s64 offen lds
s_add_u32 m0, s63, 104448
s_add_u32 s64, s61, 49152
buffer_load_dwordx4 v5, s[36:39], s64 offen lds
s_add_u32 m0, s63, 105472
s_add_u32 s64, s61, 49280
buffer_load_dwordx4 v5, s[36:39], s64 offen lds
s_add_u32 s61, s61, 131072
s_barrier
s_add_u32 m0, s62, 0
s_add_u32 s64, s60, 229376
buffer_load_dwordx4 v2, s[32:35], s60 offen offset:0 sc1 lds
buffer_load_dwordx4 v2, s[32:35], s60 offen offset:1024 sc1 lds
buffer_load_dwordx4 v2, s[32:35], s60 offen offset:2048 sc1 lds
buffer_load_dwordx4 v2, s[32:35], s60 offen offset:3072 sc1 lds
s_add_u32 m0, s62, 4096
s_add_u32 s60, s60, 4096
buffer_load_dwordx4 v2, s[32:35], s64 offen offset:0 sc1 lds
buffer_load_dwordx4 v2, s[32:35], s64 offen offset:1024 sc1 lds
buffer_load_dwordx4 v2, s[32:35], s64 offen offset:2048 sc1 lds
buffer_load_dwordx4 v2, s[32:35], s64 offen offset:3072 sc1 lds
s_add_u32 m0, s62, 32768
s_add_u32 s64, s60, 229376
buffer_load_dwordx4 v2, s[32:35], s60 offen offset:0 sc1 lds
buffer_load_dwordx4 v2, s[32:35], s60 offen offset:1024 sc1 lds
buffer_load_dwordx4 v2, s[32:35], s60 offen offset:2048 sc1 lds
buffer_load_dwordx4 v2, s[32:35], s60 offen offset:3072 sc1 lds
s_add_u32 m0, s62, 36864
s_add_u32 s60, s60, 4096
buffer_load_dwordx4 v2, s[32:35], s64 offen offset:0 sc1 lds
buffer_load_dwordx4 v2, s[32:35], s64 offen offset:1024 sc1 lds
buffer_load_dwordx4 v2, s[32:35], s64 offen offset:2048 sc1 lds
buffer_load_dwordx4 v2, s[32:35], s64 offen offset:3072 sc1 lds
s_waitcnt vmcnt(8)
s_barrier
s_add_u32 m0, s62, 65536
s_add_u32 s64, s60, 229376
buffer_load_dwordx4 v2, s[32:35], s60 offen offset:0 sc1 lds
buffer_load_dwordx4 v2, s[32:35], s60 offen offset:1024 sc1 lds
buffer_load_dwordx4 v2, s[32:35], s60 offen offset:2048 sc1 lds
buffer_load_dwordx4 v2, s[32:35], s60 offen offset:3072 sc1 lds
s_add_u32 m0, s62, 69632
s_add_u32 s60, s60, 4096
buffer_load_dwordx4 v2, s[32:35], s64 offen offset:0 sc1 lds
buffer_load_dwordx4 v2, s[32:35], s64 offen offset:1024 sc1 lds
buffer_load_dwordx4 v2, s[32:35], s64 offen offset:2048 sc1 lds
buffer_load_dwordx4 v2, s[32:35], s64 offen offset:3072 sc1 lds
s_add_u32 m0, s62, 98304
s_add_u32 s64, s60, 229376
buffer_load_dwordx4 v2, s[32:35], s60 offen offset:0 sc1 lds
buffer_load_dwordx4 v2, s[32:35], s60 offen offset:1024 sc1 lds
buffer_load_dwordx4 v2, s[32:35], s60 offen offset:2048 sc1 lds
buffer_load_dwordx4 v2, s[32:35], s60 offen offset:3072 sc1 lds
s_add_u32 m0, s62, 102400
s_add_u32 s60, s60, 4096
buffer_load_dwordx4 v2, s[32:35], s64 offen offset:0 sc1 lds
buffer_load_dwordx4 v2, s[32:35], s64 offen offset:1024 sc1 lds
buffer_load_dwordx4 v2, s[32:35], s64 offen offset:2048 sc1 lds
buffer_load_dwordx4 v2, s[32:35], s64 offen offset:3072 sc1 lds
s_mov_b32 s67, 0
s_waitcnt vmcnt(16)
s_barrier
s_add_u32 m0, s62, 0
s_add_u32 s64, s60, 229376
buffer_load_dwordx4 v2, s[32:35], s60 offen offset:0 sc1 lds
buffer_load_dwordx4 v2, s[32:35], s60 offen offset:1024 sc1 lds
buffer_load_dwordx4 v2, s[32:35], s60 offen offset:2048 sc1 lds
buffer_load_dwordx4 v2, s[32:35], s60 offen offset:3072 sc1 lds
s_add_u32 m0, s62, 4096
s_add_u32 s60, s60, 4096
buffer_load_dwordx4 v2, s[32:35], s64 offen offset:0 sc1 lds
buffer_load_dwordx4 v2, s[32:35], s64 offen offset:1024 sc1 lds
buffer_load_dwordx4 v2, s[32:35], s64 offen offset:2048 sc1 lds
buffer_load_dwordx4 v2, s[32:35], s64 offen offset:3072 sc1 lds
s_add_u32 m0, s63, 0
s_add_u32 s64, s61, 0
buffer_load_dwordx4 v4, s[36:39], s64 offen lds
s_add_u32 m0, s63, 1024
s_add_u32 s64, s61, 128
buffer_load_dwordx4 v4, s[36:39], s64 offen lds
s_add_u32 m0, s63, 2048
s_add_u32 s64, s61, 16384
buffer_load_dwordx4 v5, s[36:39], s64 offen lds
s_add_u32 m0, s63, 3072
s_add_u32 s64, s61, 16512
buffer_load_dwordx4 v5, s[36:39], s64 offen lds
s_add_u32 m0, s63, 4096
s_add_u32 s64, s61, 32768
buffer_load_dwordx4 v4, s[36:39], s64 offen lds
s_add_u32 m0, s63, 5120
s_add_u32 s64, s61, 32896
buffer_load_dwordx4 v4, s[36:39], s64 offen lds
s_add_u32 m0, s63, 6144
s_add_u32 s64, s61, 49152
buffer_load_dwordx4 v5, s[36:39], s64 offen lds
s_add_u32 m0, s63, 7168
s_add_u32 s64, s61, 49280
buffer_load_dwordx4 v5, s[36:39], s64 offen lds
s_add_u32 s61, s61, 131072
s_add_u32 s67, s67, 1
s_cmp_eq_u32 s67, 4
s_cselect_b32 s66, s69, s68
s_cselect_b32 s67, 0, s67
s_add_u32 s62, s62, s66
s_add_u32 s63, s63, s66
s_waitcnt vmcnt(24)
s_barrier
s_add_u32 m0, s62, 0
s_add_u32 s64, s60, 229376
buffer_load_dwordx4 v2, s[32:35], s60 offen offset:0 sc1 lds
buffer_load_dwordx4 v2, s[32:35], s60 offen offset:1024 sc1 lds
buffer_load_dwordx4 v2, s[32:35], s60 offen offset:2048 sc1 lds
buffer_load_dwordx4 v2, s[32:35], s60 offen offset:3072 sc1 lds
s_add_u32 m0, s62, 4096
s_add_u32 s60, s60, 4096
buffer_load_dwordx4 v2, s[32:35], s64 offen offset:0 sc1 lds
buffer_load_dwordx4 v2, s[32:35], s64 offen offset:1024 sc1 lds
buffer_load_dwordx4 v2, s[32:35], s64 offen offset:2048 sc1 lds
buffer_load_dwordx4 v2, s[32:35], s64 offen offset:3072 sc1 lds
s_add_u32 m0, s63, 0
s_add_u32 s64, s61, 0
buffer_load_dwordx4 v4, s[36:39], s64 offen lds
s_add_u32 m0, s63, 1024
s_add_u32 s64, s61, 128
buffer_load_dwordx4 v4, s[36:39], s64 offen lds
s_add_u32 m0, s63, 2048
s_add_u32 s64, s61, 16384
buffer_load_dwordx4 v5, s[36:39], s64 offen lds
s_add_u32 m0, s63, 3072
s_add_u32 s64, s61, 16512
buffer_load_dwordx4 v5, s[36:39], s64 offen lds
s_add_u32 m0, s63, 4096
s_add_u32 s64, s61, 32768
buffer_load_dwordx4 v4, s[36:39], s64 offen lds
s_add_u32 m0, s63, 5120
s_add_u32 s64, s61, 32896
buffer_load_dwordx4 v4, s[36:39], s64 offen lds
s_add_u32 m0, s63, 6144
s_add_u32 s64, s61, 49152
buffer_load_dwordx4 v5, s[36:39], s64 offen lds
s_add_u32 m0, s63, 7168
s_add_u32 s64, s61, 49280
buffer_load_dwordx4 v5, s[36:39], s64 offen lds
s_add_u32 s61, s61, 131072
s_add_u32 s67, s67, 1
s_cmp_eq_u32 s67, 4
s_cselect_b32 s66, s69, s68
s_cselect_b32 s67, 0, s67
s_add_u32 s62, s62, s66
s_add_u32 s63, s63, s66
s_mov_b32 s65, 2
p5_ld_loop:
s_waitcnt vmcnt(32)
s_barrier
s_cmp_lg_u32 s65, 20
s_cbranch_scc1 p5_ld_nj
s_mul_i32 s64, s82, 131072
s_sub_u32 s60, s60, s64
s_mul_i32 s64, s82, 4194304
s_sub_u32 s61, s61, s64
s_cmp_lg_u32 s7, s82
s_cselect_b32 s60, 0x70000000, s60
p5_ld_nj:
s_add_u32 m0, s62, 0
s_add_u32 s64, s60, 229376
buffer_load_dwordx4 v2, s[32:35], s60 offen offset:0 sc1 lds
buffer_load_dwordx4 v2, s[32:35], s60 offen offset:1024 sc1 lds
buffer_load_dwordx4 v2, s[32:35], s60 offen offset:2048 sc1 lds
buffer_load_dwordx4 v2, s[32:35], s60 offen offset:3072 sc1 lds
s_add_u32 m0, s62, 4096
s_add_u32 s60, s60, 4096
buffer_load_dwordx4 v2, s[32:35], s64 offen offset:0 sc1 lds
buffer_load_dwordx4 v2, s[32:35], s64 offen offset:1024 sc1 lds
buffer_load_dwordx4 v2, s[32:35], s64 offen offset:2048 sc1 lds
buffer_load_dwordx4 v2, s[32:35], s64 offen offset:3072 sc1 lds
s_add_u32 m0, s63, 0
s_add_u32 s64, s61, 0
buffer_load_dwordx4 v4, s[36:39], s64 offen lds
s_add_u32 m0, s63, 1024
s_add_u32 s64, s61, 128
buffer_load_dwordx4 v4, s[36:39], s64 offen lds
s_add_u32 m0, s63, 2048
s_add_u32 s64, s61, 16384
buffer_load_dwordx4 v5, s[36:39], s64 offen lds
s_add_u32 m0, s63, 3072
s_add_u32 s64, s61, 16512
buffer_load_dwordx4 v5, s[36:39], s64 offen lds
s_add_u32 m0, s63, 4096
s_add_u32 s64, s61, 32768
buffer_load_dwordx4 v4, s[36:39], s64 offen lds
s_add_u32 m0, s63, 5120
s_add_u32 s64, s61, 32896
buffer_load_dwordx4 v4, s[36:39], s64 offen lds
s_add_u32 m0, s63, 6144
s_add_u32 s64, s61, 49152
buffer_load_dwordx4 v5, s[36:39], s64 offen lds
s_add_u32 m0, s63, 7168
s_add_u32 s64, s61, 49280
buffer_load_dwordx4 v5, s[36:39], s64 offen lds
s_add_u32 s61, s61, 131072
s_add_u32 s67, s67, 1
s_cmp_eq_u32 s67, 4
s_cselect_b32 s66, s69, s68
s_cselect_b32 s67, 0, s67
s_add_u32 s62, s62, s66
s_add_u32 s63, s63, s66
s_add_u32 s65, s65, 1
s_cmp_lt_u32 s65, 28
s_cbranch_scc1 p5_ld_loop
s_waitcnt vmcnt(32)
s_barrier
s_waitcnt vmcnt(16)
s_barrier
s_waitcnt vmcnt(0)
s_barrier
s_barrier
s_endpgm
kp_compute:
s_lshr_b32 s6, s3, 1
s_and_b32 s7, s3, 1
s_and_b32 s4, s30, 1
s_lshr_b32 s5, s30, 1
s_mul_i32 s4, s4, 8
s_mul_i32 s5, s5, 4
s_and_b32 s64, s31, 7
s_add_u32 s4, s4, s64
s_lshr_b32 s64, s31, 3
s_add_u32 s5, s5, s64
v_and_b32 v10, 15, v1
v_lshrrev_b32 v11, 4, v1
s_lshl_b32 s64, s6, 13
v_bfe_u32 v12, v10, 1, 3
v_xor_b32 v12, v12, v11
v_lshlrev_b32 v13, 7, v10
v_add_u32 v13, s64, v13
v_xor_b32 v14, 0, v12
v_lshl_add_u32 v2, v14, 4, v13
v_xor_b32 v14, 4, v12
v_lshl_add_u32 v3, v14, 4, v13
v_bfe_u32 v12, v1, 2, 2
v_lshlrev_b32 v12, 6, v12
v_and_b32 v13, 3, v1
v_lshl_add_u32 v12, v13, 3, v12
v_mul_u32_u24 v13, 3072, v11
v_add_u32 v12, v12, v13
v_and_b32 v13, 1, v11
v_lshl_add_u32 v12, v13, 5, v12
s_mul_i32 s64, s7, 256
v_add_u32 v6, s64, v12
v_xor_b32 v7, 32, v6
s_mov_b32 s68, 40960
s_mov_b32 s69, 0xfffec000
v_mov_b32 v16, 0
v_mov_b32 v17, 0
v_mov_b32 v18, 0
v_mov_b32 v19, 0
v_mov_b32 v20, 0
v_mov_b32 v21, 0
v_mov_b32 v22, 0
v_mov_b32 v23, 0
v_mov_b32 v24, 0
v_mov_b32 v25, 0
v_mov_b32 v26, 0
v_mov_b32 v27, 0
v_mov_b32 v28, 0
v_mov_b32 v29, 0
v_mov_b32 v30, 0
v_mov_b32 v31, 0
v_mov_b32 v32, 0
v_mov_b32 v33, 0
v_mov_b32 v34, 0
v_mov_b32 v35, 0
v_mov_b32 v36, 0
v_mov_b32 v37, 0
v_mov_b32 v38, 0
v_mov_b32 v39, 0
v_mov_b32 v40, 0
v_mov_b32 v41, 0
v_mov_b32 v42, 0
v_mov_b32 v43, 0
v_mov_b32 v44, 0
v_mov_b32 v45, 0
v_mov_b32 v46, 0
v_mov_b32 v47, 0
v_mov_b32 v48, 0
v_mov_b32 v49, 0
v_mov_b32 v50, 0
v_mov_b32 v51, 0
v_mov_b32 v52, 0
v_mov_b32 v53, 0
v_mov_b32 v54, 0
v_mov_b32 v55, 0
v_mov_b32 v56, 0
v_mov_b32 v57, 0
v_mov_b32 v58, 0
v_mov_b32 v59, 0
v_mov_b32 v60, 0
v_mov_b32 v61, 0
v_mov_b32 v62, 0
v_mov_b32 v63, 0
v_mov_b32 v64, 0
v_mov_b32 v65, 0
v_mov_b32 v66, 0
v_mov_b32 v67, 0
v_mov_b32 v68, 0
v_mov_b32 v69, 0
v_mov_b32 v70, 0
v_mov_b32 v71, 0
v_mov_b32 v72, 0
v_mov_b32 v73, 0
v_mov_b32 v74, 0
v_mov_b32 v75, 0
v_mov_b32 v76, 0
v_mov_b32 v77, 0
v_mov_b32 v78, 0
v_mov_b32 v79, 0
v_mov_b32 v80, 0
v_mov_b32 v81, 0
v_mov_b32 v82, 0
v_mov_b32 v83, 0
v_mov_b32 v84, 0
v_mov_b32 v85, 0
v_mov_b32 v86, 0
v_mov_b32 v87, 0
v_mov_b32 v88, 0
v_mov_b32 v89, 0
v_mov_b32 v90, 0
v_mov_b32 v91, 0
v_mov_b32 v92, 0
v_mov_b32 v93, 0
v_mov_b32 v94, 0
v_mov_b32 v95, 0
v_mov_b32 v96, 0
v_mov_b32 v97, 0
v_mov_b32 v98, 0
v_mov_b32 v99, 0
v_mov_b32 v100, 0
v_mov_b32 v101, 0
v_mov_b32 v102, 0
v_mov_b32 v103, 0
v_mov_b32 v104, 0
v_mov_b32 v105, 0
v_mov_b32 v106, 0
v_mov_b32 v107, 0
v_mov_b32 v108, 0
v_mov_b32 v109, 0
v_mov_b32 v110, 0
v_mov_b32 v111, 0
v_mov_b32 v192, 0x3f803f80
v_mov_b32 v193, 0x3f803f80
v_mov_b32 v194, 0x3f803f80
v_mov_b32 v195, 0x3f803f80
s_barrier
ds_read_b64_tr_b16 v[144:145], v6 offset:16384
ds_read_b64_tr_b16 v[146:147], v6 offset:16896
ds_read_b128 v[112:115], v2 offset:0
ds_read_b128 v[116:119], v2 offset:2048
ds_read_b128 v[120:123], v2 offset:4096
ds_read_b128 v[124:127], v2 offset:6144
ds_read_b64_tr_b16 v[148:149], v7 offset:16384
ds_read_b64_tr_b16 v[150:151], v7 offset:16896
ds_read_b64_tr_b16 v[152:153], v6 offset:17408
ds_read_b64_tr_b16 v[154:155], v6 offset:17920
ds_read_b64_tr_b16 v[156:157], v7 offset:17408
ds_read_b64_tr_b16 v[158:159], v7 offset:17920
ds_read_b64_tr_b16 v[160:161], v6 offset:18432
ds_read_b64_tr_b16 v[162:163], v6 offset:18944
ds_read_b64_tr_b16 v[164:165], v7 offset:18432
ds_read_b64_tr_b16 v[166:167], v7 offset:18944
s_mov_b32 s65, 0
s_mov_b32 s67, 0
p1_pre:
s_waitcnt lgkmcnt(0)
v_mfma_f32_16x16x32_bf16 v[16:19], v[144:147], v[112:115], v[16:19]
ds_read_b64_tr_b16 v[168:169], v6 offset:28672
v_mfma_f32_16x16x32_bf16 v[40:43], v[144:147], v[116:119], v[40:43]
ds_read_b64_tr_b16 v[170:171], v6 offset:29184
v_mfma_f32_16x16x32_bf16 v[64:67], v[144:147], v[120:123], v[64:67]
ds_read_b128 v[128:131], v3 offset:0
v_mfma_f32_16x16x32_bf16 v[88:91], v[144:147], v[124:127], v[88:91]
ds_read_b128 v[132:135], v3 offset:2048
v_mfma_f32_16x16x32_bf16 v[20:23], v[148:151], v[112:115], v[20:23]
ds_read_b128 v[136:139], v3 offset:4096
v_mfma_f32_16x16x32_bf16 v[44:47], v[148:151], v[116:119], v[44:47]
ds_read_b128 v[140:143], v3 offset:6144
v_mfma_f32_16x16x32_bf16 v[68:71], v[148:151], v[120:123], v[68:71]
ds_read_b64_tr_b16 v[172:173], v7 offset:28672
v_mfma_f32_16x16x32_bf16 v[92:95], v[148:151], v[124:127], v[92:95]
ds_read_b64_tr_b16 v[174:175], v7 offset:29184
v_mfma_f32_16x16x32_bf16 v[24:27], v[152:155], v[112:115], v[24:27]
ds_read_b64_tr_b16 v[176:177], v6 offset:29696
v_mfma_f32_16x16x32_bf16 v[48:51], v[152:155], v[116:119], v[48:51]
ds_read_b64_tr_b16 v[178:179], v6 offset:30208
v_mfma_f32_16x16x32_bf16 v[72:75], v[152:155], v[120:123], v[72:75]
ds_read_b64_tr_b16 v[180:181], v7 offset:29696
v_mfma_f32_16x16x32_bf16 v[96:99], v[152:155], v[124:127], v[96:99]
ds_read_b64_tr_b16 v[182:183], v7 offset:30208
v_mfma_f32_16x16x32_bf16 v[28:31], v[156:159], v[112:115], v[28:31]
ds_read_b64_tr_b16 v[184:185], v6 offset:30720
v_mfma_f32_16x16x32_bf16 v[52:55], v[156:159], v[116:119], v[52:55]
ds_read_b64_tr_b16 v[186:187], v6 offset:31232
v_mfma_f32_16x16x32_bf16 v[76:79], v[156:159], v[120:123], v[76:79]
ds_read_b64_tr_b16 v[188:189], v7 offset:30720
v_mfma_f32_16x16x32_bf16 v[100:103], v[156:159], v[124:127], v[100:103]
ds_read_b64_tr_b16 v[190:191], v7 offset:31232
v_mfma_f32_16x16x32_bf16 v[32:35], v[112:115], v[160:163], v[32:35]
v_mfma_f32_16x16x32_bf16 v[56:59], v[116:119], v[160:163], v[56:59]
v_mfma_f32_16x16x32_bf16 v[80:83], v[120:123], v[160:163], v[80:83]
v_mfma_f32_16x16x32_bf16 v[104:107], v[124:127], v[160:163], v[104:107]
v_mfma_f32_16x16x32_bf16 v[36:39], v[112:115], v[164:167], v[36:39]
v_mfma_f32_16x16x32_bf16 v[60:63], v[116:119], v[164:167], v[60:63]
v_mfma_f32_16x16x32_bf16 v[84:87], v[120:123], v[164:167], v[84:87]
v_mfma_f32_16x16x32_bf16 v[108:111], v[124:127], v[164:167], v[108:111]
s_waitcnt lgkmcnt(0)
s_add_u32 s67, s67, 1
s_cmp_eq_u32 s67, 3
s_cselect_b32 s66, s69, s68
s_cselect_b32 s67, 0, s67
v_add_u32 v2, s66, v2
v_add_u32 v3, s66, v3
v_add_u32 v6, s66, v6
v_add_u32 v7, s66, v7
s_barrier
v_mfma_f32_16x16x32_bf16 v[16:19], v[168:171], v[128:131], v[16:19]
ds_read_b64_tr_b16 v[144:145], v6 offset:16384
v_mfma_f32_16x16x32_bf16 v[40:43], v[168:171], v[132:135], v[40:43]
ds_read_b64_tr_b16 v[146:147], v6 offset:16896
v_mfma_f32_16x16x32_bf16 v[64:67], v[168:171], v[136:139], v[64:67]
ds_read_b128 v[112:115], v2 offset:0
v_mfma_f32_16x16x32_bf16 v[88:91], v[168:171], v[140:143], v[88:91]
ds_read_b128 v[116:119], v2 offset:2048
v_mfma_f32_16x16x32_bf16 v[20:23], v[172:175], v[128:131], v[20:23]
ds_read_b128 v[120:123], v2 offset:4096
v_mfma_f32_16x16x32_bf16 v[44:47], v[172:175], v[132:135], v[44:47]
ds_read_b128 v[124:127], v2 offset:6144
v_mfma_f32_16x16x32_bf16 v[68:71], v[172:175], v[136:139], v[68:71]
ds_read_b64_tr_b16 v[148:149], v7 offset:16384
v_mfma_f32_16x16x32_bf16 v[92:95], v[172:175], v[140:143], v[92:95]
ds_read_b64_tr_b16 v[150:151], v7 offset:16896
v_mfma_f32_16x16x32_bf16 v[24:27], v[176:179], v[128:131], v[24:27]
ds_read_b64_tr_b16 v[152:153], v6 offset:17408
v_mfma_f32_16x16x32_bf16 v[48:51], v[176:179], v[132:135], v[48:51]
ds_read_b64_tr_b16 v[154:155], v6 offset:17920
v_mfma_f32_16x16x32_bf16 v[72:75], v[176:179], v[136:139], v[72:75]
ds_read_b64_tr_b16 v[156:157], v7 offset:17408
v_mfma_f32_16x16x32_bf16 v[96:99], v[176:179], v[140:143], v[96:99]
ds_read_b64_tr_b16 v[158:159], v7 offset:17920
v_mfma_f32_16x16x32_bf16 v[28:31], v[180:183], v[128:131], v[28:31]
ds_read_b64_tr_b16 v[160:161], v6 offset:18432
v_mfma_f32_16x16x32_bf16 v[52:55], v[180:183], v[132:135], v[52:55]
ds_read_b64_tr_b16 v[162:163], v6 offset:18944
v_mfma_f32_16x16x32_bf16 v[76:79], v[180:183], v[136:139], v[76:79]
ds_read_b64_tr_b16 v[164:165], v7 offset:18432
v_mfma_f32_16x16x32_bf16 v[100:103], v[180:183], v[140:143], v[100:103]
ds_read_b64_tr_b16 v[166:167], v7 offset:18944
v_mfma_f32_16x16x32_bf16 v[32:35], v[128:131], v[184:187], v[32:35]
v_mfma_f32_16x16x32_bf16 v[56:59], v[132:135], v[184:187], v[56:59]
v_mfma_f32_16x16x32_bf16 v[80:83], v[136:139], v[184:187], v[80:83]
v_mfma_f32_16x16x32_bf16 v[104:107], v[140:143], v[184:187], v[104:107]
v_mfma_f32_16x16x32_bf16 v[36:39], v[128:131], v[188:191], v[36:39]
v_mfma_f32_16x16x32_bf16 v[60:63], v[132:135], v[188:191], v[60:63]
v_mfma_f32_16x16x32_bf16 v[84:87], v[136:139], v[188:191], v[84:87]
v_mfma_f32_16x16x32_bf16 v[108:111], v[140:143], v[188:191], v[108:111]
s_add_u32 s65, s65, 1
s_cmp_lt_u32 s65, 4
s_cbranch_scc1 p1_pre
s_waitcnt lgkmcnt(0)
v_mfma_f32_16x16x32_bf16 v[16:19], v[144:147], v[112:115], v[16:19]
ds_read_b64_tr_b16 v[168:169], v6 offset:28672
v_mfma_f32_16x16x32_bf16 v[40:43], v[144:147], v[116:119], v[40:43]
ds_read_b64_tr_b16 v[170:171], v6 offset:29184
v_mfma_f32_16x16x32_bf16 v[64:67], v[144:147], v[120:123], v[64:67]
ds_read_b128 v[128:131], v3 offset:0
v_mfma_f32_16x16x32_bf16 v[88:91], v[144:147], v[124:127], v[88:91]
ds_read_b128 v[132:135], v3 offset:2048
v_mfma_f32_16x16x32_bf16 v[20:23], v[148:151], v[112:115], v[20:23]
ds_read_b128 v[136:139], v3 offset:4096
v_mfma_f32_16x16x32_bf16 v[44:47], v[148:151], v[116:119], v[44:47]
ds_read_b128 v[140:143], v3 offset:6144
v_mfma_f32_16x16x32_bf16 v[68:71], v[148:151], v[120:123], v[68:71]
ds_read_b64_tr_b16 v[172:173], v7 offset:28672
v_mfma_f32_16x16x32_bf16 v[92:95], v[148:151], v[124:127], v[92:95]
ds_read_b64_tr_b16 v[174:175], v7 offset:29184
v_mfma_f32_16x16x32_bf16 v[24:27], v[152:155], v[112:115], v[24:27]
ds_read_b64_tr_b16 v[176:177], v6 offset:29696
v_mfma_f32_16x16x32_bf16 v[48:51], v[152:155], v[116:119], v[48:51]
ds_read_b64_tr_b16 v[178:179], v6 offset:30208
v_mfma_f32_16x16x32_bf16 v[72:75], v[152:155], v[120:123], v[72:75]
ds_read_b64_tr_b16 v[180:181], v7 offset:29696
v_mfma_f32_16x16x32_bf16 v[96:99], v[152:155], v[124:127], v[96:99]
ds_read_b64_tr_b16 v[182:183], v7 offset:30208
v_mfma_f32_16x16x32_bf16 v[28:31], v[156:159], v[112:115], v[28:31]
ds_read_b64_tr_b16 v[184:185], v6 offset:30720
v_mfma_f32_16x16x32_bf16 v[52:55], v[156:159], v[116:119], v[52:55]
ds_read_b64_tr_b16 v[186:187], v6 offset:31232
v_mfma_f32_16x16x32_bf16 v[76:79], v[156:159], v[120:123], v[76:79]
ds_read_b64_tr_b16 v[188:189], v7 offset:30720
v_mfma_f32_16x16x32_bf16 v[100:103], v[156:159], v[124:127], v[100:103]
ds_read_b64_tr_b16 v[190:191], v7 offset:31232
v_mfma_f32_16x16x32_bf16 v[32:35], v[112:115], v[160:163], v[32:35]
v_mfma_f32_16x16x32_bf16 v[56:59], v[116:119], v[160:163], v[56:59]
v_mfma_f32_16x16x32_bf16 v[80:83], v[120:123], v[160:163], v[80:83]
v_mfma_f32_16x16x32_bf16 v[104:107], v[124:127], v[160:163], v[104:107]
v_mfma_f32_16x16x32_bf16 v[36:39], v[112:115], v[164:167], v[36:39]
v_mfma_f32_16x16x32_bf16 v[60:63], v[116:119], v[164:167], v[60:63]
v_mfma_f32_16x16x32_bf16 v[84:87], v[120:123], v[164:167], v[84:87]
v_mfma_f32_16x16x32_bf16 v[108:111], v[124:127], v[164:167], v[108:111]
v_mfma_f32_16x16x32_bf16 v[196:199], v[144:147], v[192:195], 0
v_mfma_f32_16x16x32_bf16 v[200:203], v[148:151], v[192:195], 0
v_mfma_f32_16x16x32_bf16 v[204:207], v[152:155], v[192:195], 0
v_mfma_f32_16x16x32_bf16 v[208:211], v[156:159], v[192:195], 0
v_mfma_f32_16x16x32_bf16 v[212:215], v[160:163], v[192:195], 0
v_mfma_f32_16x16x32_bf16 v[216:219], v[164:167], v[192:195], 0
v_mfma_f32_16x16x32_bf16 v[220:223], v[192:195], v[112:115], 0
v_mfma_f32_16x16x32_bf16 v[236:239], v[112:115], v[112:115], 0
v_mfma_f32_16x16x32_bf16 v[224:227], v[192:195], v[116:119], 0
v_mfma_f32_16x16x32_bf16 v[240:243], v[116:119], v[116:119], 0
v_mfma_f32_16x16x32_bf16 v[228:231], v[192:195], v[120:123], 0
v_mfma_f32_16x16x32_bf16 v[244:247], v[120:123], v[120:123], 0
v_mfma_f32_16x16x32_bf16 v[232:235], v[192:195], v[124:127], 0
v_mfma_f32_16x16x32_bf16 v[248:251], v[124:127], v[124:127], 0
s_waitcnt lgkmcnt(0)
s_add_u32 s67, s67, 1
s_cmp_eq_u32 s67, 3
s_cselect_b32 s66, s69, s68
s_cselect_b32 s67, 0, s67
v_add_u32 v2, s66, v2
v_add_u32 v3, s66, v3
v_add_u32 v6, s66, v6
v_add_u32 v7, s66, v7
s_barrier
v_mfma_f32_16x16x32_bf16 v[16:19], v[168:171], v[128:131], v[16:19]
ds_read_b64_tr_b16 v[144:145], v6 offset:16384
v_mfma_f32_16x16x32_bf16 v[40:43], v[168:171], v[132:135], v[40:43]
ds_read_b64_tr_b16 v[146:147], v6 offset:16896
v_mfma_f32_16x16x32_bf16 v[64:67], v[168:171], v[136:139], v[64:67]
ds_read_b128 v[112:115], v2 offset:0
v_mfma_f32_16x16x32_bf16 v[88:91], v[168:171], v[140:143], v[88:91]
ds_read_b128 v[116:119], v2 offset:2048
v_mfma_f32_16x16x32_bf16 v[20:23], v[172:175], v[128:131], v[20:23]
ds_read_b128 v[120:123], v2 offset:4096
v_mfma_f32_16x16x32_bf16 v[44:47], v[172:175], v[132:135], v[44:47]
ds_read_b128 v[124:127], v2 offset:6144
v_mfma_f32_16x16x32_bf16 v[68:71], v[172:175], v[136:139], v[68:71]
ds_read_b64_tr_b16 v[148:149], v7 offset:16384
v_mfma_f32_16x16x32_bf16 v[92:95], v[172:175], v[140:143], v[92:95]
ds_read_b64_tr_b16 v[150:151], v7 offset:16896
v_mfma_f32_16x16x32_bf16 v[24:27], v[176:179], v[128:131], v[24:27]
ds_read_b64_tr_b16 v[152:153], v6 offset:17408
v_mfma_f32_16x16x32_bf16 v[48:51], v[176:179], v[132:135], v[48:51]
ds_read_b64_tr_b16 v[154:155], v6 offset:17920
v_mfma_f32_16x16x32_bf16 v[72:75], v[176:179], v[136:139], v[72:75]
ds_read_b64_tr_b16 v[156:157], v7 offset:17408
v_mfma_f32_16x16x32_bf16 v[96:99], v[176:179], v[140:143], v[96:99]
ds_read_b64_tr_b16 v[158:159], v7 offset:17920
v_mfma_f32_16x16x32_bf16 v[28:31], v[180:183], v[128:131], v[28:31]
ds_read_b64_tr_b16 v[160:161], v6 offset:18432
v_mfma_f32_16x16x32_bf16 v[52:55], v[180:183], v[132:135], v[52:55]
ds_read_b64_tr_b16 v[162:163], v6 offset:18944
v_mfma_f32_16x16x32_bf16 v[76:79], v[180:183], v[136:139], v[76:79]
ds_read_b64_tr_b16 v[164:165], v7 offset:18432
v_mfma_f32_16x16x32_bf16 v[100:103], v[180:183], v[140:143], v[100:103]
ds_read_b64_tr_b16 v[166:167], v7 offset:18944
v_mfma_f32_16x16x32_bf16 v[32:35], v[128:131], v[184:187], v[32:35]
v_mfma_f32_16x16x32_bf16 v[56:59], v[132:135], v[184:187], v[56:59]
v_mfma_f32_16x16x32_bf16 v[80:83], v[136:139], v[184:187], v[80:83]
v_mfma_f32_16x16x32_bf16 v[104:107], v[140:143], v[184:187], v[104:107]
v_mfma_f32_16x16x32_bf16 v[36:39], v[128:131], v[188:191], v[36:39]
v_mfma_f32_16x16x32_bf16 v[60:63], v[132:135], v[188:191], v[60:63]
v_mfma_f32_16x16x32_bf16 v[84:87], v[136:139], v[188:191], v[84:87]
v_mfma_f32_16x16x32_bf16 v[108:111], v[140:143], v[188:191], v[108:111]
v_mfma_f32_16x16x32_bf16 v[196:199], v[168:171], v[192:195], v[196:199]
v_mfma_f32_16x16x32_bf16 v[200:203], v[172:175], v[192:195], v[200:203]
v_mfma_f32_16x16x32_bf16 v[204:207], v[176:179], v[192:195], v[204:207]
v_mfma_f32_16x16x32_bf16 v[208:211], v[180:183], v[192:195], v[208:211]
v_mfma_f32_16x16x32_bf16 v[212:215], v[184:187], v[192:195], v[212:215]
v_mfma_f32_16x16x32_bf16 v[216:219], v[188:191], v[192:195], v[216:219]
v_mfma_f32_16x16x32_bf16 v[220:223], v[192:195], v[128:131], v[220:223]
v_mfma_f32_16x16x32_bf16 v[236:239], v[128:131], v[128:131], v[236:239]
v_mfma_f32_16x16x32_bf16 v[224:227], v[192:195], v[132:135], v[224:227]
v_mfma_f32_16x16x32_bf16 v[240:243], v[132:135], v[132:135], v[240:243]
v_mfma_f32_16x16x32_bf16 v[228:231], v[192:195], v[136:139], v[228:231]
v_mfma_f32_16x16x32_bf16 v[244:247], v[136:139], v[136:139], v[244:247]
v_mfma_f32_16x16x32_bf16 v[232:235], v[192:195], v[140:143], v[232:235]
v_mfma_f32_16x16x32_bf16 v[248:251], v[140:143], v[140:143], v[248:251]
v_lshrrev_b32 v11, 4, v1
v_and_b32 v10, 15, v1
s_cmp_lg_u32 s6, 0
s_cbranch_scc1 p1a0_nocs
s_lshl_b32 s70, s7, 7
s_add_u32 s70, s70, 137216
v_lshlrev_b32 v8, 4, v11
v_add_u32 v8, s70, v8
s_mov_b32 exec_lo, 0x00010001
s_mov_b32 exec_hi, 0x00010001
ds_write_b128 v8, v[196:199] offset:0
ds_write_b128 v8, v[200:203] offset:64
ds_write_b128 v8, v[204:207] offset:256
ds_write_b128 v8, v[208:211] offset:320
ds_write_b128 v8, v[212:215] offset:512
ds_write_b128 v8, v[216:219] offset:576
s_mov_b64 exec, -1
p1a0_nocs:
s_cmp_lg_u32 s7, 0
s_cbranch_scc1 p1a0_nors
v_and_b32 v8, 3, v10
v_cmp_eq_u32 s[72:73], 1, v8
v_cmp_eq_u32 s[74:75], 2, v8
v_cmp_eq_u32 s[76:77], 3, v8
s_lshl_b32 s70, s6, 9
s_add_u32 s70, s70, 135424
v_lshlrev_b32 v9, 3, v10
v_add_u32 v9, s70, v9
v_cndmask_b32 v221, v236, v237, s[72:73]
v_cndmask_b32 v221, v221, v238, s[74:75]
v_cndmask_b32 v221, v221, v239, s[76:77]
v_cndmask_b32 v225, v240, v241, s[72:73]
v_cndmask_b32 v225, v225, v242, s[74:75]
v_cndmask_b32 v225, v225, v243, s[76:77]
v_cndmask_b32 v229, v244, v245, s[72:73]
v_cndmask_b32 v229, v229, v246, s[74:75]
v_cndmask_b32 v229, v229, v247, s[76:77]
v_cndmask_b32 v233, v248, v249, s[72:73]
v_cndmask_b32 v233, v233, v250, s[74:75]
v_cndmask_b32 v233, v233, v251, s[76:77]
s_mov_b32 exec_lo, 0x00f0000f
s_mov_b32 exec_hi, 0xf0000f00
ds_write_b64 v9, v[220:221] offset:0
ds_write_b64 v9, v[224:225] offset:128
ds_write_b64 v9, v[228:229] offset:256
ds_write_b64 v9, v[232:233] offset:384
s_mov_b64 exec, -1
p1a0_nors:
s_mov_b32 s65, 5
p1_loop:
s_waitcnt lgkmcnt(0)
s_nop 1
v_mfma_f32_16x16x32_bf16 v[16:19], v[144:147], v[112:115], v[16:19]
ds_read_b64_tr_b16 v[168:169], v6 offset:28672
v_mfma_f32_16x16x32_bf16 v[40:43], v[144:147], v[116:119], v[40:43]
ds_read_b64_tr_b16 v[170:171], v6 offset:29184
v_mfma_f32_16x16x32_bf16 v[64:67], v[144:147], v[120:123], v[64:67]
ds_read_b128 v[128:131], v3 offset:0
v_mfma_f32_16x16x32_bf16 v[88:91], v[144:147], v[124:127], v[88:91]
ds_read_b128 v[132:135], v3 offset:2048
v_mfma_f32_16x16x32_bf16 v[20:23], v[148:151], v[112:115], v[20:23]
ds_read_b128 v[136:139], v3 offset:4096
v_mfma_f32_16x16x32_bf16 v[44:47], v[148:151], v[116:119], v[44:47]
ds_read_b128 v[140:143], v3 offset:6144
v_mfma_f32_16x16x32_bf16 v[68:71], v[148:151], v[120:123], v[68:71]
ds_read_b64_tr_b16 v[172:173], v7 offset:28672
v_mfma_f32_16x16x32_bf16 v[92:95], v[148:151], v[124:127], v[92:95]
ds_read_b64_tr_b16 v[174:175], v7 offset:29184
v_mfma_f32_16x16x32_bf16 v[24:27], v[152:155], v[112:115], v[24:27]
ds_read_b64_tr_b16 v[176:177], v6 offset:29696
v_mfma_f32_16x16x32_bf16 v[48:51], v[152:155], v[116:119], v[48:51]
ds_read_b64_tr_b16 v[178:179], v6 offset:30208
v_mfma_f32_16x16x32_bf16 v[72:75], v[152:155], v[120:123], v[72:75]
ds_read_b64_tr_b16 v[180:181], v7 offset:29696
v_mfma_f32_16x16x32_bf16 v[96:99], v[152:155], v[124:127], v[96:99]
ds_read_b64_tr_b16 v[182:183], v7 offset:30208
v_mfma_f32_16x16x32_bf16 v[28:31], v[156:159], v[112:115], v[28:31]
ds_read_b64_tr_b16 v[184:185], v6 offset:30720
v_mfma_f32_16x16x32_bf16 v[52:55], v[156:159], v[116:119], v[52:55]
ds_read_b64_tr_b16 v[186:187], v6 offset:31232
v_mfma_f32_16x16x32_bf16 v[76:79], v[156:159], v[120:123], v[76:79]
ds_read_b64_tr_b16 v[188:189], v7 offset:30720
v_mfma_f32_16x16x32_bf16 v[100:103], v[156:159], v[124:127], v[100:103]
ds_read_b64_tr_b16 v[190:191], v7 offset:31232
v_mfma_f32_16x16x32_bf16 v[32:35], v[112:115], v[160:163], v[32:35]
v_mfma_f32_16x16x32_bf16 v[56:59], v[116:119], v[160:163], v[56:59]
v_mfma_f32_16x16x32_bf16 v[80:83], v[120:123], v[160:163], v[80:83]
v_mfma_f32_16x16x32_bf16 v[104:107], v[124:127], v[160:163], v[104:107]
v_mfma_f32_16x16x32_bf16 v[36:39], v[112:115], v[164:167], v[36:39]
v_mfma_f32_16x16x32_bf16 v[60:63], v[116:119], v[164:167], v[60:63]
v_mfma_f32_16x16x32_bf16 v[84:87], v[120:123], v[164:167], v[84:87]
v_mfma_f32_16x16x32_bf16 v[108:111], v[124:127], v[164:167], v[108:111]
s_waitcnt lgkmcnt(0)
s_add_u32 s67, s67, 1
s_cmp_eq_u32 s67, 3
s_cselect_b32 s66, s69, s68
s_cselect_b32 s67, 0, s67
v_add_u32 v2, s66, v2
v_add_u32 v3, s66, v3
v_add_u32 v6, s66, v6
v_add_u32 v7, s66, v7
s_barrier
v_mfma_f32_16x16x32_bf16 v[16:19], v[168:171], v[128:131], v[16:19]
ds_read_b64_tr_b16 v[144:145], v6 offset:16384
v_mfma_f32_16x16x32_bf16 v[40:43], v[168:171], v[132:135], v[40:43]
ds_read_b64_tr_b16 v[146:147], v6 offset:16896
v_mfma_f32_16x16x32_bf16 v[64:67], v[168:171], v[136:139], v[64:67]
ds_read_b128 v[112:115], v2 offset:0
v_mfma_f32_16x16x32_bf16 v[88:91], v[168:171], v[140:143], v[88:91]
ds_read_b128 v[116:119], v2 offset:2048
v_mfma_f32_16x16x32_bf16 v[20:23], v[172:175], v[128:131], v[20:23]
ds_read_b128 v[120:123], v2 offset:4096
v_mfma_f32_16x16x32_bf16 v[44:47], v[172:175], v[132:135], v[44:47]
ds_read_b128 v[124:127], v2 offset:6144
v_mfma_f32_16x16x32_bf16 v[68:71], v[172:175], v[136:139], v[68:71]
ds_read_b64_tr_b16 v[148:149], v7 offset:16384
v_mfma_f32_16x16x32_bf16 v[92:95], v[172:175], v[140:143], v[92:95]
ds_read_b64_tr_b16 v[150:151], v7 offset:16896
v_mfma_f32_16x16x32_bf16 v[24:27], v[176:179], v[128:131], v[24:27]
ds_read_b64_tr_b16 v[152:153], v6 offset:17408
v_mfma_f32_16x16x32_bf16 v[48:51], v[176:179], v[132:135], v[48:51]
ds_read_b64_tr_b16 v[154:155], v6 offset:17920
v_mfma_f32_16x16x32_bf16 v[72:75], v[176:179], v[136:139], v[72:75]
ds_read_b64_tr_b16 v[156:157], v7 offset:17408
v_mfma_f32_16x16x32_bf16 v[96:99], v[176:179], v[140:143], v[96:99]
ds_read_b64_tr_b16 v[158:159], v7 offset:17920
v_mfma_f32_16x16x32_bf16 v[28:31], v[180:183], v[128:131], v[28:31]
ds_read_b64_tr_b16 v[160:161], v6 offset:18432
v_mfma_f32_16x16x32_bf16 v[52:55], v[180:183], v[132:135], v[52:55]
ds_read_b64_tr_b16 v[162:163], v6 offset:18944
v_mfma_f32_16x16x32_bf16 v[76:79], v[180:183], v[136:139], v[76:79]
ds_read_b64_tr_b16 v[164:165], v7 offset:18432
v_mfma_f32_16x16x32_bf16 v[100:103], v[180:183], v[140:143], v[100:103]
ds_read_b64_tr_b16 v[166:167], v7 offset:18944
v_mfma_f32_16x16x32_bf16 v[32:35], v[128:131], v[184:187], v[32:35]
v_mfma_f32_16x16x32_bf16 v[56:59], v[132:135], v[184:187], v[56:59]
v_mfma_f32_16x16x32_bf16 v[80:83], v[136:139], v[184:187], v[80:83]
v_mfma_f32_16x16x32_bf16 v[104:107], v[140:143], v[184:187], v[104:107]
v_mfma_f32_16x16x32_bf16 v[36:39], v[128:131], v[188:191], v[36:39]
v_mfma_f32_16x16x32_bf16 v[60:63], v[132:135], v[188:191], v[60:63]
v_mfma_f32_16x16x32_bf16 v[84:87], v[136:139], v[188:191], v[84:87]
v_mfma_f32_16x16x32_bf16 v[108:111], v[140:143], v[188:191], v[108:111]
s_add_u32 s65, s65, 1
s_cmp_lt_u32 s65, 16
s_cbranch_scc1 p1_loop
s_waitcnt lgkmcnt(0)
v_mov_b32 v14, 163776
ds_read_b64 v[8:9], v14
s_mov_b32 s94, 0x3fb8aa3b
s_mov_b32 s95, 0x3fb8aa3b
s_add_u32 s40, s8, 0x400000
s_addc_u32 s41, s9, 0
s_mov_b32 s42, 0x200000
s_mov_b32 s43, 0x20000
s_add_u32 s44, s8, 0x700000
s_addc_u32 s45, s9, 0
s_mov_b32 s46, 0x20000
s_mov_b32 s47, 0x20000
v_lshrrev_b32 v11, 4, v1
v_bfe_u32 v12, v1, 2, 2
v_and_b32 v13, 3, v1
v_lshlrev_b32 v14, 8, v11
v_lshl_add_u32 v14, v12, 6, v14
v_lshl_add_u32 v14, v13, 3, v14
s_lshl_b32 s70, s7, 11
s_add_u32 s70, s70, 122880
v_add_u32 v14, s70, v14
ds_read_b64_tr_b16 v[112:113], v14 offset:0
ds_read_b64_tr_b16 v[114:115], v14 offset:1024
ds_read_b64_tr_b16 v[116:117], v14 offset:32
ds_read_b64_tr_b16 v[118:119], v14 offset:1056
v_and_b32 v10, 15, v1
v_bfe_u32 v12, v1, 2, 2
v_and_b32 v13, 3, v1
s_lshl_b32 s70, s6, 9
s_add_u32 s70, s70, 135424
v_lshlrev_b32 v14, 3, v10
v_add_u32 v14, s70, v14
ds_read_b64 v[192:193], v14 offset:0
ds_read_b64 v[194:195], v14 offset:128
ds_read_b64 v[196:197], v14 offset:256
ds_read_b64 v[198:199], v14 offset:384
s_lshl_b32 s71, s7, 7
s_add_u32 s71, s71, 136448
v_lshlrev_b32 v15, 4, v11
v_add_u32 v15, s71, v15
ds_read_b128 v[232:235], v15 offset:0
ds_read_b128 v[236:239], v15 offset:64
ds_read_b128 v[240:243], v15 offset:256
ds_read_b128 v[244:247], v15 offset:320
v_lshlrev_b32 v14, 5, v11
v_add_u32 v14, s70, v14
ds_read_b128 v[200:203], v14 offset:0
ds_read_b128 v[204:207], v14 offset:16
ds_read_b128 v[208:211], v14 offset:128
ds_read_b128 v[212:215], v14 offset:144
ds_read_b128 v[216:219], v14 offset:256
ds_read_b128 v[220:223], v14 offset:272
ds_read_b128 v[224:227], v14 offset:384
ds_read_b128 v[228:231], v14 offset:400
v_lshlrev_b32 v14, 2, v10
v_add_u32 v14, s71, v14
ds_read_b32 v248, v14 offset:512
ds_read_b32 v249, v14 offset:576
v_lshlrev_b32 v15, 4, v1
s_lshl_b32 s70, s3, 13
s_add_u32 s70, s70, 65536
v_add_u32 v15, s70, v15
ds_write_b128 v15, v[64:67] offset:2048
ds_write_b128 v15, v[68:71] offset:3072
ds_write_b128 v15, v[88:91] offset:4096
ds_write_b128 v15, v[92:95] offset:5120
s_waitcnt lgkmcnt(0)
v_readfirstlane_b32 s28, v8
v_readfirstlane_b32 s29, v9
v_pk_mul_f32 v[250:251], v[240:241], v[196:197] op_sel:[0,1] op_sel_hi:[1,1]
v_pk_mul_f32 v[252:253], v[242:243], v[196:197] op_sel:[0,1] op_sel_hi:[1,1]
v_pk_fma_f32 v[72:73], v[72:73], v[196:197], v[250:251] op_sel:[0,0,0] op_sel_hi:[1,0,1]
v_pk_fma_f32 v[74:75], v[74:75], v[196:197], v[252:253] op_sel:[0,0,0] op_sel_hi:[1,0,1]
v_pk_mul_f32 v[250:251], v[244:245], v[196:197] op_sel:[0,1] op_sel_hi:[1,1]
v_pk_mul_f32 v[252:253], v[246:247], v[196:197] op_sel:[0,1] op_sel_hi:[1,1]
v_pk_fma_f32 v[76:77], v[76:77], v[196:197], v[250:251] op_sel:[0,0,0] op_sel_hi:[1,0,1]
v_pk_fma_f32 v[78:79], v[78:79], v[196:197], v[252:253] op_sel:[0,0,0] op_sel_hi:[1,0,1]
v_cvt_pk_bf16_f32 v144, v72, v73
v_cvt_pk_bf16_f32 v145, v74, v75
v_cvt_pk_bf16_f32 v146, v76, v77
v_cvt_pk_bf16_f32 v147, v78, v79
ds_write_b128 v15, v[144:147] offset:0
v_pk_mul_f32 v[250:251], v[240:241], v[198:199] op_sel:[0,1] op_sel_hi:[1,1]
v_pk_mul_f32 v[252:253], v[242:243], v[198:199] op_sel:[0,1] op_sel_hi:[1,1]
v_pk_fma_f32 v[96:97], v[96:97], v[198:199], v[250:251] op_sel:[0,0,0] op_sel_hi:[1,0,1]
v_pk_fma_f32 v[98:99], v[98:99], v[198:199], v[252:253] op_sel:[0,0,0] op_sel_hi:[1,0,1]
v_pk_mul_f32 v[250:251], v[244:245], v[198:199] op_sel:[0,1] op_sel_hi:[1,1]
v_pk_mul_f32 v[252:253], v[246:247], v[198:199] op_sel:[0,1] op_sel_hi:[1,1]
v_pk_fma_f32 v[100:101], v[100:101], v[198:199], v[250:251] op_sel:[0,0,0] op_sel_hi:[1,0,1]
v_pk_fma_f32 v[102:103], v[102:103], v[198:199], v[252:253] op_sel:[0,0,0] op_sel_hi:[1,0,1]
v_cvt_pk_bf16_f32 v148, v96, v97
v_cvt_pk_bf16_f32 v149, v98, v99
v_cvt_pk_bf16_f32 v150, v100, v101
v_cvt_pk_bf16_f32 v151, v102, v103
ds_write_b128 v15, v[148:151] offset:1024
v_pk_mul_f32 v[250:251], v[240:241], v[192:193] op_sel:[0,1] op_sel_hi:[1,1]
v_pk_mul_f32 v[252:253], v[242:243], v[192:193] op_sel:[0,1] op_sel_hi:[1,1]
v_pk_fma_f32 v[24:25], v[24:25], v[192:193], v[250:251] op_sel:[0,0,0] op_sel_hi:[1,0,1]
v_pk_fma_f32 v[26:27], v[26:27], v[192:193], v[252:253] op_sel:[0,0,0] op_sel_hi:[1,0,1]
v_pk_mul_f32 v[250:251], v[244:245], v[192:193] op_sel:[0,1] op_sel_hi:[1,1]
v_pk_mul_f32 v[252:253], v[246:247], v[192:193] op_sel:[0,1] op_sel_hi:[1,1]
v_pk_fma_f32 v[28:29], v[28:29], v[192:193], v[250:251] op_sel:[0,0,0] op_sel_hi:[1,0,1]
v_pk_fma_f32 v[30:31], v[30:31], v[192:193], v[252:253] op_sel:[0,0,0] op_sel_hi:[1,0,1]
v_cvt_pk_bf16_f32 v136, v24, v25
v_cvt_pk_bf16_f32 v137, v26, v27
v_cvt_pk_bf16_f32 v138, v28, v29
v_cvt_pk_bf16_f32 v139, v30, v31
v_pk_mul_f32 v[250:251], v[240:241], v[194:195] op_sel:[0,1] op_sel_hi:[1,1]
v_pk_mul_f32 v[252:253], v[242:243], v[194:195] op_sel:[0,1] op_sel_hi:[1,1]
v_pk_fma_f32 v[48:49], v[48:49], v[194:195], v[250:251] op_sel:[0,0,0] op_sel_hi:[1,0,1]
v_pk_fma_f32 v[50:51], v[50:51], v[194:195], v[252:253] op_sel:[0,0,0] op_sel_hi:[1,0,1]
v_pk_mul_f32 v[250:251], v[244:245], v[194:195] op_sel:[0,1] op_sel_hi:[1,1]
v_pk_mul_f32 v[252:253], v[246:247], v[194:195] op_sel:[0,1] op_sel_hi:[1,1]
v_pk_fma_f32 v[52:53], v[52:53], v[194:195], v[250:251] op_sel:[0,0,0] op_sel_hi:[1,0,1]
v_pk_fma_f32 v[54:55], v[54:55], v[194:195], v[252:253] op_sel:[0,0,0] op_sel_hi:[1,0,1]
v_cvt_pk_bf16_f32 v140, v48, v49
v_cvt_pk_bf16_f32 v141, v50, v51
v_cvt_pk_bf16_f32 v142, v52, v53
v_cvt_pk_bf16_f32 v143, v54, v55
v_pk_mul_f32 v[250:251], v[232:233], v[192:193] op_sel:[0,1] op_sel_hi:[1,1]
v_pk_mul_f32 v[252:253], v[234:235], v[192:193] op_sel:[0,1] op_sel_hi:[1,1]
v_pk_fma_f32 v[16:17], v[16:17], v[192:193], v[250:251] op_sel:[0,0,0] op_sel_hi:[1,0,1]
v_pk_fma_f32 v[18:19], v[18:19], v[192:193], v[252:253] op_sel:[0,0,0] op_sel_hi:[1,0,1]
v_pk_mul_f32 v[250:251], v[236:237], v[192:193] op_sel:[0,1] op_sel_hi:[1,1]
v_pk_mul_f32 v[252:253], v[238:239], v[192:193] op_sel:[0,1] op_sel_hi:[1,1]
v_pk_fma_f32 v[20:21], v[20:21], v[192:193], v[250:251] op_sel:[0,0,0] op_sel_hi:[1,0,1]
v_pk_fma_f32 v[22:23], v[22:23], v[192:193], v[252:253] op_sel:[0,0,0] op_sel_hi:[1,0,1]
v_cvt_pk_bf16_f32 v120, v16, v17
v_cvt_pk_bf16_f32 v121, v18, v19
v_cvt_pk_bf16_f32 v122, v20, v21
v_cvt_pk_bf16_f32 v123, v22, v23
v_pk_mul_f32 v[250:251], v[232:233], v[194:195] op_sel:[0,1] op_sel_hi:[1,1]
v_pk_mul_f32 v[252:253], v[234:235], v[194:195] op_sel:[0,1] op_sel_hi:[1,1]
v_pk_fma_f32 v[40:41], v[40:41], v[194:195], v[250:251] op_sel:[0,0,0] op_sel_hi:[1,0,1]
v_pk_fma_f32 v[42:43], v[42:43], v[194:195], v[252:253] op_sel:[0,0,0] op_sel_hi:[1,0,1]
v_pk_mul_f32 v[250:251], v[236:237], v[194:195] op_sel:[0,1] op_sel_hi:[1,1]
v_pk_mul_f32 v[252:253], v[238:239], v[194:195] op_sel:[0,1] op_sel_hi:[1,1]
v_pk_fma_f32 v[44:45], v[44:45], v[194:195], v[250:251] op_sel:[0,0,0] op_sel_hi:[1,0,1]
v_pk_fma_f32 v[46:47], v[46:47], v[194:195], v[252:253] op_sel:[0,0,0] op_sel_hi:[1,0,1]
v_cvt_pk_bf16_f32 v124, v40, v41
v_cvt_pk_bf16_f32 v125, v42, v43
v_cvt_pk_bf16_f32 v126, v44, v45
v_cvt_pk_bf16_f32 v127, v46, v47
s_waitcnt lgkmcnt(0)
s_barrier
v_mul_f32 v250, v201, v248
v_mul_f32 v251, v203, v248
v_mul_f32 v252, v205, v248
v_mul_f32 v253, v207, v248
v_fma_f32 v32, v32, v200, v250
v_fma_f32 v33, v33, v202, v251
v_fma_f32 v34, v34, v204, v252
v_fma_f32 v35, v35, v206, v253
v_mul_f32 v250, v201, v249
v_mul_f32 v251, v203, v249
v_mul_f32 v252, v205, v249
v_mul_f32 v253, v207, v249
v_fma_f32 v36, v36, v200, v250
v_fma_f32 v37, v37, v202, v251
v_fma_f32 v38, v38, v204, v252
v_fma_f32 v39, v39, v206, v253
v_mul_f32 v250, v209, v248
v_mul_f32 v251, v211, v248
v_mul_f32 v252, v213, v248
v_mul_f32 v253, v215, v248
v_fma_f32 v56, v56, v208, v250
v_fma_f32 v57, v57, v210, v251
v_fma_f32 v58, v58, v212, v252
v_fma_f32 v59, v59, v214, v253
v_mul_f32 v250, v209, v249
v_mul_f32 v251, v211, v249
v_mul_f32 v252, v213, v249
v_mul_f32 v253, v215, v249
v_fma_f32 v60, v60, v208, v250
v_fma_f32 v61, v61, v210, v251
v_fma_f32 v62, v62, v212, v252
v_fma_f32 v63, v63, v214, v253
v_mul_f32 v250, v217, v248
v_mul_f32 v251, v219, v248
v_mul_f32 v252, v221, v248
v_mul_f32 v253, v223, v248
v_fma_f32 v80, v80, v216, v250
v_fma_f32 v81, v81, v218, v251
v_fma_f32 v82, v82, v220, v252
v_fma_f32 v83, v83, v222, v253
v_mul_f32 v250, v217, v249
v_mul_f32 v251, v219, v249
v_mul_f32 v252, v221, v249
v_mul_f32 v253, v223, v249
v_fma_f32 v84, v84, v216, v250
v_fma_f32 v85, v85, v218, v251
v_fma_f32 v86, v86, v220, v252
v_fma_f32 v87, v87, v222, v253
v_mul_f32 v250, v225, v248
v_mul_f32 v251, v227, v248
v_mul_f32 v252, v229, v248
v_mul_f32 v253, v231, v248
v_fma_f32 v104, v104, v224, v250
v_fma_f32 v105, v105, v226, v251
v_fma_f32 v106, v106, v228, v252
v_fma_f32 v107, v107, v230, v253
v_mul_f32 v250, v225, v249
v_mul_f32 v251, v227, v249
v_mul_f32 v252, v229, v249
v_mul_f32 v253, v231, v249
v_fma_f32 v108, v108, v224, v250
v_fma_f32 v109, v109, v226, v251
v_fma_f32 v110, v110, v228, v252
v_fma_f32 v111, v111, v230, v253
v_cvt_pk_bf16_f32 v152, v32, v33
v_cvt_pk_bf16_f32 v153, v34, v35
v_cvt_pk_bf16_f32 v154, v56, v57
v_cvt_pk_bf16_f32 v155, v58, v59
v_cvt_pk_bf16_f32 v156, v36, v37
v_cvt_pk_bf16_f32 v157, v38, v39
v_cvt_pk_bf16_f32 v158, v60, v61
v_cvt_pk_bf16_f32 v159, v62, v63
v_cvt_pk_bf16_f32 v160, v80, v81
v_cvt_pk_bf16_f32 v161, v82, v83
v_cvt_pk_bf16_f32 v162, v104, v105
v_cvt_pk_bf16_f32 v163, v106, v107
v_cvt_pk_bf16_f32 v164, v84, v85
v_cvt_pk_bf16_f32 v165, v86, v87
v_cvt_pk_bf16_f32 v166, v108, v109
v_cvt_pk_bf16_f32 v167, v110, v111
s_lshl_b32 s70, s3, 13
v_bfe_u32 v14, v10, 1, 2
v_bfe_u32 v15, v10, 2, 1
v_lshl_or_b32 v14, v15, 2, v14
v_xor_b32 v14, v14, v11
v_lshlrev_b32 v15, 6, v10
v_lshl_add_u32 v15, v14, 3, v15
v_add_u32 v8, s70, v15
v_xor_b32 v9, 32, v8
s_lshl_b32 s70, s3, 13
v_lshl_add_u32 v14, v11, 2, v12
v_bfe_u32 v15, v14, 1, 2
v_bfe_u32 v2, v14, 2, 1
v_lshl_or_b32 v15, v2, 2, v15
v_xor_b32 v15, v15, v13
v_lshlrev_b32 v14, 6, v14
v_lshl_add_u32 v14, v15, 3, v14
v_add_u32 v4, s70, v14
v_xor_b32 v5, 32, v4
v_mov_b32 v168, 0x3f803f80
v_mov_b32 v169, 0x3f803f80
v_mov_b32 v170, 0x3f803f80
v_mov_b32 v171, 0x3f803f80
v_mfma_f32_16x16x32_bf16 v[16:19], v[112:115], v[136:139], 0
v_mfma_f32_16x16x32_bf16 v[20:23], v[116:119], v[136:139], 0
v_mfma_f32_16x16x32_bf16 v[48:51], v[112:115], v[140:143], 0
v_mfma_f32_16x16x32_bf16 v[52:55], v[116:119], v[140:143], 0
s_nop 4
v_max3_f32 v32, v16, v17, v18
s_nop 0
v_max3_f32 v64, v48, v49, v50
v_min3_f32 v34, v16, v17, v18
v_min3_f32 v66, v48, v49, v50
v_max3_f32 v32, v32, v19, v20
v_max3_f32 v64, v64, v51, v52
v_min3_f32 v34, v34, v19, v20
v_min3_f32 v66, v66, v51, v52
v_max3_f32 v32, v32, v21, v22
v_max3_f32 v64, v64, v53, v54
v_min3_f32 v34, v34, v21, v22
v_min3_f32 v66, v66, v53, v54
v_max_f32 v32, v32, v23
v_max_f32 v64, v64, v55
v_min_f32 v34, v34, v23
v_min_f32 v66, v66, v55
v_mov_b32 v36, v32
v_mov_b32 v68, v64
v_mov_b32 v37, v34
v_mov_b32 v69, v66
v_permlane16_swap_b32 v32, v36
v_permlane16_swap_b32 v64, v68
v_permlane16_swap_b32 v34, v37
v_permlane16_swap_b32 v66, v69
v_max_f32 v32, v32, v36
v_max_f32 v64, v64, v68
v_min_f32 v34, v34, v37
v_min_f32 v66, v66, v69
v_mov_b32 v36, v32
v_mov_b32 v68, v64
v_mov_b32 v37, v34
v_mov_b32 v69, v66
v_permlane32_swap_b32 v32, v36
v_permlane32_swap_b32 v64, v68
v_permlane32_swap_b32 v34, v37
v_permlane32_swap_b32 v66, v69
v_max_f32 v32, v32, v36
v_max_f32 v64, v64, v68
v_min_f32 v34, v34, v37
v_min_f32 v66, v66, v69
v_mul_f32 v32, s94, v32
v_mul_f32 v64, s94, v64
v_mul_f32 v34, s94, v34
v_mul_f32 v66, s94, v66
v_pk_fma_f32 v[24:25], v[16:17], s[94:95], v[32:33] op_sel_hi:[1,1,0] neg_lo:[0,0,1] neg_hi:[0,0,1]
v_pk_fma_f32 v[56:57], v[48:49], s[94:95], v[64:65] op_sel_hi:[1,1,0] neg_lo:[0,0,1] neg_hi:[0,0,1]
v_pk_fma_f32 v[16:17], v[16:17], s[94:95], v[34:35] op_sel_hi:[1,1,0] neg_lo:[1,0,0] neg_hi:[1,0,0]
v_pk_fma_f32 v[48:49], v[48:49], s[94:95], v[66:67] op_sel_hi:[1,1,0] neg_lo:[1,0,0] neg_hi:[1,0,0]
v_pk_fma_f32 v[26:27], v[18:19], s[94:95], v[32:33] op_sel_hi:[1,1,0] neg_lo:[0,0,1] neg_hi:[0,0,1]
v_pk_fma_f32 v[58:59], v[50:51], s[94:95], v[64:65] op_sel_hi:[1,1,0] neg_lo:[0,0,1] neg_hi:[0,0,1]
v_pk_fma_f32 v[18:19], v[18:19], s[94:95], v[34:35] op_sel_hi:[1,1,0] neg_lo:[1,0,0] neg_hi:[1,0,0]
v_pk_fma_f32 v[50:51], v[50:51], s[94:95], v[66:67] op_sel_hi:[1,1,0] neg_lo:[1,0,0] neg_hi:[1,0,0]
v_pk_fma_f32 v[28:29], v[20:21], s[94:95], v[32:33] op_sel_hi:[1,1,0] neg_lo:[0,0,1] neg_hi:[0,0,1]
v_pk_fma_f32 v[60:61], v[52:53], s[94:95], v[64:65] op_sel_hi:[1,1,0] neg_lo:[0,0,1] neg_hi:[0,0,1]
v_pk_fma_f32 v[20:21], v[20:21], s[94:95], v[34:35] op_sel_hi:[1,1,0] neg_lo:[1,0,0] neg_hi:[1,0,0]
v_pk_fma_f32 v[52:53], v[52:53], s[94:95], v[66:67] op_sel_hi:[1,1,0] neg_lo:[1,0,0] neg_hi:[1,0,0]
v_pk_fma_f32 v[30:31], v[22:23], s[94:95], v[32:33] op_sel_hi:[1,1,0] neg_lo:[0,0,1] neg_hi:[0,0,1]
v_pk_fma_f32 v[62:63], v[54:55], s[94:95], v[64:65] op_sel_hi:[1,1,0] neg_lo:[0,0,1] neg_hi:[0,0,1]
v_pk_fma_f32 v[22:23], v[22:23], s[94:95], v[34:35] op_sel_hi:[1,1,0] neg_lo:[1,0,0] neg_hi:[1,0,0]
v_pk_fma_f32 v[54:55], v[54:55], s[94:95], v[66:67] op_sel_hi:[1,1,0] neg_lo:[1,0,0] neg_hi:[1,0,0]
v_exp_f32 v24, v24
v_exp_f32 v56, v56
v_exp_f32 v16, v16
v_exp_f32 v48, v48
v_exp_f32 v25, v25
v_exp_f32 v57, v57
v_exp_f32 v17, v17
v_exp_f32 v49, v49
v_exp_f32 v26, v26
v_exp_f32 v58, v58
v_exp_f32 v18, v18
v_exp_f32 v50, v50
v_exp_f32 v27, v27
v_exp_f32 v59, v59
v_exp_f32 v19, v19
v_exp_f32 v51, v51
v_exp_f32 v28, v28
v_exp_f32 v60, v60
v_exp_f32 v20, v20
v_exp_f32 v52, v52
v_exp_f32 v29, v29
v_exp_f32 v61, v61
v_exp_f32 v21, v21
v_exp_f32 v53, v53
v_exp_f32 v30, v30
v_exp_f32 v62, v62
v_exp_f32 v22, v22
v_exp_f32 v54, v54
v_exp_f32 v31, v31
v_exp_f32 v63, v63
v_exp_f32 v23, v23
v_exp_f32 v55, v55
v_pk_add_f32 v[32:33], v[24:25], v[26:27]
v_pk_add_f32 v[64:65], v[56:57], v[58:59]
v_pk_add_f32 v[34:35], v[16:17], v[18:19]
v_pk_add_f32 v[66:67], v[48:49], v[50:51]
v_pk_add_f32 v[32:33], v[32:33], v[28:29]
v_pk_add_f32 v[64:65], v[64:65], v[60:61]
v_pk_add_f32 v[34:35], v[34:35], v[20:21]
v_pk_add_f32 v[66:67], v[66:67], v[52:53]
v_pk_add_f32 v[32:33], v[32:33], v[30:31]
v_pk_add_f32 v[64:65], v[64:65], v[62:63]
v_pk_add_f32 v[34:35], v[34:35], v[22:23]
v_pk_add_f32 v[66:67], v[66:67], v[54:55]
v_add_f32 v38, v32, v33
v_add_f32 v70, v64, v65
v_add_f32 v39, v34, v35
v_add_f32 v71, v66, v67
v_mov_b32 v36, v38
v_mov_b32 v68, v70
v_mov_b32 v37, v39
v_mov_b32 v69, v71
v_permlane16_swap_b32 v38, v36
v_permlane16_swap_b32 v70, v68
v_permlane16_swap_b32 v39, v37
v_permlane16_swap_b32 v71, v69
v_add_f32 v38, v38, v36
v_add_f32 v70, v70, v68
v_add_f32 v39, v39, v37
v_add_f32 v71, v71, v69
v_mov_b32 v36, v38
v_mov_b32 v68, v70
v_mov_b32 v37, v39
v_mov_b32 v69, v71
v_permlane32_swap_b32 v38, v36
v_permlane32_swap_b32 v70, v68
v_permlane32_swap_b32 v39, v37
v_permlane32_swap_b32 v71, v69
v_add_f32 v38, v38, v36
v_add_f32 v70, v70, v68
v_add_f32 v39, v39, v37
v_add_f32 v71, v71, v69
v_rcp_f32 v32, v38
v_rcp_f32 v64, v70
v_rcp_f32 v34, v39
v_rcp_f32 v66, v71
v_pk_mul_f32 v[24:25], v[24:25], v[32:33] op_sel_hi:[1,0]
v_pk_mul_f32 v[56:57], v[56:57], v[64:65] op_sel_hi:[1,0]
v_pk_mul_f32 v[16:17], v[16:17], v[34:35] op_sel_hi:[1,0]
v_pk_mul_f32 v[48:49], v[48:49], v[66:67] op_sel_hi:[1,0]
v_pk_mul_f32 v[26:27], v[26:27], v[32:33] op_sel_hi:[1,0]
v_pk_mul_f32 v[58:59], v[58:59], v[64:65] op_sel_hi:[1,0]
v_pk_mul_f32 v[18:19], v[18:19], v[34:35] op_sel_hi:[1,0]
v_pk_mul_f32 v[50:51], v[50:51], v[66:67] op_sel_hi:[1,0]
v_pk_mul_f32 v[28:29], v[28:29], v[32:33] op_sel_hi:[1,0]
v_pk_mul_f32 v[60:61], v[60:61], v[64:65] op_sel_hi:[1,0]
v_pk_mul_f32 v[20:21], v[20:21], v[34:35] op_sel_hi:[1,0]
v_pk_mul_f32 v[52:53], v[52:53], v[66:67] op_sel_hi:[1,0]
v_pk_mul_f32 v[30:31], v[30:31], v[32:33] op_sel_hi:[1,0]
v_pk_mul_f32 v[62:63], v[62:63], v[64:65] op_sel_hi:[1,0]
v_pk_mul_f32 v[22:23], v[22:23], v[34:35] op_sel_hi:[1,0]
v_pk_mul_f32 v[54:55], v[54:55], v[66:67] op_sel_hi:[1,0]
v_cvt_pk_bf16_f32 v220, v24, v25
v_cvt_pk_bf16_f32 v228, v56, v57
v_cvt_pk_bf16_f32 v221, v26, v27
v_cvt_pk_bf16_f32 v229, v58, v59
v_cvt_pk_bf16_f32 v222, v28, v29
v_cvt_pk_bf16_f32 v230, v60, v61
v_cvt_pk_bf16_f32 v223, v30, v31
v_cvt_pk_bf16_f32 v231, v62, v63
v_cvt_pk_bf16_f32 v224, v16, v17
v_cvt_pk_bf16_f32 v232, v48, v49
v_cvt_pk_bf16_f32 v225, v18, v19
v_cvt_pk_bf16_f32 v233, v50, v51
v_cvt_pk_bf16_f32 v226, v20, v21
v_cvt_pk_bf16_f32 v234, v52, v53
v_cvt_pk_bf16_f32 v227, v22, v23
v_cvt_pk_bf16_f32 v235, v54, v55
ds_write_b64 v8, v[220:221] offset:0
ds_write_b64 v9, v[222:223] offset:0
ds_write_b64 v8, v[224:225] offset:4096
ds_write_b64 v9, v[226:227] offset:4096
ds_write_b64 v8, v[228:229] offset:1024
ds_write_b64 v9, v[230:231] offset:1024
ds_write_b64 v8, v[232:233] offset:5120
ds_write_b64 v9, v[234:235] offset:5120
s_waitcnt lgkmcnt(0)
s_barrier
ds_read_b64_tr_b16 v[80:81], v4 offset:0
ds_read_b64_tr_b16 v[82:83], v4 offset:1024
ds_read_b64_tr_b16 v[84:85], v5 offset:0
ds_read_b64_tr_b16 v[86:87], v5 offset:1024
ds_read_b64_tr_b16 v[88:89], v4 offset:4096
ds_read_b64_tr_b16 v[90:91], v4 offset:5120
ds_read_b64_tr_b16 v[92:93], v5 offset:4096
ds_read_b64_tr_b16 v[94:95], v5 offset:5120
ds_read_b64_tr_b16 v[96:97], v4 offset:2048
ds_read_b64_tr_b16 v[98:99], v4 offset:3072
ds_read_b64_tr_b16 v[100:101], v5 offset:2048
ds_read_b64_tr_b16 v[102:103], v5 offset:3072
ds_read_b64_tr_b16 v[104:105], v4 offset:6144
ds_read_b64_tr_b16 v[106:107], v4 offset:7168
ds_read_b64_tr_b16 v[108:109], v5 offset:6144
ds_read_b64_tr_b16 v[110:111], v5 offset:7168
s_waitcnt lgkmcnt(8)
v_mfma_f32_16x16x32_bf16 v[172:175], v[80:83], v[152:155], 0
v_mfma_f32_16x16x32_bf16 v[176:179], v[80:83], v[156:159], 0
v_mfma_f32_16x16x32_bf16 v[204:207], v[80:83], v[168:171], 0
v_mfma_f32_16x16x32_bf16 v[180:183], v[84:87], v[152:155], 0
v_mfma_f32_16x16x32_bf16 v[184:187], v[84:87], v[156:159], 0
v_mfma_f32_16x16x32_bf16 v[208:211], v[84:87], v[168:171], 0
v_mfma_f32_16x16x32_bf16 v[188:191], v[88:91], v[152:155], 0
v_mfma_f32_16x16x32_bf16 v[192:195], v[88:91], v[156:159], 0
v_mfma_f32_16x16x32_bf16 v[212:215], v[88:91], v[168:171], 0
v_mfma_f32_16x16x32_bf16 v[196:199], v[92:95], v[152:155], 0
v_mfma_f32_16x16x32_bf16 v[200:203], v[92:95], v[156:159], 0
v_mfma_f32_16x16x32_bf16 v[216:219], v[92:95], v[168:171], 0
s_waitcnt lgkmcnt(0)
v_mfma_f32_16x16x32_bf16 v[172:175], v[96:99], v[160:163], v[172:175]
v_mfma_f32_16x16x32_bf16 v[176:179], v[96:99], v[164:167], v[176:179]
v_mfma_f32_16x16x32_bf16 v[204:207], v[96:99], v[168:171], v[204:207]
v_mfma_f32_16x16x32_bf16 v[180:183], v[100:103], v[160:163], v[180:183]
v_mfma_f32_16x16x32_bf16 v[184:187], v[100:103], v[164:167], v[184:187]
v_mfma_f32_16x16x32_bf16 v[208:211], v[100:103], v[168:171], v[208:211]
v_mfma_f32_16x16x32_bf16 v[188:191], v[104:107], v[160:163], v[188:191]
v_mfma_f32_16x16x32_bf16 v[192:195], v[104:107], v[164:167], v[192:195]
v_mfma_f32_16x16x32_bf16 v[212:215], v[104:107], v[168:171], v[212:215]
v_mfma_f32_16x16x32_bf16 v[196:199], v[108:111], v[160:163], v[196:199]
v_mfma_f32_16x16x32_bf16 v[200:203], v[108:111], v[164:167], v[200:203]
v_mfma_f32_16x16x32_bf16 v[216:219], v[108:111], v[168:171], v[216:219]
v_lshlrev_b32 v12, 4, v1
s_lshl_b32 s70, s3, 13
s_add_u32 s70, s70, 32768
v_add_u32 v13, s70, v12
s_xor_b32 s71, s3, 2
s_lshl_b32 s71, s71, 13
s_add_u32 s71, s71, 32768
v_add_u32 v14, s71, v12
s_cmp_eq_u32 s6, 0
s_cbranch_scc1 p1e_i0
ds_write_b128 v13, v[172:175] offset:0
ds_write_b128 v13, v[176:179] offset:1024
ds_write_b128 v13, v[180:183] offset:2048
ds_write_b128 v13, v[184:187] offset:3072
ds_write_b128 v13, v[204:207] offset:4096
ds_write_b128 v13, v[208:211] offset:5120
s_waitcnt lgkmcnt(0)
s_barrier
ds_read_b128 v[80:83], v14 offset:0
ds_read_b128 v[84:87], v14 offset:1024
ds_read_b128 v[88:91], v14 offset:2048
ds_read_b128 v[92:95], v14 offset:3072
ds_read_b128 v[96:99], v14 offset:4096
ds_read_b128 v[100:103], v14 offset:5120
s_lshl_b32 s70, s5, 4
s_add_u32 s70, s70, s4
s_lshl_b32 s72, s70, 9
s_lshl_b32 s70, s70, 3
s_lshl_b32 s71, s7, 2
s_add_u32 s70, s70, s71
s_add_u32 s70, s70, 2
s_lshl_b32 s70, s70, 10
s_lshl_b32 s71, s7, 8
s_add_u32 s72, s72, s71
s_add_u32 s72, s72, 128
v_lshlrev_b32 v15, 5, v11
s_waitcnt lgkmcnt(0)
v_pk_add_f32 v[188:189], v[188:189], v[80:81]
v_pk_add_f32 v[190:191], v[190:191], v[82:83]
v_pk_add_f32 v[192:193], v[192:193], v[84:85]
v_pk_add_f32 v[194:195], v[194:195], v[86:87]
v_pk_add_f32 v[196:197], v[196:197], v[88:89]
v_pk_add_f32 v[198:199], v[198:199], v[90:91]
v_pk_add_f32 v[200:201], v[200:201], v[92:93]
v_pk_add_f32 v[202:203], v[202:203], v[94:95]
v_pk_add_f32 v[212:213], v[212:213], v[96:97]
v_pk_add_f32 v[214:215], v[214:215], v[98:99]
v_pk_add_f32 v[216:217], v[216:217], v[100:101]
v_pk_add_f32 v[218:219], v[218:219], v[102:103]
v_cvt_pk_bf16_f32 v80, v188, v189
v_cvt_pk_bf16_f32 v81, v190, v191
v_cvt_pk_bf16_f32 v82, v196, v197
v_cvt_pk_bf16_f32 v83, v198, v199
buffer_store_dwordx4 v[80:83], v12, s[40:43], s70 offen offset:0 sc1
v_cvt_pk_bf16_f32 v84, v192, v193
v_cvt_pk_bf16_f32 v85, v194, v195
v_cvt_pk_bf16_f32 v86, v200, v201
v_cvt_pk_bf16_f32 v87, v202, v203
buffer_store_dwordx4 v[84:87], v12, s[40:43], s70 offen offset:1024 sc1
s_mov_b32 exec_lo, 0x00010001
s_mov_b32 exec_hi, 0x00010001
buffer_store_dwordx4 v[212:215], v15, s[44:47], s72 offen offset:0 sc1
buffer_store_dwordx4 v[216:219], v15, s[44:47], s72 offen offset:16 sc1
s_mov_b64 exec, -1
s_branch p1e_done
p1e_i0:
ds_write_b128 v13, v[188:191] offset:0
ds_write_b128 v13, v[192:195] offset:1024
ds_write_b128 v13, v[196:199] offset:2048
ds_write_b128 v13, v[200:203] offset:3072
ds_write_b128 v13, v[212:215] offset:4096
ds_write_b128 v13, v[216:219] offset:5120
s_waitcnt lgkmcnt(0)
s_barrier
ds_read_b128 v[80:83], v14 offset:0
ds_read_b128 v[84:87], v14 offset:1024
ds_read_b128 v[88:91], v14 offset:2048
ds_read_b128 v[92:95], v14 offset:3072
ds_read_b128 v[96:99], v14 offset:4096
ds_read_b128 v[100:103], v14 offset:5120
s_lshl_b32 s70, s5, 4
s_add_u32 s70, s70, s4
s_lshl_b32 s72, s70, 9
s_lshl_b32 s70, s70, 3
s_lshl_b32 s71, s7, 2
s_add_u32 s70, s70, s71
s_add_u32 s70, s70, 0
s_lshl_b32 s70, s70, 10
s_lshl_b32 s71, s7, 8
s_add_u32 s72, s72, s71
s_add_u32 s72, s72, 0
v_lshlrev_b32 v15, 5, v11
s_waitcnt lgkmcnt(0)
v_pk_add_f32 v[172:173], v[172:173], v[80:81]
v_pk_add_f32 v[174:175], v[174:175], v[82:83]
v_pk_add_f32 v[176:177], v[176:177], v[84:85]
v_pk_add_f32 v[178:179], v[178:179], v[86:87]
v_pk_add_f32 v[180:181], v[180:181], v[88:89]
v_pk_add_f32 v[182:183], v[182:183], v[90:91]
v_pk_add_f32 v[184:185], v[184:185], v[92:93]
v_pk_add_f32 v[186:187], v[186:187], v[94:95]
v_pk_add_f32 v[204:205], v[204:205], v[96:97]
v_pk_add_f32 v[206:207], v[206:207], v[98:99]
v_pk_add_f32 v[208:209], v[208:209], v[100:101]
v_pk_add_f32 v[210:211], v[210:211], v[102:103]
v_cvt_pk_bf16_f32 v80, v172, v173
v_cvt_pk_bf16_f32 v81, v174, v175
v_cvt_pk_bf16_f32 v82, v180, v181
v_cvt_pk_bf16_f32 v83, v182, v183
buffer_store_dwordx4 v[80:83], v12, s[40:43], s70 offen offset:0 sc1
v_cvt_pk_bf16_f32 v84, v176, v177
v_cvt_pk_bf16_f32 v85, v178, v179
v_cvt_pk_bf16_f32 v86, v184, v185
v_cvt_pk_bf16_f32 v87, v186, v187
buffer_store_dwordx4 v[84:87], v12, s[40:43], s70 offen offset:1024 sc1
s_mov_b32 exec_lo, 0x00010001
s_mov_b32 exec_hi, 0x00010001
buffer_store_dwordx4 v[204:207], v15, s[44:47], s72 offen offset:0 sc1
buffer_store_dwordx4 v[208:211], v15, s[44:47], s72 offen offset:16 sc1
s_mov_b64 exec, -1
p1e_done:
s_nop 3
v_mfma_f32_16x16x32_bf16 v[16:19], v[112:115], v[120:123], 0
v_mfma_f32_16x16x32_bf16 v[20:23], v[116:119], v[120:123], 0
v_mfma_f32_16x16x32_bf16 v[48:51], v[112:115], v[124:127], 0
v_mfma_f32_16x16x32_bf16 v[52:55], v[116:119], v[124:127], 0
s_nop 4
v_max3_f32 v32, v16, v17, v18
s_nop 0
v_max3_f32 v64, v48, v49, v50
v_min3_f32 v34, v16, v17, v18
v_min3_f32 v66, v48, v49, v50
v_max3_f32 v32, v32, v19, v20
v_max3_f32 v64, v64, v51, v52
v_min3_f32 v34, v34, v19, v20
v_min3_f32 v66, v66, v51, v52
v_max3_f32 v32, v32, v21, v22
v_max3_f32 v64, v64, v53, v54
v_min3_f32 v34, v34, v21, v22
v_min3_f32 v66, v66, v53, v54
v_max_f32 v32, v32, v23
v_max_f32 v64, v64, v55
v_min_f32 v34, v34, v23
v_min_f32 v66, v66, v55
v_mov_b32 v36, v32
v_mov_b32 v68, v64
v_mov_b32 v37, v34
v_mov_b32 v69, v66
v_permlane16_swap_b32 v32, v36
v_permlane16_swap_b32 v64, v68
v_permlane16_swap_b32 v34, v37
v_permlane16_swap_b32 v66, v69
v_max_f32 v32, v32, v36
v_max_f32 v64, v64, v68
v_min_f32 v34, v34, v37
v_min_f32 v66, v66, v69
v_mov_b32 v36, v32
v_mov_b32 v68, v64
v_mov_b32 v37, v34
v_mov_b32 v69, v66
v_permlane32_swap_b32 v32, v36
v_permlane32_swap_b32 v64, v68
v_permlane32_swap_b32 v34, v37
v_permlane32_swap_b32 v66, v69
v_max_f32 v32, v32, v36
v_max_f32 v64, v64, v68
v_min_f32 v34, v34, v37
v_min_f32 v66, v66, v69
v_mul_f32 v32, s94, v32
v_mul_f32 v64, s94, v64
v_mul_f32 v34, s94, v34
v_mul_f32 v66, s94, v66
v_pk_fma_f32 v[24:25], v[16:17], s[94:95], v[32:33] op_sel_hi:[1,1,0] neg_lo:[0,0,1] neg_hi:[0,0,1]
v_pk_fma_f32 v[56:57], v[48:49], s[94:95], v[64:65] op_sel_hi:[1,1,0] neg_lo:[0,0,1] neg_hi:[0,0,1]
v_pk_fma_f32 v[16:17], v[16:17], s[94:95], v[34:35] op_sel_hi:[1,1,0] neg_lo:[1,0,0] neg_hi:[1,0,0]
v_pk_fma_f32 v[48:49], v[48:49], s[94:95], v[66:67] op_sel_hi:[1,1,0] neg_lo:[1,0,0] neg_hi:[1,0,0]
v_pk_fma_f32 v[26:27], v[18:19], s[94:95], v[32:33] op_sel_hi:[1,1,0] neg_lo:[0,0,1] neg_hi:[0,0,1]
v_pk_fma_f32 v[58:59], v[50:51], s[94:95], v[64:65] op_sel_hi:[1,1,0] neg_lo:[0,0,1] neg_hi:[0,0,1]
v_pk_fma_f32 v[18:19], v[18:19], s[94:95], v[34:35] op_sel_hi:[1,1,0] neg_lo:[1,0,0] neg_hi:[1,0,0]
v_pk_fma_f32 v[50:51], v[50:51], s[94:95], v[66:67] op_sel_hi:[1,1,0] neg_lo:[1,0,0] neg_hi:[1,0,0]
v_pk_fma_f32 v[28:29], v[20:21], s[94:95], v[32:33] op_sel_hi:[1,1,0] neg_lo:[0,0,1] neg_hi:[0,0,1]
v_pk_fma_f32 v[60:61], v[52:53], s[94:95], v[64:65] op_sel_hi:[1,1,0] neg_lo:[0,0,1] neg_hi:[0,0,1]
v_pk_fma_f32 v[20:21], v[20:21], s[94:95], v[34:35] op_sel_hi:[1,1,0] neg_lo:[1,0,0] neg_hi:[1,0,0]
v_pk_fma_f32 v[52:53], v[52:53], s[94:95], v[66:67] op_sel_hi:[1,1,0] neg_lo:[1,0,0] neg_hi:[1,0,0]
v_pk_fma_f32 v[30:31], v[22:23], s[94:95], v[32:33] op_sel_hi:[1,1,0] neg_lo:[0,0,1] neg_hi:[0,0,1]
v_pk_fma_f32 v[62:63], v[54:55], s[94:95], v[64:65] op_sel_hi:[1,1,0] neg_lo:[0,0,1] neg_hi:[0,0,1]
v_pk_fma_f32 v[22:23], v[22:23], s[94:95], v[34:35] op_sel_hi:[1,1,0] neg_lo:[1,0,0] neg_hi:[1,0,0]
v_pk_fma_f32 v[54:55], v[54:55], s[94:95], v[66:67] op_sel_hi:[1,1,0] neg_lo:[1,0,0] neg_hi:[1,0,0]
v_exp_f32 v24, v24
v_exp_f32 v56, v56
v_exp_f32 v16, v16
v_exp_f32 v48, v48
v_exp_f32 v25, v25
v_exp_f32 v57, v57
v_exp_f32 v17, v17
v_exp_f32 v49, v49
v_exp_f32 v26, v26
v_exp_f32 v58, v58
v_exp_f32 v18, v18
v_exp_f32 v50, v50
v_exp_f32 v27, v27
v_exp_f32 v59, v59
v_exp_f32 v19, v19
v_exp_f32 v51, v51
v_exp_f32 v28, v28
v_exp_f32 v60, v60
v_exp_f32 v20, v20
v_exp_f32 v52, v52
v_exp_f32 v29, v29
v_exp_f32 v61, v61
v_exp_f32 v21, v21
v_exp_f32 v53, v53
v_exp_f32 v30, v30
v_exp_f32 v62, v62
v_exp_f32 v22, v22
v_exp_f32 v54, v54
v_exp_f32 v31, v31
v_exp_f32 v63, v63
v_exp_f32 v23, v23
v_exp_f32 v55, v55
v_pk_add_f32 v[32:33], v[24:25], v[26:27]
v_pk_add_f32 v[64:65], v[56:57], v[58:59]
v_pk_add_f32 v[34:35], v[16:17], v[18:19]
v_pk_add_f32 v[66:67], v[48:49], v[50:51]
v_pk_add_f32 v[32:33], v[32:33], v[28:29]
v_pk_add_f32 v[64:65], v[64:65], v[60:61]
v_pk_add_f32 v[34:35], v[34:35], v[20:21]
v_pk_add_f32 v[66:67], v[66:67], v[52:53]
v_pk_add_f32 v[32:33], v[32:33], v[30:31]
v_pk_add_f32 v[64:65], v[64:65], v[62:63]
v_pk_add_f32 v[34:35], v[34:35], v[22:23]
v_pk_add_f32 v[66:67], v[66:67], v[54:55]
v_add_f32 v38, v32, v33
v_add_f32 v70, v64, v65
v_add_f32 v39, v34, v35
v_add_f32 v71, v66, v67
v_mov_b32 v36, v38
v_mov_b32 v68, v70
v_mov_b32 v37, v39
v_mov_b32 v69, v71
v_permlane16_swap_b32 v38, v36
v_permlane16_swap_b32 v70, v68
v_permlane16_swap_b32 v39, v37
v_permlane16_swap_b32 v71, v69
v_add_f32 v38, v38, v36
v_add_f32 v70, v70, v68
v_add_f32 v39, v39, v37
v_add_f32 v71, v71, v69
v_mov_b32 v36, v38
v_mov_b32 v68, v70
v_mov_b32 v37, v39
v_mov_b32 v69, v71
v_permlane32_swap_b32 v38, v36
v_permlane32_swap_b32 v70, v68
v_permlane32_swap_b32 v39, v37
v_permlane32_swap_b32 v71, v69
v_add_f32 v38, v38, v36
v_add_f32 v70, v70, v68
v_add_f32 v39, v39, v37
v_add_f32 v71, v71, v69
v_rcp_f32 v32, v38
v_rcp_f32 v64, v70
v_rcp_f32 v34, v39
v_rcp_f32 v66, v71
v_pk_mul_f32 v[24:25], v[24:25], v[32:33] op_sel_hi:[1,0]
v_pk_mul_f32 v[56:57], v[56:57], v[64:65] op_sel_hi:[1,0]
v_pk_mul_f32 v[16:17], v[16:17], v[34:35] op_sel_hi:[1,0]
v_pk_mul_f32 v[48:49], v[48:49], v[66:67] op_sel_hi:[1,0]
v_pk_mul_f32 v[26:27], v[26:27], v[32:33] op_sel_hi:[1,0]
v_pk_mul_f32 v[58:59], v[58:59], v[64:65] op_sel_hi:[1,0]
v_pk_mul_f32 v[18:19], v[18:19], v[34:35] op_sel_hi:[1,0]
v_pk_mul_f32 v[50:51], v[50:51], v[66:67] op_sel_hi:[1,0]
v_pk_mul_f32 v[28:29], v[28:29], v[32:33] op_sel_hi:[1,0]
v_pk_mul_f32 v[60:61], v[60:61], v[64:65] op_sel_hi:[1,0]
v_pk_mul_f32 v[20:21], v[20:21], v[34:35] op_sel_hi:[1,0]
v_pk_mul_f32 v[52:53], v[52:53], v[66:67] op_sel_hi:[1,0]
v_pk_mul_f32 v[30:31], v[30:31], v[32:33] op_sel_hi:[1,0]
v_pk_mul_f32 v[62:63], v[62:63], v[64:65] op_sel_hi:[1,0]
v_pk_mul_f32 v[22:23], v[22:23], v[34:35] op_sel_hi:[1,0]
v_pk_mul_f32 v[54:55], v[54:55], v[66:67] op_sel_hi:[1,0]
v_cvt_pk_bf16_f32 v220, v24, v25
v_cvt_pk_bf16_f32 v228, v56, v57
v_cvt_pk_bf16_f32 v221, v26, v27
v_cvt_pk_bf16_f32 v229, v58, v59
v_cvt_pk_bf16_f32 v222, v28, v29
v_cvt_pk_bf16_f32 v230, v60, v61
v_cvt_pk_bf16_f32 v223, v30, v31
v_cvt_pk_bf16_f32 v231, v62, v63
v_cvt_pk_bf16_f32 v224, v16, v17
v_cvt_pk_bf16_f32 v232, v48, v49
v_cvt_pk_bf16_f32 v225, v18, v19
v_cvt_pk_bf16_f32 v233, v50, v51
v_cvt_pk_bf16_f32 v226, v20, v21
v_cvt_pk_bf16_f32 v234, v52, v53
v_cvt_pk_bf16_f32 v227, v22, v23
v_cvt_pk_bf16_f32 v235, v54, v55
s_waitcnt vmcnt(0)
v_mov_b32 v8, 163792
v_mov_b32 v9, 1
s_mov_b64 exec, 1
ds_add_rtn_u32 v9, v8, v9
s_waitcnt lgkmcnt(0)
s_nop 1
v_readfirstlane_b32 s72, v9
s_mov_b64 exec, -1
s_nop 2
s_cmp_lg_u32 s72, 3
s_cbranch_scc1 pub2
s_add_u32 s56, s8, 0x1200000
s_addc_u32 s57, s9, 0
s_mov_b32 s58, 0x8000
s_mov_b32 s59, 0x20000
s_lshl_b32 s70, s5, 7
s_lshl_b32 s71, s4, 3
s_add_u32 s71, s71, s70
v_mov_b32 v8, s28
v_mov_b32 v9, s29
v_mov_b32 v10, 0
s_mov_b64 exec, 1
buffer_store_dwordx2 v[8:9], v10, s[56:59], s71 offen sc1
s_mov_b64 exec, -1
pub2:
s_barrier
s_add_u32 s40, s8, 0x400000
s_addc_u32 s41, s9, 0
s_mov_b32 s42, 0x200000
s_mov_b32 s43, 0x20000
v_lshlrev_b32 v8, 4, v1
s_lshl_b32 s70, s5, 17
s_lshl_b32 s71, s3, 10
s_add_u32 s70, s70, s71
buffer_load_dwordx4 v[32:35], v8, s[40:43], s70 offen sc1
s_add_u32 s70, s70, 8192
buffer_load_dwordx4 v[36:39], v8, s[40:43], s70 offen sc1
s_add_u32 s70, s70, 8192
buffer_load_dwordx4 v[40:43], v8, s[40:43], s70 offen sc1
s_add_u32 s70, s70, 8192
buffer_load_dwordx4 v[44:47], v8, s[40:43], s70 offen sc1
s_add_u32 s70, s70, 8192
buffer_load_dwordx4 v[48:51], v8, s[40:43], s70 offen sc1
s_add_u32 s70, s70, 8192
buffer_load_dwordx4 v[52:55], v8, s[40:43], s70 offen sc1
s_add_u32 s70, s70, 8192
buffer_load_dwordx4 v[56:59], v8, s[40:43], s70 offen sc1
s_add_u32 s70, s70, 8192
buffer_load_dwordx4 v[60:63], v8, s[40:43], s70 offen sc1
s_add_u32 s70, s70, 8192
buffer_load_dwordx4 v[64:67], v8, s[40:43], s70 offen sc1
s_add_u32 s70, s70, 8192
buffer_load_dwordx4 v[68:71], v8, s[40:43], s70 offen sc1
s_add_u32 s70, s70, 8192
buffer_load_dwordx4 v[72:75], v8, s[40:43], s70 offen sc1
s_add_u32 s70, s70, 8192
buffer_load_dwordx4 v[76:79], v8, s[40:43], s70 offen sc1
s_add_u32 s70, s70, 8192
buffer_load_dwordx4 v[80:83], v8, s[40:43], s70 offen sc1
s_add_u32 s70, s70, 8192
buffer_load_dwordx4 v[84:87], v8, s[40:43], s70 offen sc1
s_add_u32 s70, s70, 8192
buffer_load_dwordx4 v[88:91], v8, s[40:43], s70 offen sc1
s_add_u32 s70, s70, 8192
buffer_load_dwordx4 v[92:95], v8, s[40:43], s70 offen sc1
s_mov_b32 s74, 0x00003f80
s_mov_b32 s75, 0x3f800000
v_mov_b32 v16, 0
v_mov_b32 v17, 0
v_mov_b32 v18, 0
v_mov_b32 v19, 0
v_mov_b32 v20, 0
v_mov_b32 v21, 0
v_mov_b32 v22, 0
v_mov_b32 v23, 0
v_mov_b32 v24, s74
v_mov_b32 v25, s75
s_waitcnt vmcnt(0)
v_dot2c_f32_bf16 v16, v32, v24
v_dot2c_f32_bf16 v17, v32, v25
v_dot2c_f32_bf16 v18, v33, v24
v_dot2c_f32_bf16 v19, v33, v25
v_dot2c_f32_bf16 v20, v34, v24
v_dot2c_f32_bf16 v21, v34, v25
v_dot2c_f32_bf16 v22, v35, v24
v_dot2c_f32_bf16 v23, v35, v25
v_dot2c_f32_bf16 v16, v36, v24
v_dot2c_f32_bf16 v17, v36, v25
v_dot2c_f32_bf16 v18, v37, v24
v_dot2c_f32_bf16 v19, v37, v25
v_dot2c_f32_bf16 v20, v38, v24
v_dot2c_f32_bf16 v21, v38, v25
v_dot2c_f32_bf16 v22, v39, v24
v_dot2c_f32_bf16 v23, v39, v25
v_dot2c_f32_bf16 v16, v40, v24
v_dot2c_f32_bf16 v17, v40, v25
v_dot2c_f32_bf16 v18, v41, v24
v_dot2c_f32_bf16 v19, v41, v25
v_dot2c_f32_bf16 v20, v42, v24
v_dot2c_f32_bf16 v21, v42, v25
v_dot2c_f32_bf16 v22, v43, v24
v_dot2c_f32_bf16 v23, v43, v25
v_dot2c_f32_bf16 v16, v44, v24
v_dot2c_f32_bf16 v17, v44, v25
v_dot2c_f32_bf16 v18, v45, v24
v_dot2c_f32_bf16 v19, v45, v25
v_dot2c_f32_bf16 v20, v46, v24
v_dot2c_f32_bf16 v21, v46, v25
v_dot2c_f32_bf16 v22, v47, v24
v_dot2c_f32_bf16 v23, v47, v25
v_dot2c_f32_bf16 v16, v48, v24
v_dot2c_f32_bf16 v17, v48, v25
v_dot2c_f32_bf16 v18, v49, v24
v_dot2c_f32_bf16 v19, v49, v25
v_dot2c_f32_bf16 v20, v50, v24
v_dot2c_f32_bf16 v21, v50, v25
v_dot2c_f32_bf16 v22, v51, v24
v_dot2c_f32_bf16 v23, v51, v25
v_dot2c_f32_bf16 v16, v52, v24
v_dot2c_f32_bf16 v17, v52, v25
v_dot2c_f32_bf16 v18, v53, v24
v_dot2c_f32_bf16 v19, v53, v25
v_dot2c_f32_bf16 v20, v54, v24
v_dot2c_f32_bf16 v21, v54, v25
v_dot2c_f32_bf16 v22, v55, v24
v_dot2c_f32_bf16 v23, v55, v25
v_dot2c_f32_bf16 v16, v56, v24
v_dot2c_f32_bf16 v17, v56, v25
v_dot2c_f32_bf16 v18, v57, v24
v_dot2c_f32_bf16 v19, v57, v25
v_dot2c_f32_bf16 v20, v58, v24
v_dot2c_f32_bf16 v21, v58, v25
v_dot2c_f32_bf16 v22, v59, v24
v_dot2c_f32_bf16 v23, v59, v25
v_dot2c_f32_bf16 v16, v60, v24
v_dot2c_f32_bf16 v17, v60, v25
v_dot2c_f32_bf16 v18, v61, v24
v_dot2c_f32_bf16 v19, v61, v25
v_dot2c_f32_bf16 v20, v62, v24
v_dot2c_f32_bf16 v21, v62, v25
v_dot2c_f32_bf16 v22, v63, v24
v_dot2c_f32_bf16 v23, v63, v25
v_dot2c_f32_bf16 v16, v64, v24
v_dot2c_f32_bf16 v17, v64, v25
v_dot2c_f32_bf16 v18, v65, v24
v_dot2c_f32_bf16 v19, v65, v25
v_dot2c_f32_bf16 v20, v66, v24
v_dot2c_f32_bf16 v21, v66, v25
v_dot2c_f32_bf16 v22, v67, v24
v_dot2c_f32_bf16 v23, v67, v25
v_dot2c_f32_bf16 v16, v68, v24
v_dot2c_f32_bf16 v17, v68, v25
v_dot2c_f32_bf16 v18, v69, v24
v_dot2c_f32_bf16 v19, v69, v25
v_dot2c_f32_bf16 v20, v70, v24
v_dot2c_f32_bf16 v21, v70, v25
v_dot2c_f32_bf16 v22, v71, v24
v_dot2c_f32_bf16 v23, v71, v25
v_dot2c_f32_bf16 v16, v72, v24
v_dot2c_f32_bf16 v17, v72, v25
v_dot2c_f32_bf16 v18, v73, v24
v_dot2c_f32_bf16 v19, v73, v25
v_dot2c_f32_bf16 v20, v74, v24
v_dot2c_f32_bf16 v21, v74, v25
v_dot2c_f32_bf16 v22, v75, v24
v_dot2c_f32_bf16 v23, v75, v25
v_dot2c_f32_bf16 v16, v76, v24
v_dot2c_f32_bf16 v17, v76, v25
v_dot2c_f32_bf16 v18, v77, v24
v_dot2c_f32_bf16 v19, v77, v25
v_dot2c_f32_bf16 v20, v78, v24
v_dot2c_f32_bf16 v21, v78, v25
v_dot2c_f32_bf16 v22, v79, v24
v_dot2c_f32_bf16 v23, v79, v25
v_dot2c_f32_bf16 v16, v80, v24
v_dot2c_f32_bf16 v17, v80, v25
v_dot2c_f32_bf16 v18, v81, v24
v_dot2c_f32_bf16 v19, v81, v25
v_dot2c_f32_bf16 v20, v82, v24
v_dot2c_f32_bf16 v21, v82, v25
v_dot2c_f32_bf16 v22, v83, v24
v_dot2c_f32_bf16 v23, v83, v25
v_dot2c_f32_bf16 v16, v84, v24
v_dot2c_f32_bf16 v17, v84, v25
v_dot2c_f32_bf16 v18, v85, v24
v_dot2c_f32_bf16 v19, v85, v25
v_dot2c_f32_bf16 v20, v86, v24
v_dot2c_f32_bf16 v21, v86, v25
v_dot2c_f32_bf16 v22, v87, v24
v_dot2c_f32_bf16 v23, v87, v25
v_dot2c_f32_bf16 v16, v88, v24
v_dot2c_f32_bf16 v17, v88, v25
v_dot2c_f32_bf16 v18, v89, v24
v_dot2c_f32_bf16 v19, v89, v25
v_dot2c_f32_bf16 v20, v90, v24
v_dot2c_f32_bf16 v21, v90, v25
v_dot2c_f32_bf16 v22, v91, v24
v_dot2c_f32_bf16 v23, v91, v25
v_dot2c_f32_bf16 v16, v92, v24
v_dot2c_f32_bf16 v17, v92, v25
v_dot2c_f32_bf16 v18, v93, v24
v_dot2c_f32_bf16 v19, v93, v25
v_dot2c_f32_bf16 v20, v94, v24
v_dot2c_f32_bf16 v21, v94, v25
v_dot2c_f32_bf16 v22, v95, v24
v_dot2c_f32_bf16 v23, v95, v25
v_cvt_pk_bf16_f32 v28, v16, v17
v_cvt_pk_bf16_f32 v29, v18, v19
v_cvt_pk_bf16_f32 v30, v20, v21
v_cvt_pk_bf16_f32 v31, v22, v23
s_lshl_b32 s71, s3, 10
s_add_u32 s71, s71, 126976
v_add_u32 v8, s71, v8
ds_write_b128 v8, v[28:31]
s_waitcnt lgkmcnt(0)
s_barrier
s_add_u32 s48, s8, 0x800000
s_addc_u32 s49, s9, 0
s_mov_b32 s50, 0x400000
s_mov_b32 s51, 0x20000
v_lshrrev_b32 v11, 4, v1
v_lshlrev_b32 v12, 4, v1
s_lshl_b32 s70, s7, 12
s_add_u32 s70, s70, 126976
v_add_u32 v13, s70, v12
ds_read_b128 v[112:115], v13 offset:0
ds_read_b128 v[116:119], v13 offset:1024
ds_read_b128 v[120:123], v13 offset:2048
ds_read_b128 v[124:127], v13 offset:3072
s_lshl_b32 s70, s7, 7
s_add_u32 s70, s70, 135168
v_lshlrev_b32 v14, 4, v11
v_add_u32 v14, s70, v14
ds_read_b128 v[160:163], v14 offset:0
ds_read_b128 v[164:167], v14 offset:64
s_lshl_b32 s70, s4, 2
s_lshl_b32 s71, s6, 1
s_add_u32 s70, s70, s71
s_add_u32 s70, s70, 0
s_lshl_b32 s70, s70, 7
s_lshl_b32 s71, s5, 3
s_add_u32 s70, s70, s71
s_lshl_b32 s71, s7, 2
s_add_u32 s70, s70, s71
s_lshl_b32 s70, s70, 9
s_lshl_b32 s88, s4, 7
s_lshl_b32 s71, s5, 3
s_add_u32 s88, s88, s71
s_waitcnt lgkmcnt(0)
v_mfma_f32_16x16x32_bf16 v[48:51], v[160:163], v[220:223], 0
v_mfma_f32_16x16x32_bf16 v[48:51], v[164:167], v[224:227], v[48:51]
v_mfma_f32_16x16x32_bf16 v[52:55], v[160:163], v[228:231], 0
v_mfma_f32_16x16x32_bf16 v[52:55], v[164:167], v[232:235], v[52:55]
v_mfma_f32_16x16x32_bf16 v[16:19], v[112:115], v[220:223], 0
v_mfma_f32_16x16x32_bf16 v[16:19], v[120:123], v[224:227], v[16:19]
v_mfma_f32_16x16x32_bf16 v[20:23], v[116:119], v[220:223], 0
v_mfma_f32_16x16x32_bf16 v[20:23], v[124:127], v[224:227], v[20:23]
v_mfma_f32_16x16x32_bf16 v[24:27], v[112:115], v[228:231], 0
v_mfma_f32_16x16x32_bf16 v[24:27], v[120:123], v[232:235], v[24:27]
v_mfma_f32_16x16x32_bf16 v[28:31], v[116:119], v[228:231], 0
v_mfma_f32_16x16x32_bf16 v[28:31], v[124:127], v[232:235], v[28:31]
v_add_f32 v64, 0x358637bd, v48
v_add_f32 v66, 0x358637bd, v52
v_rcp_f32 v64, v64
v_rcp_f32 v66, v66
v_pk_mul_f32 v[16:17], v[16:17], v[64:65] op_sel_hi:[1,0]
v_pk_mul_f32 v[18:19], v[18:19], v[64:65] op_sel_hi:[1,0]
v_pk_mul_f32 v[20:21], v[20:21], v[64:65] op_sel_hi:[1,0]
v_pk_mul_f32 v[22:23], v[22:23], v[64:65] op_sel_hi:[1,0]
v_pk_mul_f32 v[24:25], v[24:25], v[66:67] op_sel_hi:[1,0]
v_pk_mul_f32 v[26:27], v[26:27], v[66:67] op_sel_hi:[1,0]
v_pk_mul_f32 v[28:29], v[28:29], v[66:67] op_sel_hi:[1,0]
v_pk_mul_f32 v[30:31], v[30:31], v[66:67] op_sel_hi:[1,0]
v_cvt_pk_bf16_f32 v72, v16, v17
v_cvt_pk_bf16_f32 v73, v18, v19
v_cvt_pk_bf16_f32 v74, v24, v25
v_cvt_pk_bf16_f32 v75, v26, v27
s_nop 0
v_permlane16_swap_b32 v72, v74
v_permlane16_swap_b32 v73, v75
buffer_store_dwordx4 v[72:75], v12, s[48:51], s70 offen offset:0 sc1
v_cvt_pk_bf16_f32 v76, v20, v21
v_cvt_pk_bf16_f32 v77, v22, v23
v_cvt_pk_bf16_f32 v78, v28, v29
v_cvt_pk_bf16_f32 v79, v30, v31
s_nop 0
v_permlane16_swap_b32 v76, v78
v_permlane16_swap_b32 v77, v79
buffer_store_dwordx4 v[76:79], v12, s[48:51], s70 offen offset:1024 sc1
s_barrier
s_waitcnt vmcnt(0)
v_mov_b32 v8, 163796
v_mov_b32 v9, 1
s_mov_b64 exec, 1
ds_add_rtn_u32 v9, v8, v9
s_waitcnt lgkmcnt(0)
s_nop 1
v_readfirstlane_b32 s72, v9
s_mov_b64 exec, -1
s_nop 2
s_cmp_lg_u32 s72, 7
s_cbranch_scc1 pub3
s_add_u32 s56, s8, 0x1200000
s_addc_u32 s57, s9, 0
s_mov_b32 s58, 0x8000
s_mov_b32 s59, 0x20000
s_mov_b32 s71, s88
v_mov_b32 v8, s28
v_mov_b32 v9, s29
v_mov_b32 v10, 4096
s_mov_b64 exec, 1
buffer_store_dwordx2 v[8:9], v10, s[56:59], s71 offen sc1
s_mov_b64 exec, -1
pub3:
s_and_b32 s4, s30, 3
s_lshr_b32 s5, s30, 2
s_mul_i32 s4, s4, 4
s_mul_i32 s5, s5, 8
s_and_b32 s64, s31, 3
s_add_u32 s4, s4, s64
s_lshr_b32 s64, s31, 2
s_add_u32 s5, s5, s64
v_and_b32 v10, 15, v1
v_lshrrev_b32 v11, 4, v1
s_lshl_b32 s64, s6, 13
v_lshlrev_b32 v13, 9, v11
v_lshl_add_u32 v13, v10, 4, v13
v_add_u32 v2, s64, v13
v_bfe_u32 v12, v1, 2, 2
v_lshlrev_b32 v12, 6, v12
v_and_b32 v13, 3, v1
v_lshl_add_u32 v12, v13, 3, v12
v_mul_u32_u24 v13, 1024, v11
v_add_u32 v12, v12, v13
v_and_b32 v13, 1, v11
v_lshl_add_u32 v12, v13, 5, v12
s_mul_i32 s64, s7, 256
v_add_u32 v6, s64, v12
v_xor_b32 v7, 32, v6
s_mov_b32 s68, 24576
s_mov_b32 s69, 0xfffe8000
v_mov_b32 v16, 0
v_mov_b32 v17, 0
v_mov_b32 v18, 0
v_mov_b32 v19, 0
v_mov_b32 v20, 0
v_mov_b32 v21, 0
v_mov_b32 v22, 0
v_mov_b32 v23, 0
v_mov_b32 v24, 0
v_mov_b32 v25, 0
v_mov_b32 v26, 0
v_mov_b32 v27, 0
v_mov_b32 v28, 0
v_mov_b32 v29, 0
v_mov_b32 v30, 0
v_mov_b32 v31, 0
v_mov_b32 v32, 0
v_mov_b32 v33, 0
v_mov_b32 v34, 0
v_mov_b32 v35, 0
v_mov_b32 v36, 0
v_mov_b32 v37, 0
v_mov_b32 v38, 0
v_mov_b32 v39, 0
v_mov_b32 v40, 0
v_mov_b32 v41, 0
v_mov_b32 v42, 0
v_mov_b32 v43, 0
v_mov_b32 v44, 0
v_mov_b32 v45, 0
v_mov_b32 v46, 0
v_mov_b32 v47, 0
s_barrier
s_barrier
ds_read_b64_tr_b16 v[80:81], v6 offset:16384
ds_read_b64_tr_b16 v[82:83], v6 offset:16896
ds_read_b128 v[48:51], v2 offset:0
ds_read_b128 v[52:55], v2 offset:256
ds_read_b128 v[56:59], v2 offset:4096
ds_read_b128 v[60:63], v2 offset:4352
ds_read_b64_tr_b16 v[84:85], v7 offset:16384
ds_read_b64_tr_b16 v[86:87], v7 offset:16896
s_mov_b32 s65, 0
s_mov_b32 s67, 0
p3_loop:
s_waitcnt lgkmcnt(0)
v_mfma_f32_16x16x32_bf16 v[16:19], v[80:83], v[48:51], v[16:19]
ds_read_b64_tr_b16 v[88:89], v6 offset:20480
ds_read_b64_tr_b16 v[90:91], v6 offset:20992
v_mfma_f32_16x16x32_bf16 v[24:27], v[80:83], v[52:55], v[24:27]
ds_read_b128 v[64:67], v2 offset:2048
ds_read_b128 v[68:71], v2 offset:2304
v_mfma_f32_16x16x32_bf16 v[32:35], v[80:83], v[56:59], v[32:35]
ds_read_b128 v[72:75], v2 offset:6144
ds_read_b128 v[76:79], v2 offset:6400
v_mfma_f32_16x16x32_bf16 v[40:43], v[80:83], v[60:63], v[40:43]
ds_read_b64_tr_b16 v[92:93], v7 offset:20480
ds_read_b64_tr_b16 v[94:95], v7 offset:20992
v_mfma_f32_16x16x32_bf16 v[20:23], v[84:87], v[48:51], v[20:23]
v_mfma_f32_16x16x32_bf16 v[28:31], v[84:87], v[52:55], v[28:31]
v_mfma_f32_16x16x32_bf16 v[36:39], v[84:87], v[56:59], v[36:39]
v_mfma_f32_16x16x32_bf16 v[44:47], v[84:87], v[60:63], v[44:47]
s_waitcnt lgkmcnt(0)
s_add_u32 s67, s67, 1
s_cmp_eq_u32 s67, 5
s_cselect_b32 s66, s69, s68
s_cselect_b32 s67, 0, s67
v_add_u32 v2, s66, v2
v_add_u32 v6, s66, v6
v_add_u32 v7, s66, v7
s_barrier
v_mfma_f32_16x16x32_bf16 v[16:19], v[88:91], v[64:67], v[16:19]
ds_read_b64_tr_b16 v[80:81], v6 offset:16384
ds_read_b64_tr_b16 v[82:83], v6 offset:16896
v_mfma_f32_16x16x32_bf16 v[24:27], v[88:91], v[68:71], v[24:27]
ds_read_b128 v[48:51], v2 offset:0
ds_read_b128 v[52:55], v2 offset:256
v_mfma_f32_16x16x32_bf16 v[32:35], v[88:91], v[72:75], v[32:35]
ds_read_b128 v[56:59], v2 offset:4096
ds_read_b128 v[60:63], v2 offset:4352
v_mfma_f32_16x16x32_bf16 v[40:43], v[88:91], v[76:79], v[40:43]
ds_read_b64_tr_b16 v[84:85], v7 offset:16384
ds_read_b64_tr_b16 v[86:87], v7 offset:16896
v_mfma_f32_16x16x32_bf16 v[20:23], v[92:95], v[64:67], v[20:23]
v_mfma_f32_16x16x32_bf16 v[28:31], v[92:95], v[68:71], v[28:31]
v_mfma_f32_16x16x32_bf16 v[36:39], v[92:95], v[72:75], v[36:39]
v_mfma_f32_16x16x32_bf16 v[44:47], v[92:95], v[76:79], v[44:47]
s_add_u32 s65, s65, 1
s_cmp_lt_u32 s65, 16
s_cbranch_scc1 p3_loop
s_waitcnt lgkmcnt(0)
s_add_u32 s40, s8, 0xc00000
s_addc_u32 s41, s9, 0
s_mov_b32 s42, 0x400000
s_mov_b32 s43, 0x20000
s_add_u32 s44, s8, 0x1000000
s_addc_u32 s45, s9, 0
s_mov_b32 s46, 0x80000
s_mov_b32 s47, 0x20000
v_and_b32 v10, 15, v1
v_lshrrev_b32 v11, 4, v1
v_bfe_u32 v12, v10, 1, 3
v_lshrrev_b32 v13, 1, v11
s_lshl_b32 s70, s7, 2
v_add_u32 v13, s70, v13
v_xor_b32 v12, v12, v13
s_lshl_b32 s70, s6, 13
s_add_u32 s70, s70, 139264
v_lshlrev_b32 v13, 7, v10
v_and_b32 v14, 1, v11
v_lshl_add_u32 v13, v14, 3, v13
v_add_u32 v13, s70, v13
v_lshl_add_u32 v96, v12, 4, v13
v_xor_b32 v12, 2, v12
v_lshl_add_u32 v97, v12, 4, v13
ds_read_b64 v[100:101], v96 offset:0
ds_read_b64 v[102:103], v97 offset:0
ds_read_b64 v[104:105], v96 offset:2048
ds_read_b64 v[106:107], v97 offset:2048
ds_read_b64 v[108:109], v96 offset:4096
ds_read_b64 v[110:111], v97 offset:4096
ds_read_b64 v[112:113], v96 offset:6144
ds_read_b64 v[114:115], v97 offset:6144
v_lshlrev_b32 v15, 4, v1
s_lshl_b32 s70, s4, 2
s_lshl_b32 s71, s6, 1
s_add_u32 s70, s70, s71
s_mov_b32 s72, s70
s_lshl_b32 s70, s70, 7
s_lshl_b32 s71, s5, 3
s_add_u32 s70, s70, s71
s_lshl_b32 s71, s7, 2
s_add_u32 s70, s70, s71
s_lshl_b32 s70, s70, 9
s_lshl_b32 s71, s5, 1
s_add_u32 s71, s71, s7
s_lshl_b32 s71, s71, 11
s_lshl_b32 s73, s72, 5
s_add_u32 s71, s71, s73
s_lshl_b32 s71, s71, 3
v_lshlrev_b32 v9, 3, v10
v_and_b32 v14, 1, v11
v_lshl_add_u32 v9, v14, 2, v9
v_lshrrev_b32 v14, 1, v11
v_lshl_add_u32 v9, v14, 7, v9
v_and_b32 v14, 1, v11
v_cmp_eq_u32 s[74:75], 0, v14
v_cmp_gt_u32 s[76:77], 2, v11
s_waitcnt lgkmcnt(0)
v_lshlrev_b32 v136, 16, v100
v_and_b32 v137, 0xffff0000, v100
v_pk_add_f32 v[16:17], v[16:17], v[136:137]
v_lshlrev_b32 v138, 16, v101
v_and_b32 v139, 0xffff0000, v101
v_pk_add_f32 v[18:19], v[18:19], v[138:139]
v_lshlrev_b32 v140, 16, v102
v_and_b32 v141, 0xffff0000, v102
v_pk_add_f32 v[20:21], v[20:21], v[140:141]
v_lshlrev_b32 v142, 16, v103
v_and_b32 v143, 0xffff0000, v103
v_pk_add_f32 v[22:23], v[22:23], v[142:143]
v_pk_add_f32 v[144:145], v[16:17], v[18:19]
v_pk_mul_f32 v[146:147], v[16:17], v[16:17]
v_pk_fma_f32 v[146:147], v[18:19], v[18:19], v[146:147]
v_pk_add_f32 v[144:145], v[144:145], v[20:21]
v_pk_fma_f32 v[146:147], v[20:21], v[20:21], v[146:147]
v_pk_add_f32 v[144:145], v[144:145], v[22:23]
v_pk_fma_f32 v[146:147], v[22:23], v[22:23], v[146:147]
v_add_f32 v120, v144, v145
v_add_f32 v121, v146, v147
v_mov_b32 v124, v120
s_nop 1
v_permlane16_swap_b32 v120, v124
v_add_f32 v120, v120, v124
v_mov_b32 v124, v120
s_nop 1
v_permlane32_swap_b32 v120, v124
v_add_f32 v120, v120, v124
v_mov_b32 v125, v121
s_nop 1
v_permlane16_swap_b32 v121, v125
v_add_f32 v121, v121, v125
v_mov_b32 v125, v121
s_nop 1
v_permlane32_swap_b32 v121, v125
v_add_f32 v121, v121, v125
v_lshlrev_b32 v136, 16, v104
v_and_b32 v137, 0xffff0000, v104
v_pk_add_f32 v[24:25], v[24:25], v[136:137]
v_lshlrev_b32 v138, 16, v105
v_and_b32 v139, 0xffff0000, v105
v_pk_add_f32 v[26:27], v[26:27], v[138:139]
v_lshlrev_b32 v140, 16, v106
v_and_b32 v141, 0xffff0000, v106
v_pk_add_f32 v[28:29], v[28:29], v[140:141]
v_lshlrev_b32 v142, 16, v107
v_and_b32 v143, 0xffff0000, v107
v_pk_add_f32 v[30:31], v[30:31], v[142:143]
v_pk_add_f32 v[144:145], v[24:25], v[26:27]
v_pk_mul_f32 v[146:147], v[24:25], v[24:25]
v_pk_fma_f32 v[146:147], v[26:27], v[26:27], v[146:147]
v_pk_add_f32 v[144:145], v[144:145], v[28:29]
v_pk_fma_f32 v[146:147], v[28:29], v[28:29], v[146:147]
v_pk_add_f32 v[144:145], v[144:145], v[30:31]
v_pk_fma_f32 v[146:147], v[30:31], v[30:31], v[146:147]
v_add_f32 v122, v144, v145
v_add_f32 v123, v146, v147
v_mov_b32 v124, v122
s_nop 1
v_permlane16_swap_b32 v122, v124
v_add_f32 v122, v122, v124
v_mov_b32 v124, v122
s_nop 1
v_permlane32_swap_b32 v122, v124
v_add_f32 v122, v122, v124
v_mov_b32 v125, v123
s_nop 1
v_permlane16_swap_b32 v123, v125
v_add_f32 v123, v123, v125
v_mov_b32 v125, v123
s_nop 1
v_permlane32_swap_b32 v123, v125
v_add_f32 v123, v123, v125
v_cndmask_b32 v124, v121, v120, s[74:75]
v_cndmask_b32 v125, v123, v122, s[74:75]
v_cndmask_b32 v124, v125, v124, s[76:77]
buffer_store_dword v124, v9, s[44:47], s71 offen sc1
v_cvt_pk_bf16_f32 v128, v16, v17
v_cvt_pk_bf16_f32 v129, v18, v19
v_cvt_pk_bf16_f32 v130, v24, v25
v_cvt_pk_bf16_f32 v131, v26, v27
s_nop 0
v_permlane16_swap_b32 v128, v130
v_permlane16_swap_b32 v129, v131
buffer_store_dwordx4 v[128:131], v15, s[40:43], s70 offen offset:0 sc1
v_cvt_pk_bf16_f32 v132, v20, v21
v_cvt_pk_bf16_f32 v133, v22, v23
v_cvt_pk_bf16_f32 v134, v28, v29
v_cvt_pk_bf16_f32 v135, v30, v31
s_nop 0
v_permlane16_swap_b32 v132, v134
v_permlane16_swap_b32 v133, v135
buffer_store_dwordx4 v[132:135], v15, s[40:43], s70 offen offset:1024 sc1
s_add_u32 s70, s70, 65536
s_add_u32 s71, s71, 256
v_lshlrev_b32 v136, 16, v108
v_and_b32 v137, 0xffff0000, v108
v_pk_add_f32 v[32:33], v[32:33], v[136:137]
v_lshlrev_b32 v138, 16, v109
v_and_b32 v139, 0xffff0000, v109
v_pk_add_f32 v[34:35], v[34:35], v[138:139]
v_lshlrev_b32 v140, 16, v110
v_and_b32 v141, 0xffff0000, v110
v_pk_add_f32 v[36:37], v[36:37], v[140:141]
v_lshlrev_b32 v142, 16, v111
v_and_b32 v143, 0xffff0000, v111
v_pk_add_f32 v[38:39], v[38:39], v[142:143]
v_pk_add_f32 v[144:145], v[32:33], v[34:35]
v_pk_mul_f32 v[146:147], v[32:33], v[32:33]
v_pk_fma_f32 v[146:147], v[34:35], v[34:35], v[146:147]
v_pk_add_f32 v[144:145], v[144:145], v[36:37]
v_pk_fma_f32 v[146:147], v[36:37], v[36:37], v[146:147]
v_pk_add_f32 v[144:145], v[144:145], v[38:39]
v_pk_fma_f32 v[146:147], v[38:39], v[38:39], v[146:147]
v_add_f32 v120, v144, v145
v_add_f32 v121, v146, v147
v_mov_b32 v124, v120
s_nop 1
v_permlane16_swap_b32 v120, v124
v_add_f32 v120, v120, v124
v_mov_b32 v124, v120
s_nop 1
v_permlane32_swap_b32 v120, v124
v_add_f32 v120, v120, v124
v_mov_b32 v125, v121
s_nop 1
v_permlane16_swap_b32 v121, v125
v_add_f32 v121, v121, v125
v_mov_b32 v125, v121
s_nop 1
v_permlane32_swap_b32 v121, v125
v_add_f32 v121, v121, v125
v_lshlrev_b32 v136, 16, v112
v_and_b32 v137, 0xffff0000, v112
v_pk_add_f32 v[40:41], v[40:41], v[136:137]
v_lshlrev_b32 v138, 16, v113
v_and_b32 v139, 0xffff0000, v113
v_pk_add_f32 v[42:43], v[42:43], v[138:139]
v_lshlrev_b32 v140, 16, v114
v_and_b32 v141, 0xffff0000, v114
v_pk_add_f32 v[44:45], v[44:45], v[140:141]
v_lshlrev_b32 v142, 16, v115
v_and_b32 v143, 0xffff0000, v115
v_pk_add_f32 v[46:47], v[46:47], v[142:143]
v_pk_add_f32 v[144:145], v[40:41], v[42:43]
v_pk_mul_f32 v[146:147], v[40:41], v[40:41]
v_pk_fma_f32 v[146:147], v[42:43], v[42:43], v[146:147]
v_pk_add_f32 v[144:145], v[144:145], v[44:45]
v_pk_fma_f32 v[146:147], v[44:45], v[44:45], v[146:147]
v_pk_add_f32 v[144:145], v[144:145], v[46:47]
v_pk_fma_f32 v[146:147], v[46:47], v[46:47], v[146:147]
v_add_f32 v122, v144, v145
v_add_f32 v123, v146, v147
v_mov_b32 v124, v122
s_nop 1
v_permlane16_swap_b32 v122, v124
v_add_f32 v122, v122, v124
v_mov_b32 v124, v122
s_nop 1
v_permlane32_swap_b32 v122, v124
v_add_f32 v122, v122, v124
v_mov_b32 v125, v123
s_nop 1
v_permlane16_swap_b32 v123, v125
v_add_f32 v123, v123, v125
v_mov_b32 v125, v123
s_nop 1
v_permlane32_swap_b32 v123, v125
v_add_f32 v123, v123, v125
v_cndmask_b32 v124, v121, v120, s[74:75]
v_cndmask_b32 v125, v123, v122, s[74:75]
v_cndmask_b32 v124, v125, v124, s[76:77]
buffer_store_dword v124, v9, s[44:47], s71 offen sc1
v_cvt_pk_bf16_f32 v128, v32, v33
v_cvt_pk_bf16_f32 v129, v34, v35
v_cvt_pk_bf16_f32 v130, v40, v41
v_cvt_pk_bf16_f32 v131, v42, v43
s_nop 0
v_permlane16_swap_b32 v128, v130
v_permlane16_swap_b32 v129, v131
buffer_store_dwordx4 v[128:131], v15, s[40:43], s70 offen offset:0 sc1
v_cvt_pk_bf16_f32 v132, v36, v37
v_cvt_pk_bf16_f32 v133, v38, v39
v_cvt_pk_bf16_f32 v134, v44, v45
v_cvt_pk_bf16_f32 v135, v46, v47
s_nop 0
v_permlane16_swap_b32 v132, v134
v_permlane16_swap_b32 v133, v135
buffer_store_dwordx4 v[132:135], v15, s[40:43], s70 offen offset:1024 sc1
s_barrier
s_waitcnt vmcnt(0)
v_mov_b32 v8, 163800
v_mov_b32 v9, 1
s_mov_b64 exec, 1
ds_add_rtn_u32 v9, v8, v9
s_waitcnt lgkmcnt(0)
s_nop 1
v_readfirstlane_b32 s72, v9
s_mov_b64 exec, -1
s_nop 2
s_cmp_lg_u32 s72, 3
s_cbranch_scc1 pub4
s_add_u32 s56, s8, 0x1200000
s_addc_u32 s57, s9, 0
s_mov_b32 s58, 0x8000
s_mov_b32 s59, 0x20000
s_lshl_b32 s70, s4, 7
s_lshl_b32 s71, s5, 3
s_add_u32 s71, s71, s70
v_mov_b32 v8, s28
v_mov_b32 v9, s29
v_mov_b32 v10, 8192
s_mov_b64 exec, 1
buffer_store_dwordx2 v[8:9], v10, s[56:59], s71 offen sc1
s_mov_b64 exec, -1
pub4:
s_and_b32 s4, s30, 1
s_lshr_b32 s5, s30, 1
s_mul_i32 s4, s4, 8
s_mul_i32 s5, s5, 4
s_and_b32 s64, s31, 7
s_add_u32 s4, s4, s64
s_lshr_b32 s64, s31, 3
s_add_u32 s5, s5, s64
v_and_b32 v10, 15, v1
v_lshrrev_b32 v11, 4, v1
s_lshl_b32 s64, s6, 13
v_lshlrev_b32 v13, 9, v11
v_lshl_add_u32 v13, v10, 4, v13
v_add_u32 v2, s64, v13
v_bfe_u32 v12, v1, 2, 2
v_lshlrev_b32 v12, 6, v12
v_and_b32 v13, 3, v1
v_lshl_add_u32 v12, v13, 3, v12
v_mul_u32_u24 v13, 3584, v11
v_add_u32 v12, v12, v13
v_and_b32 v13, 1, v11
v_lshl_add_u32 v12, v13, 5, v12
s_lshl_b32 s64, s7, 5
v_xor_b32 v12, s64, v12
v_xor_b32 v13, 32, v12
s_mul_i32 s64, s7, 768
v_add_u32 v6, s64, v12
s_lshl_b32 s64, s7, 10
v_add_u32 v7, s64, v13
s_mov_b32 s68, 45056
s_mov_b32 s69, 0xfffea000
v_mov_b32 v16, 0
v_mov_b32 v17, 0
v_mov_b32 v18, 0
v_mov_b32 v19, 0
v_mov_b32 v20, 0
v_mov_b32 v21, 0
v_mov_b32 v22, 0
v_mov_b32 v23, 0
v_mov_b32 v24, 0
v_mov_b32 v25, 0
v_mov_b32 v26, 0
v_mov_b32 v27, 0
v_mov_b32 v28, 0
v_mov_b32 v29, 0
v_mov_b32 v30, 0
v_mov_b32 v31, 0
v_mov_b32 v32, 0
v_mov_b32 v33, 0
v_mov_b32 v34, 0
v_mov_b32 v35, 0
v_mov_b32 v36, 0
v_mov_b32 v37, 0
v_mov_b32 v38, 0
v_mov_b32 v39, 0
v_mov_b32 v40, 0
v_mov_b32 v41, 0
v_mov_b32 v42, 0
v_mov_b32 v43, 0
v_mov_b32 v44, 0
v_mov_b32 v45, 0
v_mov_b32 v46, 0
v_mov_b32 v47, 0
v_mov_b32 v48, 0
v_mov_b32 v49, 0
v_mov_b32 v50, 0
v_mov_b32 v51, 0
v_mov_b32 v52, 0
v_mov_b32 v53, 0
v_mov_b32 v54, 0
v_mov_b32 v55, 0
v_mov_b32 v56, 0
v_mov_b32 v57, 0
v_mov_b32 v58, 0
v_mov_b32 v59, 0
v_mov_b32 v60, 0
v_mov_b32 v61, 0
v_mov_b32 v62, 0
v_mov_b32 v63, 0
v_mov_b32 v64, 0
v_mov_b32 v65, 0
v_mov_b32 v66, 0
v_mov_b32 v67, 0
v_mov_b32 v68, 0
v_mov_b32 v69, 0
v_mov_b32 v70, 0
v_mov_b32 v71, 0
v_mov_b32 v72, 0
v_mov_b32 v73, 0
v_mov_b32 v74, 0
v_mov_b32 v75, 0
v_mov_b32 v76, 0
v_mov_b32 v77, 0
v_mov_b32 v78, 0
v_mov_b32 v79, 0
v_mov_b32 v80, 0
v_mov_b32 v81, 0
v_mov_b32 v82, 0
v_mov_b32 v83, 0
v_mov_b32 v84, 0
v_mov_b32 v85, 0
v_mov_b32 v86, 0
v_mov_b32 v87, 0
v_mov_b32 v88, 0
v_mov_b32 v89, 0
v_mov_b32 v90, 0
v_mov_b32 v91, 0
v_mov_b32 v92, 0
v_mov_b32 v93, 0
v_mov_b32 v94, 0
v_mov_b32 v95, 0
v_mov_b32 v96, 0
v_mov_b32 v97, 0
v_mov_b32 v98, 0
v_mov_b32 v99, 0
v_mov_b32 v100, 0
v_mov_b32 v101, 0
v_mov_b32 v102, 0
v_mov_b32 v103, 0
v_mov_b32 v104, 0
v_mov_b32 v105, 0
v_mov_b32 v106, 0
v_mov_b32 v107, 0
v_mov_b32 v108, 0
v_mov_b32 v109, 0
v_mov_b32 v110, 0
v_mov_b32 v111, 0
v_mov_b32 v112, 0
v_mov_b32 v113, 0
v_mov_b32 v114, 0
v_mov_b32 v115, 0
v_mov_b32 v116, 0
v_mov_b32 v117, 0
v_mov_b32 v118, 0
v_mov_b32 v119, 0
v_mov_b32 v120, 0
v_mov_b32 v121, 0
v_mov_b32 v122, 0
v_mov_b32 v123, 0
v_mov_b32 v124, 0
v_mov_b32 v125, 0
v_mov_b32 v126, 0
v_mov_b32 v127, 0
v_mov_b32 v244, 0x3f803f80
v_mov_b32 v245, 0x3f803f80
v_mov_b32 v246, 0x3f803f80
v_mov_b32 v247, 0x3f803f80
s_barrier
s_barrier
ds_read_b64_tr_b16 v[160:161], v6 offset:16384
ds_read_b64_tr_b16 v[162:163], v6 offset:18176
ds_read_b128 v[128:131], v2 offset:0
ds_read_b128 v[132:135], v2 offset:256
ds_read_b128 v[136:139], v2 offset:4096
ds_read_b128 v[140:143], v2 offset:4352
ds_read_b64_tr_b16 v[164:165], v7 offset:16384
ds_read_b64_tr_b16 v[166:167], v7 offset:18176
ds_read_b64_tr_b16 v[168:169], v6 offset:16640
ds_read_b64_tr_b16 v[170:171], v6 offset:18432
ds_read_b64_tr_b16 v[172:173], v7 offset:16640
ds_read_b64_tr_b16 v[174:175], v7 offset:18432
ds_read_b64_tr_b16 v[176:177], v6 offset:16896
ds_read_b64_tr_b16 v[178:179], v6 offset:18688
ds_read_b64_tr_b16 v[180:181], v7 offset:16896
ds_read_b64_tr_b16 v[182:183], v7 offset:18688
ds_read_b64_tr_b16 v[184:185], v6 offset:17152
ds_read_b64_tr_b16 v[186:187], v6 offset:18944
s_mov_b32 s65, 0
s_mov_b32 s67, 0
s_waitcnt lgkmcnt(0)
v_mfma_f32_16x16x32_bf16 v[16:19], v[160:163], v[128:131], v[16:19]
ds_read_b64_tr_b16 v[188:189], v6 offset:30720
v_mfma_f32_16x16x32_bf16 v[44:47], v[160:163], v[132:135], v[44:47]
ds_read_b64_tr_b16 v[190:191], v6 offset:32512
v_mfma_f32_16x16x32_bf16 v[72:75], v[160:163], v[136:139], v[72:75]
ds_read_b128 v[144:147], v2 offset:2048
v_mfma_f32_16x16x32_bf16 v[100:103], v[160:163], v[140:143], v[100:103]
ds_read_b128 v[148:151], v2 offset:2304
v_mfma_f32_16x16x32_bf16 v[20:23], v[164:167], v[128:131], v[20:23]
ds_read_b128 v[152:155], v2 offset:6144
v_mfma_f32_16x16x32_bf16 v[48:51], v[164:167], v[132:135], v[48:51]
ds_read_b128 v[156:159], v2 offset:6400
v_mfma_f32_16x16x32_bf16 v[76:79], v[164:167], v[136:139], v[76:79]
ds_read_b64_tr_b16 v[192:193], v7 offset:30720
v_mfma_f32_16x16x32_bf16 v[104:107], v[164:167], v[140:143], v[104:107]
ds_read_b64_tr_b16 v[194:195], v7 offset:32512
v_mfma_f32_16x16x32_bf16 v[24:27], v[168:171], v[128:131], v[24:27]
ds_read_b64_tr_b16 v[196:197], v6 offset:30976
v_mfma_f32_16x16x32_bf16 v[52:55], v[168:171], v[132:135], v[52:55]
ds_read_b64_tr_b16 v[198:199], v6 offset:32768
v_mfma_f32_16x16x32_bf16 v[80:83], v[168:171], v[136:139], v[80:83]
ds_read_b64_tr_b16 v[200:201], v7 offset:30976
v_mfma_f32_16x16x32_bf16 v[108:111], v[168:171], v[140:143], v[108:111]
ds_read_b64_tr_b16 v[202:203], v7 offset:32768
v_mfma_f32_16x16x32_bf16 v[28:31], v[172:175], v[128:131], v[28:31]
ds_read_b64_tr_b16 v[204:205], v6 offset:31232
v_mfma_f32_16x16x32_bf16 v[56:59], v[172:175], v[132:135], v[56:59]
ds_read_b64_tr_b16 v[206:207], v6 offset:33024
v_mfma_f32_16x16x32_bf16 v[84:87], v[172:175], v[136:139], v[84:87]
ds_read_b64_tr_b16 v[208:209], v7 offset:31232
v_mfma_f32_16x16x32_bf16 v[112:115], v[172:175], v[140:143], v[112:115]
ds_read_b64_tr_b16 v[210:211], v7 offset:33024
v_mfma_f32_16x16x32_bf16 v[32:35], v[176:179], v[128:131], v[32:35]
ds_read_b64_tr_b16 v[212:213], v6 offset:31488
v_mfma_f32_16x16x32_bf16 v[60:63], v[176:179], v[132:135], v[60:63]
ds_read_b64_tr_b16 v[214:215], v6 offset:33280
v_mfma_f32_16x16x32_bf16 v[88:91], v[176:179], v[136:139], v[88:91]
v_mfma_f32_16x16x32_bf16 v[116:119], v[176:179], v[140:143], v[116:119]
v_mfma_f32_16x16x32_bf16 v[36:39], v[180:183], v[128:131], v[36:39]
v_mfma_f32_16x16x32_bf16 v[64:67], v[180:183], v[132:135], v[64:67]
v_mfma_f32_16x16x32_bf16 v[92:95], v[180:183], v[136:139], v[92:95]
v_mfma_f32_16x16x32_bf16 v[120:123], v[180:183], v[140:143], v[120:123]
v_mfma_f32_16x16x32_bf16 v[40:43], v[184:187], v[128:131], v[40:43]
v_mfma_f32_16x16x32_bf16 v[68:71], v[184:187], v[132:135], v[68:71]
v_mfma_f32_16x16x32_bf16 v[96:99], v[184:187], v[136:139], v[96:99]
v_mfma_f32_16x16x32_bf16 v[124:127], v[184:187], v[140:143], v[124:127]
v_mfma_f32_16x16x32_bf16 v[216:219], v[160:163], v[244:247], 0
v_mfma_f32_16x16x32_bf16 v[220:223], v[164:167], v[244:247], 0
v_mfma_f32_16x16x32_bf16 v[224:227], v[168:171], v[244:247], 0
v_mfma_f32_16x16x32_bf16 v[228:231], v[172:175], v[244:247], 0
v_mfma_f32_16x16x32_bf16 v[232:235], v[176:179], v[244:247], 0
v_mfma_f32_16x16x32_bf16 v[236:239], v[180:183], v[244:247], 0
v_mfma_f32_16x16x32_bf16 v[240:243], v[184:187], v[244:247], 0
s_waitcnt lgkmcnt(0)
s_add_u32 s67, s67, 1
s_cmp_eq_u32 s67, 3
s_cselect_b32 s66, s69, s68
s_cselect_b32 s67, 0, s67
v_add_u32 v2, s66, v2
v_add_u32 v6, s66, v6
v_add_u32 v7, s66, v7
s_barrier
v_mfma_f32_16x16x32_bf16 v[16:19], v[188:191], v[144:147], v[16:19]
ds_read_b64_tr_b16 v[160:161], v6 offset:16384
v_mfma_f32_16x16x32_bf16 v[44:47], v[188:191], v[148:151], v[44:47]
ds_read_b64_tr_b16 v[162:163], v6 offset:18176
v_mfma_f32_16x16x32_bf16 v[72:75], v[188:191], v[152:155], v[72:75]
ds_read_b128 v[128:131], v2 offset:0
v_mfma_f32_16x16x32_bf16 v[100:103], v[188:191], v[156:159], v[100:103]
ds_read_b128 v[132:135], v2 offset:256
v_mfma_f32_16x16x32_bf16 v[20:23], v[192:195], v[144:147], v[20:23]
ds_read_b128 v[136:139], v2 offset:4096
v_mfma_f32_16x16x32_bf16 v[48:51], v[192:195], v[148:151], v[48:51]
ds_read_b128 v[140:143], v2 offset:4352
v_mfma_f32_16x16x32_bf16 v[76:79], v[192:195], v[152:155], v[76:79]
ds_read_b64_tr_b16 v[164:165], v7 offset:16384
v_mfma_f32_16x16x32_bf16 v[104:107], v[192:195], v[156:159], v[104:107]
ds_read_b64_tr_b16 v[166:167], v7 offset:18176
v_mfma_f32_16x16x32_bf16 v[24:27], v[196:199], v[144:147], v[24:27]
ds_read_b64_tr_b16 v[168:169], v6 offset:16640
v_mfma_f32_16x16x32_bf16 v[52:55], v[196:199], v[148:151], v[52:55]
ds_read_b64_tr_b16 v[170:171], v6 offset:18432
v_mfma_f32_16x16x32_bf16 v[80:83], v[196:199], v[152:155], v[80:83]
ds_read_b64_tr_b16 v[172:173], v7 offset:16640
v_mfma_f32_16x16x32_bf16 v[108:111], v[196:199], v[156:159], v[108:111]
ds_read_b64_tr_b16 v[174:175], v7 offset:18432
v_mfma_f32_16x16x32_bf16 v[28:31], v[200:203], v[144:147], v[28:31]
ds_read_b64_tr_b16 v[176:177], v6 offset:16896
v_mfma_f32_16x16x32_bf16 v[56:59], v[200:203], v[148:151], v[56:59]
ds_read_b64_tr_b16 v[178:179], v6 offset:18688
v_mfma_f32_16x16x32_bf16 v[84:87], v[200:203], v[152:155], v[84:87]
ds_read_b64_tr_b16 v[180:181], v7 offset:16896
v_mfma_f32_16x16x32_bf16 v[112:115], v[200:203], v[156:159], v[112:115]
ds_read_b64_tr_b16 v[182:183], v7 offset:18688
v_mfma_f32_16x16x32_bf16 v[32:35], v[204:207], v[144:147], v[32:35]
ds_read_b64_tr_b16 v[184:185], v6 offset:17152
v_mfma_f32_16x16x32_bf16 v[60:63], v[204:207], v[148:151], v[60:63]
ds_read_b64_tr_b16 v[186:187], v6 offset:18944
v_mfma_f32_16x16x32_bf16 v[88:91], v[204:207], v[152:155], v[88:91]
v_mfma_f32_16x16x32_bf16 v[116:119], v[204:207], v[156:159], v[116:119]
v_mfma_f32_16x16x32_bf16 v[36:39], v[208:211], v[144:147], v[36:39]
v_mfma_f32_16x16x32_bf16 v[64:67], v[208:211], v[148:151], v[64:67]
v_mfma_f32_16x16x32_bf16 v[92:95], v[208:211], v[152:155], v[92:95]
v_mfma_f32_16x16x32_bf16 v[120:123], v[208:211], v[156:159], v[120:123]
v_mfma_f32_16x16x32_bf16 v[40:43], v[212:215], v[144:147], v[40:43]
v_mfma_f32_16x16x32_bf16 v[68:71], v[212:215], v[148:151], v[68:71]
v_mfma_f32_16x16x32_bf16 v[96:99], v[212:215], v[152:155], v[96:99]
v_mfma_f32_16x16x32_bf16 v[124:127], v[212:215], v[156:159], v[124:127]
v_mfma_f32_16x16x32_bf16 v[216:219], v[188:191], v[244:247], v[216:219]
v_mfma_f32_16x16x32_bf16 v[220:223], v[192:195], v[244:247], v[220:223]
v_mfma_f32_16x16x32_bf16 v[224:227], v[196:199], v[244:247], v[224:227]
v_mfma_f32_16x16x32_bf16 v[228:231], v[200:203], v[244:247], v[228:231]
v_mfma_f32_16x16x32_bf16 v[232:235], v[204:207], v[244:247], v[232:235]
v_mfma_f32_16x16x32_bf16 v[236:239], v[208:211], v[244:247], v[236:239]
v_mfma_f32_16x16x32_bf16 v[240:243], v[212:215], v[244:247], v[240:243]
s_cmp_lg_u32 s6, 0
s_cbranch_scc1 p4a0_nocs
s_mul_i32 s70, s7, 448
s_add_u32 s70, s70, 138240
v_lshrrev_b32 v8, 4, v1
v_lshlrev_b32 v8, 4, v8
v_add_u32 v8, s70, v8
s_mov_b32 exec_lo, 0x00010001
s_mov_b32 exec_hi, 0x00010001
ds_write_b128 v8, v[216:219] offset:0
ds_write_b128 v8, v[220:223] offset:64
ds_write_b128 v8, v[224:227] offset:128
ds_write_b128 v8, v[228:231] offset:192
ds_write_b128 v8, v[232:235] offset:256
ds_write_b128 v8, v[236:239] offset:320
ds_write_b128 v8, v[240:243] offset:384
s_mov_b64 exec, -1
p4a0_nocs:
s_mov_b32 s65, 1
p4_loop:
s_waitcnt lgkmcnt(0)
s_nop 1
v_mfma_f32_16x16x32_bf16 v[16:19], v[160:163], v[128:131], v[16:19]
ds_read_b64_tr_b16 v[188:189], v6 offset:30720
v_mfma_f32_16x16x32_bf16 v[44:47], v[160:163], v[132:135], v[44:47]
ds_read_b64_tr_b16 v[190:191], v6 offset:32512
v_mfma_f32_16x16x32_bf16 v[72:75], v[160:163], v[136:139], v[72:75]
ds_read_b128 v[144:147], v2 offset:2048
v_mfma_f32_16x16x32_bf16 v[100:103], v[160:163], v[140:143], v[100:103]
ds_read_b128 v[148:151], v2 offset:2304
v_mfma_f32_16x16x32_bf16 v[20:23], v[164:167], v[128:131], v[20:23]
ds_read_b128 v[152:155], v2 offset:6144
v_mfma_f32_16x16x32_bf16 v[48:51], v[164:167], v[132:135], v[48:51]
ds_read_b128 v[156:159], v2 offset:6400
v_mfma_f32_16x16x32_bf16 v[76:79], v[164:167], v[136:139], v[76:79]
ds_read_b64_tr_b16 v[192:193], v7 offset:30720
v_mfma_f32_16x16x32_bf16 v[104:107], v[164:167], v[140:143], v[104:107]
ds_read_b64_tr_b16 v[194:195], v7 offset:32512
v_mfma_f32_16x16x32_bf16 v[24:27], v[168:171], v[128:131], v[24:27]
ds_read_b64_tr_b16 v[196:197], v6 offset:30976
v_mfma_f32_16x16x32_bf16 v[52:55], v[168:171], v[132:135], v[52:55]
ds_read_b64_tr_b16 v[198:199], v6 offset:32768
v_mfma_f32_16x16x32_bf16 v[80:83], v[168:171], v[136:139], v[80:83]
ds_read_b64_tr_b16 v[200:201], v7 offset:30976
v_mfma_f32_16x16x32_bf16 v[108:111], v[168:171], v[140:143], v[108:111]
ds_read_b64_tr_b16 v[202:203], v7 offset:32768
v_mfma_f32_16x16x32_bf16 v[28:31], v[172:175], v[128:131], v[28:31]
ds_read_b64_tr_b16 v[204:205], v6 offset:31232
v_mfma_f32_16x16x32_bf16 v[56:59], v[172:175], v[132:135], v[56:59]
ds_read_b64_tr_b16 v[206:207], v6 offset:33024
v_mfma_f32_16x16x32_bf16 v[84:87], v[172:175], v[136:139], v[84:87]
ds_read_b64_tr_b16 v[208:209], v7 offset:31232
v_mfma_f32_16x16x32_bf16 v[112:115], v[172:175], v[140:143], v[112:115]
ds_read_b64_tr_b16 v[210:211], v7 offset:33024
v_mfma_f32_16x16x32_bf16 v[32:35], v[176:179], v[128:131], v[32:35]
ds_read_b64_tr_b16 v[212:213], v6 offset:31488
v_mfma_f32_16x16x32_bf16 v[60:63], v[176:179], v[132:135], v[60:63]
ds_read_b64_tr_b16 v[214:215], v6 offset:33280
v_mfma_f32_16x16x32_bf16 v[88:91], v[176:179], v[136:139], v[88:91]
v_mfma_f32_16x16x32_bf16 v[116:119], v[176:179], v[140:143], v[116:119]
v_mfma_f32_16x16x32_bf16 v[36:39], v[180:183], v[128:131], v[36:39]
v_mfma_f32_16x16x32_bf16 v[64:67], v[180:183], v[132:135], v[64:67]
v_mfma_f32_16x16x32_bf16 v[92:95], v[180:183], v[136:139], v[92:95]
v_mfma_f32_16x16x32_bf16 v[120:123], v[180:183], v[140:143], v[120:123]
v_mfma_f32_16x16x32_bf16 v[40:43], v[184:187], v[128:131], v[40:43]
v_mfma_f32_16x16x32_bf16 v[68:71], v[184:187], v[132:135], v[68:71]
v_mfma_f32_16x16x32_bf16 v[96:99], v[184:187], v[136:139], v[96:99]
v_mfma_f32_16x16x32_bf16 v[124:127], v[184:187], v[140:143], v[124:127]
s_waitcnt lgkmcnt(0)
s_add_u32 s67, s67, 1
s_cmp_eq_u32 s67, 3
s_cselect_b32 s66, s69, s68
s_cselect_b32 s67, 0, s67
v_add_u32 v2, s66, v2
v_add_u32 v6, s66, v6
v_add_u32 v7, s66, v7
s_barrier
v_mfma_f32_16x16x32_bf16 v[16:19], v[188:191], v[144:147], v[16:19]
ds_read_b64_tr_b16 v[160:161], v6 offset:16384
v_mfma_f32_16x16x32_bf16 v[44:47], v[188:191], v[148:151], v[44:47]
ds_read_b64_tr_b16 v[162:163], v6 offset:18176
v_mfma_f32_16x16x32_bf16 v[72:75], v[188:191], v[152:155], v[72:75]
ds_read_b128 v[128:131], v2 offset:0
v_mfma_f32_16x16x32_bf16 v[100:103], v[188:191], v[156:159], v[100:103]
ds_read_b128 v[132:135], v2 offset:256
v_mfma_f32_16x16x32_bf16 v[20:23], v[192:195], v[144:147], v[20:23]
ds_read_b128 v[136:139], v2 offset:4096
v_mfma_f32_16x16x32_bf16 v[48:51], v[192:195], v[148:151], v[48:51]
ds_read_b128 v[140:143], v2 offset:4352
v_mfma_f32_16x16x32_bf16 v[76:79], v[192:195], v[152:155], v[76:79]
ds_read_b64_tr_b16 v[164:165], v7 offset:16384
v_mfma_f32_16x16x32_bf16 v[104:107], v[192:195], v[156:159], v[104:107]
ds_read_b64_tr_b16 v[166:167], v7 offset:18176
v_mfma_f32_16x16x32_bf16 v[24:27], v[196:199], v[144:147], v[24:27]
ds_read_b64_tr_b16 v[168:169], v6 offset:16640
v_mfma_f32_16x16x32_bf16 v[52:55], v[196:199], v[148:151], v[52:55]
ds_read_b64_tr_b16 v[170:171], v6 offset:18432
v_mfma_f32_16x16x32_bf16 v[80:83], v[196:199], v[152:155], v[80:83]
ds_read_b64_tr_b16 v[172:173], v7 offset:16640
v_mfma_f32_16x16x32_bf16 v[108:111], v[196:199], v[156:159], v[108:111]
ds_read_b64_tr_b16 v[174:175], v7 offset:18432
v_mfma_f32_16x16x32_bf16 v[28:31], v[200:203], v[144:147], v[28:31]
ds_read_b64_tr_b16 v[176:177], v6 offset:16896
v_mfma_f32_16x16x32_bf16 v[56:59], v[200:203], v[148:151], v[56:59]
ds_read_b64_tr_b16 v[178:179], v6 offset:18688
v_mfma_f32_16x16x32_bf16 v[84:87], v[200:203], v[152:155], v[84:87]
ds_read_b64_tr_b16 v[180:181], v7 offset:16896
v_mfma_f32_16x16x32_bf16 v[112:115], v[200:203], v[156:159], v[112:115]
ds_read_b64_tr_b16 v[182:183], v7 offset:18688
v_mfma_f32_16x16x32_bf16 v[32:35], v[204:207], v[144:147], v[32:35]
ds_read_b64_tr_b16 v[184:185], v6 offset:17152
v_mfma_f32_16x16x32_bf16 v[60:63], v[204:207], v[148:151], v[60:63]
ds_read_b64_tr_b16 v[186:187], v6 offset:18944
v_mfma_f32_16x16x32_bf16 v[88:91], v[204:207], v[152:155], v[88:91]
v_mfma_f32_16x16x32_bf16 v[116:119], v[204:207], v[156:159], v[116:119]
v_mfma_f32_16x16x32_bf16 v[36:39], v[208:211], v[144:147], v[36:39]
v_mfma_f32_16x16x32_bf16 v[64:67], v[208:211], v[148:151], v[64:67]
v_mfma_f32_16x16x32_bf16 v[92:95], v[208:211], v[152:155], v[92:95]
v_mfma_f32_16x16x32_bf16 v[120:123], v[208:211], v[156:159], v[120:123]
v_mfma_f32_16x16x32_bf16 v[40:43], v[212:215], v[144:147], v[40:43]
v_mfma_f32_16x16x32_bf16 v[68:71], v[212:215], v[148:151], v[68:71]
v_mfma_f32_16x16x32_bf16 v[96:99], v[212:215], v[152:155], v[96:99]
v_mfma_f32_16x16x32_bf16 v[124:127], v[212:215], v[156:159], v[124:127]
s_add_u32 s65, s65, 1
s_cmp_lt_u32 s65, 16
s_cbranch_scc1 p4_loop
s_waitcnt lgkmcnt(0)
s_add_u32 s40, s8, 0x1400000
s_addc_u32 s41, s9, 0
s_mov_b32 s42, 0xe00000
s_mov_b32 s43, 0x20000
v_and_b32 v10, 15, v1
v_lshrrev_b32 v11, 4, v1
s_mul_i32 s70, s7, 448
s_add_u32 s70, s70, 135168
v_lshlrev_b32 v12, 4, v11
v_add_u32 v12, s70, v12
s_lshl_b32 s70, s6, 9
s_add_u32 s70, s70, 137216
v_lshlrev_b32 v13, 3, v10
v_add_u32 v13, s70, v13
ds_read_b64 v[128:129], v13 offset:0
ds_read_b64 v[130:131], v13 offset:128
ds_read_b64 v[132:133], v13 offset:256
ds_read_b64 v[134:135], v13 offset:384
v_lshlrev_b32 v15, 4, v1
s_lshl_b32 s70, s4, 2
s_lshl_b32 s71, s6, 1
s_add_u32 s70, s70, s71
s_mul_i32 s70, s70, 448
s_mul_i32 s71, s5, 28
s_add_u32 s70, s70, s71
s_mul_i32 s71, s7, 14
s_add_u32 s70, s70, s71
s_lshl_b32 s70, s70, 9
s_add_u32 s71, s70, 229376
ds_read_b128 v[136:139], v12 offset:0
ds_read_b128 v[140:143], v12 offset:1024
ds_read_b128 v[144:147], v12 offset:64
ds_read_b128 v[148:151], v12 offset:1088
ds_read_b128 v[152:155], v12 offset:128
ds_read_b128 v[156:159], v12 offset:1152
ds_read_b128 v[160:163], v12 offset:192
ds_read_b128 v[164:167], v12 offset:1216
ds_read_b128 v[168:171], v12 offset:256
ds_read_b128 v[172:175], v12 offset:1280
ds_read_b128 v[176:179], v12 offset:320
ds_read_b128 v[180:183], v12 offset:1344
ds_read_b128 v[184:187], v12 offset:384
ds_read_b128 v[188:191], v12 offset:1408
v_add_u32 v14, 4096, v15
s_waitcnt lgkmcnt(0)
v_pk_fma_f32 v[192:193], v[136:137], v[128:129], v[140:141] op_sel:[0,1,0] op_sel_hi:[1,1,1]
v_pk_fma_f32 v[194:195], v[138:139], v[128:129], v[142:143] op_sel:[0,1,0] op_sel_hi:[1,1,1]
v_pk_fma_f32 v[196:197], v[136:137], v[130:131], v[140:141] op_sel:[0,1,0] op_sel_hi:[1,1,1]
v_pk_fma_f32 v[198:199], v[138:139], v[130:131], v[142:143] op_sel:[0,1,0] op_sel_hi:[1,1,1]
v_pk_fma_f32 v[200:201], v[136:137], v[132:133], v[140:141] op_sel:[0,1,0] op_sel_hi:[1,1,1]
v_pk_fma_f32 v[202:203], v[138:139], v[132:133], v[142:143] op_sel:[0,1,0] op_sel_hi:[1,1,1]
v_pk_fma_f32 v[204:205], v[136:137], v[134:135], v[140:141] op_sel:[0,1,0] op_sel_hi:[1,1,1]
v_pk_fma_f32 v[206:207], v[138:139], v[134:135], v[142:143] op_sel:[0,1,0] op_sel_hi:[1,1,1]
v_pk_fma_f32 v[16:17], v[16:17], v[128:129], v[192:193] op_sel:[0,0,0] op_sel_hi:[1,0,1]
v_pk_fma_f32 v[18:19], v[18:19], v[128:129], v[194:195] op_sel:[0,0,0] op_sel_hi:[1,0,1]
v_pk_fma_f32 v[44:45], v[44:45], v[130:131], v[196:197] op_sel:[0,0,0] op_sel_hi:[1,0,1]
v_pk_fma_f32 v[46:47], v[46:47], v[130:131], v[198:199] op_sel:[0,0,0] op_sel_hi:[1,0,1]
v_pk_fma_f32 v[72:73], v[72:73], v[132:133], v[200:201] op_sel:[0,0,0] op_sel_hi:[1,0,1]
v_pk_fma_f32 v[74:75], v[74:75], v[132:133], v[202:203] op_sel:[0,0,0] op_sel_hi:[1,0,1]
v_pk_fma_f32 v[100:101], v[100:101], v[134:135], v[204:205] op_sel:[0,0,0] op_sel_hi:[1,0,1]
v_pk_fma_f32 v[102:103], v[102:103], v[134:135], v[206:207] op_sel:[0,0,0] op_sel_hi:[1,0,1]
v_max_f32 v16, 0, v16
v_max_f32 v17, 0, v17
v_max_f32 v18, 0, v18
v_max_f32 v19, 0, v19
v_max_f32 v44, 0, v44
v_max_f32 v45, 0, v45
v_max_f32 v46, 0, v46
v_max_f32 v47, 0, v47
v_max_f32 v72, 0, v72
v_max_f32 v73, 0, v73
v_max_f32 v74, 0, v74
v_max_f32 v75, 0, v75
v_max_f32 v100, 0, v100
v_max_f32 v101, 0, v101
v_max_f32 v102, 0, v102
v_max_f32 v103, 0, v103
v_pk_mul_f32 v[16:17], v[16:17], v[16:17]
v_pk_mul_f32 v[18:19], v[18:19], v[18:19]
v_pk_mul_f32 v[44:45], v[44:45], v[44:45]
v_pk_mul_f32 v[46:47], v[46:47], v[46:47]
v_pk_mul_f32 v[72:73], v[72:73], v[72:73]
v_pk_mul_f32 v[74:75], v[74:75], v[74:75]
v_pk_mul_f32 v[100:101], v[100:101], v[100:101]
v_pk_mul_f32 v[102:103], v[102:103], v[102:103]
v_cvt_pk_bf16_f32 v208, v16, v17
v_cvt_pk_bf16_f32 v209, v18, v19
v_cvt_pk_bf16_f32 v210, v44, v45
v_cvt_pk_bf16_f32 v211, v46, v47
s_nop 0
v_permlane16_swap_b32 v208, v210
v_permlane16_swap_b32 v209, v211
buffer_store_dwordx4 v[208:211], v15, s[40:43], s70 offen offset:0 sc1
v_cvt_pk_bf16_f32 v212, v72, v73
v_cvt_pk_bf16_f32 v213, v74, v75
v_cvt_pk_bf16_f32 v214, v100, v101
v_cvt_pk_bf16_f32 v215, v102, v103
s_nop 0
v_permlane16_swap_b32 v212, v214
v_permlane16_swap_b32 v213, v215
buffer_store_dwordx4 v[212:215], v15, s[40:43], s71 offen offset:0 sc1
v_pk_fma_f32 v[192:193], v[144:145], v[128:129], v[148:149] op_sel:[0,1,0] op_sel_hi:[1,1,1]
v_pk_fma_f32 v[194:195], v[146:147], v[128:129], v[150:151] op_sel:[0,1,0] op_sel_hi:[1,1,1]
v_pk_fma_f32 v[196:197], v[144:145], v[130:131], v[148:149] op_sel:[0,1,0] op_sel_hi:[1,1,1]
v_pk_fma_f32 v[198:199], v[146:147], v[130:131], v[150:151] op_sel:[0,1,0] op_sel_hi:[1,1,1]
v_pk_fma_f32 v[200:201], v[144:145], v[132:133], v[148:149] op_sel:[0,1,0] op_sel_hi:[1,1,1]
v_pk_fma_f32 v[202:203], v[146:147], v[132:133], v[150:151] op_sel:[0,1,0] op_sel_hi:[1,1,1]
v_pk_fma_f32 v[204:205], v[144:145], v[134:135], v[148:149] op_sel:[0,1,0] op_sel_hi:[1,1,1]
v_pk_fma_f32 v[206:207], v[146:147], v[134:135], v[150:151] op_sel:[0,1,0] op_sel_hi:[1,1,1]
v_pk_fma_f32 v[20:21], v[20:21], v[128:129], v[192:193] op_sel:[0,0,0] op_sel_hi:[1,0,1]
v_pk_fma_f32 v[22:23], v[22:23], v[128:129], v[194:195] op_sel:[0,0,0] op_sel_hi:[1,0,1]
v_pk_fma_f32 v[48:49], v[48:49], v[130:131], v[196:197] op_sel:[0,0,0] op_sel_hi:[1,0,1]
v_pk_fma_f32 v[50:51], v[50:51], v[130:131], v[198:199] op_sel:[0,0,0] op_sel_hi:[1,0,1]
v_pk_fma_f32 v[76:77], v[76:77], v[132:133], v[200:201] op_sel:[0,0,0] op_sel_hi:[1,0,1]
v_pk_fma_f32 v[78:79], v[78:79], v[132:133], v[202:203] op_sel:[0,0,0] op_sel_hi:[1,0,1]
v_pk_fma_f32 v[104:105], v[104:105], v[134:135], v[204:205] op_sel:[0,0,0] op_sel_hi:[1,0,1]
v_pk_fma_f32 v[106:107], v[106:107], v[134:135], v[206:207] op_sel:[0,0,0] op_sel_hi:[1,0,1]
v_max_f32 v20, 0, v20
v_max_f32 v21, 0, v21
v_max_f32 v22, 0, v22
v_max_f32 v23, 0, v23
v_max_f32 v48, 0, v48
v_max_f32 v49, 0, v49
v_max_f32 v50, 0, v50
v_max_f32 v51, 0, v51
v_max_f32 v76, 0, v76
v_max_f32 v77, 0, v77
v_max_f32 v78, 0, v78
v_max_f32 v79, 0, v79
v_max_f32 v104, 0, v104
v_max_f32 v105, 0, v105
v_max_f32 v106, 0, v106
v_max_f32 v107, 0, v107
v_pk_mul_f32 v[20:21], v[20:21], v[20:21]
v_pk_mul_f32 v[22:23], v[22:23], v[22:23]
v_pk_mul_f32 v[48:49], v[48:49], v[48:49]
v_pk_mul_f32 v[50:51], v[50:51], v[50:51]
v_pk_mul_f32 v[76:77], v[76:77], v[76:77]
v_pk_mul_f32 v[78:79], v[78:79], v[78:79]
v_pk_mul_f32 v[104:105], v[104:105], v[104:105]
v_pk_mul_f32 v[106:107], v[106:107], v[106:107]
v_cvt_pk_bf16_f32 v216, v20, v21
v_cvt_pk_bf16_f32 v217, v22, v23
v_cvt_pk_bf16_f32 v218, v48, v49
v_cvt_pk_bf16_f32 v219, v50, v51
s_nop 0
v_permlane16_swap_b32 v216, v218
v_permlane16_swap_b32 v217, v219
buffer_store_dwordx4 v[216:219], v15, s[40:43], s70 offen offset:1024 sc1
v_cvt_pk_bf16_f32 v220, v76, v77
v_cvt_pk_bf16_f32 v221, v78, v79
v_cvt_pk_bf16_f32 v222, v104, v105
v_cvt_pk_bf16_f32 v223, v106, v107
s_nop 0
v_permlane16_swap_b32 v220, v222
v_permlane16_swap_b32 v221, v223
buffer_store_dwordx4 v[220:223], v15, s[40:43], s71 offen offset:1024 sc1
v_pk_fma_f32 v[192:193], v[152:153], v[128:129], v[156:157] op_sel:[0,1,0] op_sel_hi:[1,1,1]
v_pk_fma_f32 v[194:195], v[154:155], v[128:129], v[158:159] op_sel:[0,1,0] op_sel_hi:[1,1,1]
v_pk_fma_f32 v[196:197], v[152:153], v[130:131], v[156:157] op_sel:[0,1,0] op_sel_hi:[1,1,1]
v_pk_fma_f32 v[198:199], v[154:155], v[130:131], v[158:159] op_sel:[0,1,0] op_sel_hi:[1,1,1]
v_pk_fma_f32 v[200:201], v[152:153], v[132:133], v[156:157] op_sel:[0,1,0] op_sel_hi:[1,1,1]
v_pk_fma_f32 v[202:203], v[154:155], v[132:133], v[158:159] op_sel:[0,1,0] op_sel_hi:[1,1,1]
v_pk_fma_f32 v[204:205], v[152:153], v[134:135], v[156:157] op_sel:[0,1,0] op_sel_hi:[1,1,1]
v_pk_fma_f32 v[206:207], v[154:155], v[134:135], v[158:159] op_sel:[0,1,0] op_sel_hi:[1,1,1]
v_pk_fma_f32 v[24:25], v[24:25], v[128:129], v[192:193] op_sel:[0,0,0] op_sel_hi:[1,0,1]
v_pk_fma_f32 v[26:27], v[26:27], v[128:129], v[194:195] op_sel:[0,0,0] op_sel_hi:[1,0,1]
v_pk_fma_f32 v[52:53], v[52:53], v[130:131], v[196:197] op_sel:[0,0,0] op_sel_hi:[1,0,1]
v_pk_fma_f32 v[54:55], v[54:55], v[130:131], v[198:199] op_sel:[0,0,0] op_sel_hi:[1,0,1]
v_pk_fma_f32 v[80:81], v[80:81], v[132:133], v[200:201] op_sel:[0,0,0] op_sel_hi:[1,0,1]
v_pk_fma_f32 v[82:83], v[82:83], v[132:133], v[202:203] op_sel:[0,0,0] op_sel_hi:[1,0,1]
v_pk_fma_f32 v[108:109], v[108:109], v[134:135], v[204:205] op_sel:[0,0,0] op_sel_hi:[1,0,1]
v_pk_fma_f32 v[110:111], v[110:111], v[134:135], v[206:207] op_sel:[0,0,0] op_sel_hi:[1,0,1]
v_max_f32 v24, 0, v24
v_max_f32 v25, 0, v25
v_max_f32 v26, 0, v26
v_max_f32 v27, 0, v27
v_max_f32 v52, 0, v52
v_max_f32 v53, 0, v53
v_max_f32 v54, 0, v54
v_max_f32 v55, 0, v55
v_max_f32 v80, 0, v80
v_max_f32 v81, 0, v81
v_max_f32 v82, 0, v82
v_max_f32 v83, 0, v83
v_max_f32 v108, 0, v108
v_max_f32 v109, 0, v109
v_max_f32 v110, 0, v110
v_max_f32 v111, 0, v111
v_pk_mul_f32 v[24:25], v[24:25], v[24:25]
v_pk_mul_f32 v[26:27], v[26:27], v[26:27]
v_pk_mul_f32 v[52:53], v[52:53], v[52:53]
v_pk_mul_f32 v[54:55], v[54:55], v[54:55]
v_pk_mul_f32 v[80:81], v[80:81], v[80:81]
v_pk_mul_f32 v[82:83], v[82:83], v[82:83]
v_pk_mul_f32 v[108:109], v[108:109], v[108:109]
v_pk_mul_f32 v[110:111], v[110:111], v[110:111]
v_cvt_pk_bf16_f32 v208, v24, v25
v_cvt_pk_bf16_f32 v209, v26, v27
v_cvt_pk_bf16_f32 v210, v52, v53
v_cvt_pk_bf16_f32 v211, v54, v55
s_nop 0
v_permlane16_swap_b32 v208, v210
v_permlane16_swap_b32 v209, v211
buffer_store_dwordx4 v[208:211], v15, s[40:43], s70 offen offset:2048 sc1
v_cvt_pk_bf16_f32 v212, v80, v81
v_cvt_pk_bf16_f32 v213, v82, v83
v_cvt_pk_bf16_f32 v214, v108, v109
v_cvt_pk_bf16_f32 v215, v110, v111
s_nop 0
v_permlane16_swap_b32 v212, v214
v_permlane16_swap_b32 v213, v215
buffer_store_dwordx4 v[212:215], v15, s[40:43], s71 offen offset:2048 sc1
v_pk_fma_f32 v[192:193], v[160:161], v[128:129], v[164:165] op_sel:[0,1,0] op_sel_hi:[1,1,1]
v_pk_fma_f32 v[194:195], v[162:163], v[128:129], v[166:167] op_sel:[0,1,0] op_sel_hi:[1,1,1]
v_pk_fma_f32 v[196:197], v[160:161], v[130:131], v[164:165] op_sel:[0,1,0] op_sel_hi:[1,1,1]
v_pk_fma_f32 v[198:199], v[162:163], v[130:131], v[166:167] op_sel:[0,1,0] op_sel_hi:[1,1,1]
v_pk_fma_f32 v[200:201], v[160:161], v[132:133], v[164:165] op_sel:[0,1,0] op_sel_hi:[1,1,1]
v_pk_fma_f32 v[202:203], v[162:163], v[132:133], v[166:167] op_sel:[0,1,0] op_sel_hi:[1,1,1]
v_pk_fma_f32 v[204:205], v[160:161], v[134:135], v[164:165] op_sel:[0,1,0] op_sel_hi:[1,1,1]
v_pk_fma_f32 v[206:207], v[162:163], v[134:135], v[166:167] op_sel:[0,1,0] op_sel_hi:[1,1,1]
v_pk_fma_f32 v[28:29], v[28:29], v[128:129], v[192:193] op_sel:[0,0,0] op_sel_hi:[1,0,1]
v_pk_fma_f32 v[30:31], v[30:31], v[128:129], v[194:195] op_sel:[0,0,0] op_sel_hi:[1,0,1]
v_pk_fma_f32 v[56:57], v[56:57], v[130:131], v[196:197] op_sel:[0,0,0] op_sel_hi:[1,0,1]
v_pk_fma_f32 v[58:59], v[58:59], v[130:131], v[198:199] op_sel:[0,0,0] op_sel_hi:[1,0,1]
v_pk_fma_f32 v[84:85], v[84:85], v[132:133], v[200:201] op_sel:[0,0,0] op_sel_hi:[1,0,1]
v_pk_fma_f32 v[86:87], v[86:87], v[132:133], v[202:203] op_sel:[0,0,0] op_sel_hi:[1,0,1]
v_pk_fma_f32 v[112:113], v[112:113], v[134:135], v[204:205] op_sel:[0,0,0] op_sel_hi:[1,0,1]
v_pk_fma_f32 v[114:115], v[114:115], v[134:135], v[206:207] op_sel:[0,0,0] op_sel_hi:[1,0,1]
v_max_f32 v28, 0, v28
v_max_f32 v29, 0, v29
v_max_f32 v30, 0, v30
v_max_f32 v31, 0, v31
v_max_f32 v56, 0, v56
v_max_f32 v57, 0, v57
v_max_f32 v58, 0, v58
v_max_f32 v59, 0, v59
v_max_f32 v84, 0, v84
v_max_f32 v85, 0, v85
v_max_f32 v86, 0, v86
v_max_f32 v87, 0, v87
v_max_f32 v112, 0, v112
v_max_f32 v113, 0, v113
v_max_f32 v114, 0, v114
v_max_f32 v115, 0, v115
v_pk_mul_f32 v[28:29], v[28:29], v[28:29]
v_pk_mul_f32 v[30:31], v[30:31], v[30:31]
v_pk_mul_f32 v[56:57], v[56:57], v[56:57]
v_pk_mul_f32 v[58:59], v[58:59], v[58:59]
v_pk_mul_f32 v[84:85], v[84:85], v[84:85]
v_pk_mul_f32 v[86:87], v[86:87], v[86:87]
v_pk_mul_f32 v[112:113], v[112:113], v[112:113]
v_pk_mul_f32 v[114:115], v[114:115], v[114:115]
v_cvt_pk_bf16_f32 v216, v28, v29
v_cvt_pk_bf16_f32 v217, v30, v31
v_cvt_pk_bf16_f32 v218, v56, v57
v_cvt_pk_bf16_f32 v219, v58, v59
s_nop 0
v_permlane16_swap_b32 v216, v218
v_permlane16_swap_b32 v217, v219
buffer_store_dwordx4 v[216:219], v15, s[40:43], s70 offen offset:3072 sc1
v_cvt_pk_bf16_f32 v220, v84, v85
v_cvt_pk_bf16_f32 v221, v86, v87
v_cvt_pk_bf16_f32 v222, v112, v113
v_cvt_pk_bf16_f32 v223, v114, v115
s_nop 0
v_permlane16_swap_b32 v220, v222
v_permlane16_swap_b32 v221, v223
buffer_store_dwordx4 v[220:223], v15, s[40:43], s71 offen offset:3072 sc1
v_pk_fma_f32 v[192:193], v[168:169], v[128:129], v[172:173] op_sel:[0,1,0] op_sel_hi:[1,1,1]
v_pk_fma_f32 v[194:195], v[170:171], v[128:129], v[174:175] op_sel:[0,1,0] op_sel_hi:[1,1,1]
v_pk_fma_f32 v[196:197], v[168:169], v[130:131], v[172:173] op_sel:[0,1,0] op_sel_hi:[1,1,1]
v_pk_fma_f32 v[198:199], v[170:171], v[130:131], v[174:175] op_sel:[0,1,0] op_sel_hi:[1,1,1]
v_pk_fma_f32 v[200:201], v[168:169], v[132:133], v[172:173] op_sel:[0,1,0] op_sel_hi:[1,1,1]
v_pk_fma_f32 v[202:203], v[170:171], v[132:133], v[174:175] op_sel:[0,1,0] op_sel_hi:[1,1,1]
v_pk_fma_f32 v[204:205], v[168:169], v[134:135], v[172:173] op_sel:[0,1,0] op_sel_hi:[1,1,1]
v_pk_fma_f32 v[206:207], v[170:171], v[134:135], v[174:175] op_sel:[0,1,0] op_sel_hi:[1,1,1]
v_pk_fma_f32 v[32:33], v[32:33], v[128:129], v[192:193] op_sel:[0,0,0] op_sel_hi:[1,0,1]
v_pk_fma_f32 v[34:35], v[34:35], v[128:129], v[194:195] op_sel:[0,0,0] op_sel_hi:[1,0,1]
v_pk_fma_f32 v[60:61], v[60:61], v[130:131], v[196:197] op_sel:[0,0,0] op_sel_hi:[1,0,1]
v_pk_fma_f32 v[62:63], v[62:63], v[130:131], v[198:199] op_sel:[0,0,0] op_sel_hi:[1,0,1]
v_pk_fma_f32 v[88:89], v[88:89], v[132:133], v[200:201] op_sel:[0,0,0] op_sel_hi:[1,0,1]
v_pk_fma_f32 v[90:91], v[90:91], v[132:133], v[202:203] op_sel:[0,0,0] op_sel_hi:[1,0,1]
v_pk_fma_f32 v[116:117], v[116:117], v[134:135], v[204:205] op_sel:[0,0,0] op_sel_hi:[1,0,1]
v_pk_fma_f32 v[118:119], v[118:119], v[134:135], v[206:207] op_sel:[0,0,0] op_sel_hi:[1,0,1]
v_max_f32 v32, 0, v32
v_max_f32 v33, 0, v33
v_max_f32 v34, 0, v34
v_max_f32 v35, 0, v35
v_max_f32 v60, 0, v60
v_max_f32 v61, 0, v61
v_max_f32 v62, 0, v62
v_max_f32 v63, 0, v63
v_max_f32 v88, 0, v88
v_max_f32 v89, 0, v89
v_max_f32 v90, 0, v90
v_max_f32 v91, 0, v91
v_max_f32 v116, 0, v116
v_max_f32 v117, 0, v117
v_max_f32 v118, 0, v118
v_max_f32 v119, 0, v119
v_pk_mul_f32 v[32:33], v[32:33], v[32:33]
v_pk_mul_f32 v[34:35], v[34:35], v[34:35]
v_pk_mul_f32 v[60:61], v[60:61], v[60:61]
v_pk_mul_f32 v[62:63], v[62:63], v[62:63]
v_pk_mul_f32 v[88:89], v[88:89], v[88:89]
v_pk_mul_f32 v[90:91], v[90:91], v[90:91]
v_pk_mul_f32 v[116:117], v[116:117], v[116:117]
v_pk_mul_f32 v[118:119], v[118:119], v[118:119]
v_cvt_pk_bf16_f32 v208, v32, v33
v_cvt_pk_bf16_f32 v209, v34, v35
v_cvt_pk_bf16_f32 v210, v60, v61
v_cvt_pk_bf16_f32 v211, v62, v63
s_nop 0
v_permlane16_swap_b32 v208, v210
v_permlane16_swap_b32 v209, v211
buffer_store_dwordx4 v[208:211], v14, s[40:43], s70 offen offset:0 sc1
v_cvt_pk_bf16_f32 v212, v88, v89
v_cvt_pk_bf16_f32 v213, v90, v91
v_cvt_pk_bf16_f32 v214, v116, v117
v_cvt_pk_bf16_f32 v215, v118, v119
s_nop 0
v_permlane16_swap_b32 v212, v214
v_permlane16_swap_b32 v213, v215
buffer_store_dwordx4 v[212:215], v14, s[40:43], s71 offen offset:0 sc1
v_pk_fma_f32 v[192:193], v[176:177], v[128:129], v[180:181] op_sel:[0,1,0] op_sel_hi:[1,1,1]
v_pk_fma_f32 v[194:195], v[178:179], v[128:129], v[182:183] op_sel:[0,1,0] op_sel_hi:[1,1,1]
v_pk_fma_f32 v[196:197], v[176:177], v[130:131], v[180:181] op_sel:[0,1,0] op_sel_hi:[1,1,1]
v_pk_fma_f32 v[198:199], v[178:179], v[130:131], v[182:183] op_sel:[0,1,0] op_sel_hi:[1,1,1]
v_pk_fma_f32 v[200:201], v[176:177], v[132:133], v[180:181] op_sel:[0,1,0] op_sel_hi:[1,1,1]
v_pk_fma_f32 v[202:203], v[178:179], v[132:133], v[182:183] op_sel:[0,1,0] op_sel_hi:[1,1,1]
v_pk_fma_f32 v[204:205], v[176:177], v[134:135], v[180:181] op_sel:[0,1,0] op_sel_hi:[1,1,1]
v_pk_fma_f32 v[206:207], v[178:179], v[134:135], v[182:183] op_sel:[0,1,0] op_sel_hi:[1,1,1]
v_pk_fma_f32 v[36:37], v[36:37], v[128:129], v[192:193] op_sel:[0,0,0] op_sel_hi:[1,0,1]
v_pk_fma_f32 v[38:39], v[38:39], v[128:129], v[194:195] op_sel:[0,0,0] op_sel_hi:[1,0,1]
v_pk_fma_f32 v[64:65], v[64:65], v[130:131], v[196:197] op_sel:[0,0,0] op_sel_hi:[1,0,1]
v_pk_fma_f32 v[66:67], v[66:67], v[130:131], v[198:199] op_sel:[0,0,0] op_sel_hi:[1,0,1]
v_pk_fma_f32 v[92:93], v[92:93], v[132:133], v[200:201] op_sel:[0,0,0] op_sel_hi:[1,0,1]
v_pk_fma_f32 v[94:95], v[94:95], v[132:133], v[202:203] op_sel:[0,0,0] op_sel_hi:[1,0,1]
v_pk_fma_f32 v[120:121], v[120:121], v[134:135], v[204:205] op_sel:[0,0,0] op_sel_hi:[1,0,1]
v_pk_fma_f32 v[122:123], v[122:123], v[134:135], v[206:207] op_sel:[0,0,0] op_sel_hi:[1,0,1]
v_max_f32 v36, 0, v36
v_max_f32 v37, 0, v37
v_max_f32 v38, 0, v38
v_max_f32 v39, 0, v39
v_max_f32 v64, 0, v64
v_max_f32 v65, 0, v65
v_max_f32 v66, 0, v66
v_max_f32 v67, 0, v67
v_max_f32 v92, 0, v92
v_max_f32 v93, 0, v93
v_max_f32 v94, 0, v94
v_max_f32 v95, 0, v95
v_max_f32 v120, 0, v120
v_max_f32 v121, 0, v121
v_max_f32 v122, 0, v122
v_max_f32 v123, 0, v123
v_pk_mul_f32 v[36:37], v[36:37], v[36:37]
v_pk_mul_f32 v[38:39], v[38:39], v[38:39]
v_pk_mul_f32 v[64:65], v[64:65], v[64:65]
v_pk_mul_f32 v[66:67], v[66:67], v[66:67]
v_pk_mul_f32 v[92:93], v[92:93], v[92:93]
v_pk_mul_f32 v[94:95], v[94:95], v[94:95]
v_pk_mul_f32 v[120:121], v[120:121], v[120:121]
v_pk_mul_f32 v[122:123], v[122:123], v[122:123]
v_cvt_pk_bf16_f32 v216, v36, v37
v_cvt_pk_bf16_f32 v217, v38, v39
v_cvt_pk_bf16_f32 v218, v64, v65
v_cvt_pk_bf16_f32 v219, v66, v67
s_nop 0
v_permlane16_swap_b32 v216, v218
v_permlane16_swap_b32 v217, v219
buffer_store_dwordx4 v[216:219], v14, s[40:43], s70 offen offset:1024 sc1
v_cvt_pk_bf16_f32 v220, v92, v93
v_cvt_pk_bf16_f32 v221, v94, v95
v_cvt_pk_bf16_f32 v222, v120, v121
v_cvt_pk_bf16_f32 v223, v122, v123
s_nop 0
v_permlane16_swap_b32 v220, v222
v_permlane16_swap_b32 v221, v223
buffer_store_dwordx4 v[220:223], v14, s[40:43], s71 offen offset:1024 sc1
v_pk_fma_f32 v[192:193], v[184:185], v[128:129], v[188:189] op_sel:[0,1,0] op_sel_hi:[1,1,1]
v_pk_fma_f32 v[194:195], v[186:187], v[128:129], v[190:191] op_sel:[0,1,0] op_sel_hi:[1,1,1]
v_pk_fma_f32 v[196:197], v[184:185], v[130:131], v[188:189] op_sel:[0,1,0] op_sel_hi:[1,1,1]
v_pk_fma_f32 v[198:199], v[186:187], v[130:131], v[190:191] op_sel:[0,1,0] op_sel_hi:[1,1,1]
v_pk_fma_f32 v[200:201], v[184:185], v[132:133], v[188:189] op_sel:[0,1,0] op_sel_hi:[1,1,1]
v_pk_fma_f32 v[202:203], v[186:187], v[132:133], v[190:191] op_sel:[0,1,0] op_sel_hi:[1,1,1]
v_pk_fma_f32 v[204:205], v[184:185], v[134:135], v[188:189] op_sel:[0,1,0] op_sel_hi:[1,1,1]
v_pk_fma_f32 v[206:207], v[186:187], v[134:135], v[190:191] op_sel:[0,1,0] op_sel_hi:[1,1,1]
v_pk_fma_f32 v[40:41], v[40:41], v[128:129], v[192:193] op_sel:[0,0,0] op_sel_hi:[1,0,1]
v_pk_fma_f32 v[42:43], v[42:43], v[128:129], v[194:195] op_sel:[0,0,0] op_sel_hi:[1,0,1]
v_pk_fma_f32 v[68:69], v[68:69], v[130:131], v[196:197] op_sel:[0,0,0] op_sel_hi:[1,0,1]
v_pk_fma_f32 v[70:71], v[70:71], v[130:131], v[198:199] op_sel:[0,0,0] op_sel_hi:[1,0,1]
v_pk_fma_f32 v[96:97], v[96:97], v[132:133], v[200:201] op_sel:[0,0,0] op_sel_hi:[1,0,1]
v_pk_fma_f32 v[98:99], v[98:99], v[132:133], v[202:203] op_sel:[0,0,0] op_sel_hi:[1,0,1]
v_pk_fma_f32 v[124:125], v[124:125], v[134:135], v[204:205] op_sel:[0,0,0] op_sel_hi:[1,0,1]
v_pk_fma_f32 v[126:127], v[126:127], v[134:135], v[206:207] op_sel:[0,0,0] op_sel_hi:[1,0,1]
v_max_f32 v40, 0, v40
v_max_f32 v41, 0, v41
v_max_f32 v42, 0, v42
v_max_f32 v43, 0, v43
v_max_f32 v68, 0, v68
v_max_f32 v69, 0, v69
v_max_f32 v70, 0, v70
v_max_f32 v71, 0, v71
v_max_f32 v96, 0, v96
v_max_f32 v97, 0, v97
v_max_f32 v98, 0, v98
v_max_f32 v99, 0, v99
v_max_f32 v124, 0, v124
v_max_f32 v125, 0, v125
v_max_f32 v126, 0, v126
v_max_f32 v127, 0, v127
v_pk_mul_f32 v[40:41], v[40:41], v[40:41]
v_pk_mul_f32 v[42:43], v[42:43], v[42:43]
v_pk_mul_f32 v[68:69], v[68:69], v[68:69]
v_pk_mul_f32 v[70:71], v[70:71], v[70:71]
v_pk_mul_f32 v[96:97], v[96:97], v[96:97]
v_pk_mul_f32 v[98:99], v[98:99], v[98:99]
v_pk_mul_f32 v[124:125], v[124:125], v[124:125]
v_pk_mul_f32 v[126:127], v[126:127], v[126:127]
v_cvt_pk_bf16_f32 v208, v40, v41
v_cvt_pk_bf16_f32 v209, v42, v43
v_cvt_pk_bf16_f32 v210, v68, v69
v_cvt_pk_bf16_f32 v211, v70, v71
s_nop 0
v_permlane16_swap_b32 v208, v210
v_permlane16_swap_b32 v209, v211
buffer_store_dwordx4 v[208:211], v14, s[40:43], s70 offen offset:2048 sc1
v_cvt_pk_bf16_f32 v212, v96, v97
v_cvt_pk_bf16_f32 v213, v98, v99
v_cvt_pk_bf16_f32 v214, v124, v125
v_cvt_pk_bf16_f32 v215, v126, v127
s_nop 0
v_permlane16_swap_b32 v212, v214
v_permlane16_swap_b32 v213, v215
buffer_store_dwordx4 v[212:215], v14, s[40:43], s71 offen offset:2048 sc1
s_barrier
s_waitcnt vmcnt(0)
v_mov_b32 v8, 163804
v_mov_b32 v9, 1
s_mov_b64 exec, 1
ds_add_rtn_u32 v9, v8, v9
s_waitcnt lgkmcnt(0)
s_nop 1
v_readfirstlane_b32 s72, v9
s_mov_b64 exec, -1
s_nop 2
s_cmp_lg_u32 s72, 3
s_cbranch_scc1 pub5
s_add_u32 s56, s8, 0x1200000
s_addc_u32 s57, s9, 0
s_mov_b32 s58, 0x8000
s_mov_b32 s59, 0x20000
s_lshl_b32 s70, s4, 7
s_lshl_b32 s71, s5, 3
s_add_u32 s71, s71, s70
v_mov_b32 v8, s28
v_mov_b32 v9, s29
v_mov_b32 v10, 12288
s_mov_b64 exec, 1
buffer_store_dwordx2 v[8:9], v10, s[56:59], s71 offen sc1
s_mov_b64 exec, -1
pub5:
s_and_b32 s82, s30, 1
s_lshr_b32 s4, s30, 1
s_lshl_b32 s4, s4, 2
s_and_b32 s64, s31, 3
s_add_u32 s4, s4, s64
s_lshr_b32 s5, s31, 2
v_and_b32 v10, 15, v1
v_lshrrev_b32 v11, 4, v1
s_lshl_b32 s64, s6, 13
v_lshlrev_b32 v13, 9, v11
v_lshl_add_u32 v13, v10, 4, v13
v_add_u32 v2, s64, v13
v_bfe_u32 v12, v1, 2, 2
v_lshlrev_b32 v12, 6, v12
v_and_b32 v13, 3, v1
v_lshl_add_u32 v12, v13, 3, v12
v_mul_u32_u24 v13, 2048, v11
v_add_u32 v12, v12, v13
v_and_b32 v13, 1, v11
v_lshl_add_u32 v12, v13, 5, v12
s_mul_i32 s64, s7, 1024
v_add_u32 v6, s64, v12
v_xor_b32 v7, 32, v6
s_mov_b32 s68, 32768
s_mov_b32 s69, 0xfffe8000
v_mov_b32 v16, 0
v_mov_b32 v17, 0
v_mov_b32 v18, 0
v_mov_b32 v19, 0
v_mov_b32 v20, 0
v_mov_b32 v21, 0
v_mov_b32 v22, 0
v_mov_b32 v23, 0
v_mov_b32 v24, 0
v_mov_b32 v25, 0
v_mov_b32 v26, 0
v_mov_b32 v27, 0
v_mov_b32 v28, 0
v_mov_b32 v29, 0
v_mov_b32 v30, 0
v_mov_b32 v31, 0
v_mov_b32 v32, 0
v_mov_b32 v33, 0
v_mov_b32 v34, 0
v_mov_b32 v35, 0
v_mov_b32 v36, 0
v_mov_b32 v37, 0
v_mov_b32 v38, 0
v_mov_b32 v39, 0
v_mov_b32 v40, 0
v_mov_b32 v41, 0
v_mov_b32 v42, 0
v_mov_b32 v43, 0
v_mov_b32 v44, 0
v_mov_b32 v45, 0
v_mov_b32 v46, 0
v_mov_b32 v47, 0
v_mov_b32 v48, 0
v_mov_b32 v49, 0
v_mov_b32 v50, 0
v_mov_b32 v51, 0
v_mov_b32 v52, 0
v_mov_b32 v53, 0
v_mov_b32 v54, 0
v_mov_b32 v55, 0
v_mov_b32 v56, 0
v_mov_b32 v57, 0
v_mov_b32 v58, 0
v_mov_b32 v59, 0
v_mov_b32 v60, 0
v_mov_b32 v61, 0
v_mov_b32 v62, 0
v_mov_b32 v63, 0
v_mov_b32 v64, 0
v_mov_b32 v65, 0
v_mov_b32 v66, 0
v_mov_b32 v67, 0
v_mov_b32 v68, 0
v_mov_b32 v69, 0
v_mov_b32 v70, 0
v_mov_b32 v71, 0
v_mov_b32 v72, 0
v_mov_b32 v73, 0
v_mov_b32 v74, 0
v_mov_b32 v75, 0
v_mov_b32 v76, 0
v_mov_b32 v77, 0
v_mov_b32 v78, 0
v_mov_b32 v79, 0
s_barrier
s_add_u32 s40, s8, 0xc00000
s_addc_u32 s41, s9, 0
s_mov_b32 s42, 0x400000
s_mov_b32 s43, 0x20000
s_mov_b32 s44, s24
s_mov_b32 s45, s25
s_mov_b32 s46, 0x800
s_mov_b32 s47, 0x20000
v_and_b32 v10, 15, v1
v_lshrrev_b32 v11, 4, v1
v_lshlrev_b32 v12, 4, v10
v_lshrrev_b32 v13, 1, v11
v_lshl_add_u32 v12, v13, 9, v12
v_and_b32 v13, 1, v11
v_lshl_add_u32 v12, v13, 3, v12
s_lshl_b32 s70, s4, 2
s_lshl_b32 s71, s6, 1
s_add_u32 s70, s70, s71
s_lshl_b32 s70, s70, 7
s_lshl_b32 s71, s5, 4
s_add_u32 s70, s70, s71
s_lshl_b32 s71, s7, 3
s_add_u32 s70, s70, s71
s_lshl_b32 s70, s70, 9
s_cmp_eq_u32 s6, s82
s_cbranch_scc0 p5pre_skip
buffer_load_dwordx2 v[144:145], v12, s[40:43], s70 offen offset:0 sc1
buffer_load_dwordx2 v[146:147], v12, s[40:43], s70 offen offset:1024 sc1
buffer_load_dwordx2 v[148:149], v12, s[40:43], s70 offen offset:2048 sc1
buffer_load_dwordx2 v[150:151], v12, s[40:43], s70 offen offset:3072 sc1
buffer_load_dwordx2 v[152:153], v12, s[40:43], s70 offen offset:256 sc1
buffer_load_dwordx2 v[154:155], v12, s[40:43], s70 offen offset:1280 sc1
buffer_load_dwordx2 v[156:157], v12, s[40:43], s70 offen offset:2304 sc1
buffer_load_dwordx2 v[158:159], v12, s[40:43], s70 offen offset:3328 sc1
s_add_u32 s70, s70, 65536
buffer_load_dwordx2 v[160:161], v12, s[40:43], s70 offen offset:0 sc1
buffer_load_dwordx2 v[162:163], v12, s[40:43], s70 offen offset:1024 sc1
buffer_load_dwordx2 v[164:165], v12, s[40:43], s70 offen offset:2048 sc1
buffer_load_dwordx2 v[166:167], v12, s[40:43], s70 offen offset:3072 sc1
buffer_load_dwordx2 v[168:169], v12, s[40:43], s70 offen offset:256 sc1
buffer_load_dwordx2 v[170:171], v12, s[40:43], s70 offen offset:1280 sc1
buffer_load_dwordx2 v[172:173], v12, s[40:43], s70 offen offset:2304 sc1
buffer_load_dwordx2 v[174:175], v12, s[40:43], s70 offen offset:3328 sc1
v_lshlrev_b32 v13, 3, v11
s_lshl_b32 s70, s5, 8
s_lshl_b32 s71, s7, 7
s_add_u32 s70, s70, s71
buffer_load_dwordx2 v[176:177], v13, s[44:47], s70 offen offset:0
buffer_load_dwordx2 v[178:179], v13, s[44:47], s70 offen offset:32
buffer_load_dwordx2 v[180:181], v13, s[44:47], s70 offen offset:64
buffer_load_dwordx2 v[182:183], v13, s[44:47], s70 offen offset:96
p5pre_skip:
s_barrier
s_cmp_eq_u32 s6, s82
s_cselect_b32 s81, 30, 24
ds_read_b64_tr_b16 v[112:113], v6 offset:16384
ds_read_b64_tr_b16 v[114:115], v6 offset:16896
ds_read_b128 v[80:83], v2 offset:0
ds_read_b128 v[84:87], v2 offset:256
ds_read_b128 v[88:91], v2 offset:4096
ds_read_b128 v[92:95], v2 offset:4352
ds_read_b64_tr_b16 v[116:117], v7 offset:16384
ds_read_b64_tr_b16 v[118:119], v7 offset:16896
ds_read_b64_tr_b16 v[120:121], v6 offset:16640
ds_read_b64_tr_b16 v[122:123], v6 offset:17152
ds_read_b64_tr_b16 v[124:125], v7 offset:16640
ds_read_b64_tr_b16 v[126:127], v7 offset:17152
s_mov_b32 s65, 0
s_mov_b32 s67, 0
p5_loop:
s_waitcnt lgkmcnt(0)
v_mfma_f32_16x16x32_bf16 v[16:19], v[112:115], v[80:83], v[16:19]
ds_read_b64_tr_b16 v[128:129], v6 offset:24576
v_mfma_f32_16x16x32_bf16 v[32:35], v[112:115], v[84:87], v[32:35]
ds_read_b64_tr_b16 v[130:131], v6 offset:25088
v_mfma_f32_16x16x32_bf16 v[48:51], v[112:115], v[88:91], v[48:51]
ds_read_b128 v[96:99], v2 offset:2048
v_mfma_f32_16x16x32_bf16 v[64:67], v[112:115], v[92:95], v[64:67]
ds_read_b128 v[100:103], v2 offset:2304
v_mfma_f32_16x16x32_bf16 v[20:23], v[116:119], v[80:83], v[20:23]
ds_read_b128 v[104:107], v2 offset:6144
v_mfma_f32_16x16x32_bf16 v[36:39], v[116:119], v[84:87], v[36:39]
ds_read_b128 v[108:111], v2 offset:6400
v_mfma_f32_16x16x32_bf16 v[52:55], v[116:119], v[88:91], v[52:55]
ds_read_b64_tr_b16 v[132:133], v7 offset:24576
v_mfma_f32_16x16x32_bf16 v[68:71], v[116:119], v[92:95], v[68:71]
ds_read_b64_tr_b16 v[134:135], v7 offset:25088
v_mfma_f32_16x16x32_bf16 v[24:27], v[120:123], v[80:83], v[24:27]
ds_read_b64_tr_b16 v[136:137], v6 offset:24832
v_mfma_f32_16x16x32_bf16 v[40:43], v[120:123], v[84:87], v[40:43]
ds_read_b64_tr_b16 v[138:139], v6 offset:25344
v_mfma_f32_16x16x32_bf16 v[56:59], v[120:123], v[88:91], v[56:59]
ds_read_b64_tr_b16 v[140:141], v7 offset:24832
v_mfma_f32_16x16x32_bf16 v[72:75], v[120:123], v[92:95], v[72:75]
ds_read_b64_tr_b16 v[142:143], v7 offset:25344
v_mfma_f32_16x16x32_bf16 v[28:31], v[124:127], v[80:83], v[28:31]
v_mfma_f32_16x16x32_bf16 v[44:47], v[124:127], v[84:87], v[44:47]
v_mfma_f32_16x16x32_bf16 v[60:63], v[124:127], v[88:91], v[60:63]
v_mfma_f32_16x16x32_bf16 v[76:79], v[124:127], v[92:95], v[76:79]
s_waitcnt lgkmcnt(0)
s_add_u32 s67, s67, 1
s_cmp_eq_u32 s67, 4
s_cselect_b32 s66, s69, s68
s_cselect_b32 s67, 0, s67
v_add_u32 v2, s66, v2
v_add_u32 v6, s66, v6
v_add_u32 v7, s66, v7
s_barrier
v_mfma_f32_16x16x32_bf16 v[16:19], v[128:131], v[96:99], v[16:19]
ds_read_b64_tr_b16 v[112:113], v6 offset:16384
v_mfma_f32_16x16x32_bf16 v[32:35], v[128:131], v[100:103], v[32:35]
ds_read_b64_tr_b16 v[114:115], v6 offset:16896
v_mfma_f32_16x16x32_bf16 v[48:51], v[128:131], v[104:107], v[48:51]
ds_read_b128 v[80:83], v2 offset:0
v_mfma_f32_16x16x32_bf16 v[64:67], v[128:131], v[108:111], v[64:67]
ds_read_b128 v[84:87], v2 offset:256
v_mfma_f32_16x16x32_bf16 v[20:23], v[132:135], v[96:99], v[20:23]
ds_read_b128 v[88:91], v2 offset:4096
v_mfma_f32_16x16x32_bf16 v[36:39], v[132:135], v[100:103], v[36:39]
ds_read_b128 v[92:95], v2 offset:4352
v_mfma_f32_16x16x32_bf16 v[52:55], v[132:135], v[104:107], v[52:55]
ds_read_b64_tr_b16 v[116:117], v7 offset:16384
v_mfma_f32_16x16x32_bf16 v[68:71], v[132:135], v[108:111], v[68:71]
ds_read_b64_tr_b16 v[118:119], v7 offset:16896
v_mfma_f32_16x16x32_bf16 v[24:27], v[136:139], v[96:99], v[24:27]
ds_read_b64_tr_b16 v[120:121], v6 offset:16640
v_mfma_f32_16x16x32_bf16 v[40:43], v[136:139], v[100:103], v[40:43]
ds_read_b64_tr_b16 v[122:123], v6 offset:17152
v_mfma_f32_16x16x32_bf16 v[56:59], v[136:139], v[104:107], v[56:59]
ds_read_b64_tr_b16 v[124:125], v7 offset:16640
v_mfma_f32_16x16x32_bf16 v[72:75], v[136:139], v[108:111], v[72:75]
ds_read_b64_tr_b16 v[126:127], v7 offset:17152
v_mfma_f32_16x16x32_bf16 v[28:31], v[140:143], v[96:99], v[28:31]
v_mfma_f32_16x16x32_bf16 v[44:47], v[140:143], v[100:103], v[44:47]
v_mfma_f32_16x16x32_bf16 v[60:63], v[140:143], v[104:107], v[60:63]
v_mfma_f32_16x16x32_bf16 v[76:79], v[140:143], v[108:111], v[76:79]
s_add_u32 s65, s65, 1
s_cmp_lt_u32 s65, s81
s_cbranch_scc1 p5_loop
s_cmp_eq_u32 s6, s82
s_cbranch_scc0 p5_loopdone
s_add_u32 s48, s8, 0x2400000
s_addc_u32 s49, s9, 0
s_mov_b32 s50, 0x800000
s_mov_b32 s51, 0x20000
s_add_u32 s56, s8, 0x1200000
s_addc_u32 s57, s9, 0
s_mov_b32 s58, 0x8000
s_mov_b32 s59, 0x20000
s_lshl_b32 s72, s4, 3
s_add_u32 s72, s72, s5
s_lshl_b32 s73, s72, 2
s_xor_b32 s74, s82, 1
s_lshl_b32 s74, s74, 1
s_add_u32 s73, s73, s74
s_add_u32 s73, s73, s7
s_lshl_b32 s74, s73, 3
v_lshlrev_b32 v10, 3, v1
v_add_u32 v10, 16384, v10
s_mov_b64 exec, 0x1
s_mov_b32 s80, 0
poll6:
buffer_load_dwordx2 v[8:9], v10, s[56:59], s74 offen sc1
s_waitcnt vmcnt(0)
v_cmp_ne_u32 vcc, s28, v8
v_cmp_ne_u32 s[78:79], s29, v9
s_nop 3
s_or_b64 s[78:79], vcc, s[78:79]
s_cmp_eq_u64 s[78:79], 0
s_cbranch_scc1 poll6_ok
s_sleep 2
s_add_u32 s80, s80, 1
s_cmp_lt_u32 s80, 0x40000
s_cbranch_scc1 poll6
poll6_ok:
s_mov_b64 exec, -1
v_lshlrev_b32 v15, 4, v1
s_lshl_b32 s74, s73, 14
buffer_load_dwordx4 v[184:187], v15, s[48:51], s74 offen offset:0 sc1
buffer_load_dwordx4 v[188:191], v15, s[48:51], s74 offen offset:1024 sc1
buffer_load_dwordx4 v[192:195], v15, s[48:51], s74 offen offset:2048 sc1
buffer_load_dwordx4 v[196:199], v15, s[48:51], s74 offen offset:3072 sc1
s_add_u32 s74, s74, 4096
buffer_load_dwordx4 v[200:203], v15, s[48:51], s74 offen offset:0 sc1
buffer_load_dwordx4 v[204:207], v15, s[48:51], s74 offen offset:1024 sc1
buffer_load_dwordx4 v[208:211], v15, s[48:51], s74 offen offset:2048 sc1
buffer_load_dwordx4 v[212:215], v15, s[48:51], s74 offen offset:3072 sc1
s_add_u32 s74, s74, 4096
buffer_load_dwordx4 v[216:219], v15, s[48:51], s74 offen offset:0 sc1
buffer_load_dwordx4 v[220:223], v15, s[48:51], s74 offen offset:1024 sc1
buffer_load_dwordx4 v[224:227], v15, s[48:51], s74 offen offset:2048 sc1
buffer_load_dwordx4 v[228:231], v15, s[48:51], s74 offen offset:3072 sc1
s_add_u32 s74, s74, 4096
buffer_load_dwordx4 v[232:235], v15, s[48:51], s74 offen offset:0 sc1
buffer_load_dwordx4 v[236:239], v15, s[48:51], s74 offen offset:1024 sc1
buffer_load_dwordx4 v[240:243], v15, s[48:51], s74 offen offset:2048 sc1
buffer_load_dwordx4 v[244:247], v15, s[48:51], s74 offen offset:3072 sc1
s_mov_b32 s65, 0
p5b_loop:
s_waitcnt lgkmcnt(0)
v_mfma_f32_16x16x32_bf16 v[16:19], v[112:115], v[80:83], v[16:19]
ds_read_b64_tr_b16 v[128:129], v6 offset:24576
v_mfma_f32_16x16x32_bf16 v[32:35], v[112:115], v[84:87], v[32:35]
ds_read_b64_tr_b16 v[130:131], v6 offset:25088
v_mfma_f32_16x16x32_bf16 v[48:51], v[112:115], v[88:91], v[48:51]
ds_read_b128 v[96:99], v2 offset:2048
v_mfma_f32_16x16x32_bf16 v[64:67], v[112:115], v[92:95], v[64:67]
ds_read_b128 v[100:103], v2 offset:2304
v_mfma_f32_16x16x32_bf16 v[20:23], v[116:119], v[80:83], v[20:23]
ds_read_b128 v[104:107], v2 offset:6144
v_mfma_f32_16x16x32_bf16 v[36:39], v[116:119], v[84:87], v[36:39]
ds_read_b128 v[108:111], v2 offset:6400
v_mfma_f32_16x16x32_bf16 v[52:55], v[116:119], v[88:91], v[52:55]
ds_read_b64_tr_b16 v[132:133], v7 offset:24576
v_mfma_f32_16x16x32_bf16 v[68:71], v[116:119], v[92:95], v[68:71]
ds_read_b64_tr_b16 v[134:135], v7 offset:25088
v_mfma_f32_16x16x32_bf16 v[24:27], v[120:123], v[80:83], v[24:27]
ds_read_b64_tr_b16 v[136:137], v6 offset:24832
v_mfma_f32_16x16x32_bf16 v[40:43], v[120:123], v[84:87], v[40:43]
ds_read_b64_tr_b16 v[138:139], v6 offset:25344
v_mfma_f32_16x16x32_bf16 v[56:59], v[120:123], v[88:91], v[56:59]
ds_read_b64_tr_b16 v[140:141], v7 offset:24832
v_mfma_f32_16x16x32_bf16 v[72:75], v[120:123], v[92:95], v[72:75]
ds_read_b64_tr_b16 v[142:143], v7 offset:25344
v_mfma_f32_16x16x32_bf16 v[28:31], v[124:127], v[80:83], v[28:31]
v_mfma_f32_16x16x32_bf16 v[44:47], v[124:127], v[84:87], v[44:47]
v_mfma_f32_16x16x32_bf16 v[60:63], v[124:127], v[88:91], v[60:63]
v_mfma_f32_16x16x32_bf16 v[76:79], v[124:127], v[92:95], v[76:79]
s_waitcnt lgkmcnt(0)
s_add_u32 s67, s67, 1
s_cmp_eq_u32 s67, 4
s_cselect_b32 s66, s69, s68
s_cselect_b32 s67, 0, s67
v_add_u32 v2, s66, v2
v_add_u32 v6, s66, v6
v_add_u32 v7, s66, v7
s_barrier
v_mfma_f32_16x16x32_bf16 v[16:19], v[128:131], v[96:99], v[16:19]
ds_read_b64_tr_b16 v[112:113], v6 offset:16384
v_mfma_f32_16x16x32_bf16 v[32:35], v[128:131], v[100:103], v[32:35]
ds_read_b64_tr_b16 v[114:115], v6 offset:16896
v_mfma_f32_16x16x32_bf16 v[48:51], v[128:131], v[104:107], v[48:51]
ds_read_b128 v[80:83], v2 offset:0
v_mfma_f32_16x16x32_bf16 v[64:67], v[128:131], v[108:111], v[64:67]
ds_read_b128 v[84:87], v2 offset:256
v_mfma_f32_16x16x32_bf16 v[20:23], v[132:135], v[96:99], v[20:23]
ds_read_b128 v[88:91], v2 offset:4096
v_mfma_f32_16x16x32_bf16 v[36:39], v[132:135], v[100:103], v[36:39]
ds_read_b128 v[92:95], v2 offset:4352
v_mfma_f32_16x16x32_bf16 v[52:55], v[132:135], v[104:107], v[52:55]
ds_read_b64_tr_b16 v[116:117], v7 offset:16384
v_mfma_f32_16x16x32_bf16 v[68:71], v[132:135], v[108:111], v[68:71]
ds_read_b64_tr_b16 v[118:119], v7 offset:16896
v_mfma_f32_16x16x32_bf16 v[24:27], v[136:139], v[96:99], v[24:27]
ds_read_b64_tr_b16 v[120:121], v6 offset:16640
v_mfma_f32_16x16x32_bf16 v[40:43], v[136:139], v[100:103], v[40:43]
ds_read_b64_tr_b16 v[122:123], v6 offset:17152
v_mfma_f32_16x16x32_bf16 v[56:59], v[136:139], v[104:107], v[56:59]
ds_read_b64_tr_b16 v[124:125], v7 offset:16640
v_mfma_f32_16x16x32_bf16 v[72:75], v[136:139], v[108:111], v[72:75]
ds_read_b64_tr_b16 v[126:127], v7 offset:17152
v_mfma_f32_16x16x32_bf16 v[28:31], v[140:143], v[96:99], v[28:31]
v_mfma_f32_16x16x32_bf16 v[44:47], v[140:143], v[100:103], v[44:47]
v_mfma_f32_16x16x32_bf16 v[60:63], v[140:143], v[104:107], v[60:63]
v_mfma_f32_16x16x32_bf16 v[76:79], v[140:143], v[108:111], v[76:79]
s_add_u32 s65, s65, 1
s_cmp_lt_u32 s65, 2
s_cbranch_scc1 p5b_loop
p5_loopdone:
s_waitcnt lgkmcnt(0)
s_add_u32 s48, s8, 0x2400000
s_addc_u32 s49, s9, 0
s_mov_b32 s50, 0x800000
s_mov_b32 s51, 0x20000
s_mov_b32 s52, s26
s_mov_b32 s53, s27
s_mov_b32 s54, 0x400000
s_mov_b32 s55, 0x20000
s_add_u32 s56, s8, 0x1200000
s_addc_u32 s57, s9, 0
s_mov_b32 s58, 0x8000
s_mov_b32 s59, 0x20000
s_lshl_b32 s72, s4, 3
s_add_u32 s72, s72, s5
v_lshlrev_b32 v15, 4, v1
s_cmp_eq_u32 s6, s82
s_cbranch_scc1 p5_keep
s_lshl_b32 s73, s72, 2
s_lshl_b32 s74, s82, 1
s_add_u32 s73, s73, s74
s_add_u32 s73, s73, s7
s_lshl_b32 s74, s73, 14
buffer_store_dwordx4 v[16:19], v15, s[48:51], s74 offen offset:0 sc1
buffer_store_dwordx4 v[20:23], v15, s[48:51], s74 offen offset:1024 sc1
buffer_store_dwordx4 v[24:27], v15, s[48:51], s74 offen offset:2048 sc1
buffer_store_dwordx4 v[28:31], v15, s[48:51], s74 offen offset:3072 sc1
s_add_u32 s74, s74, 4096
buffer_store_dwordx4 v[32:35], v15, s[48:51], s74 offen offset:0 sc1
buffer_store_dwordx4 v[36:39], v15, s[48:51], s74 offen offset:1024 sc1
buffer_store_dwordx4 v[40:43], v15, s[48:51], s74 offen offset:2048 sc1
buffer_store_dwordx4 v[44:47], v15, s[48:51], s74 offen offset:3072 sc1
s_add_u32 s74, s74, 4096
buffer_store_dwordx4 v[48:51], v15, s[48:51], s74 offen offset:0 sc1
buffer_store_dwordx4 v[52:55], v15, s[48:51], s74 offen offset:1024 sc1
buffer_store_dwordx4 v[56:59], v15, s[48:51], s74 offen offset:2048 sc1
buffer_store_dwordx4 v[60:63], v15, s[48:51], s74 offen offset:3072 sc1
s_add_u32 s74, s74, 4096
buffer_store_dwordx4 v[64:67], v15, s[48:51], s74 offen offset:0 sc1
buffer_store_dwordx4 v[68:71], v15, s[48:51], s74 offen offset:1024 sc1
buffer_store_dwordx4 v[72:75], v15, s[48:51], s74 offen offset:2048 sc1
buffer_store_dwordx4 v[76:79], v15, s[48:51], s74 offen offset:3072 sc1
s_barrier
s_barrier
s_barrier
s_barrier
s_waitcnt vmcnt(0)
s_lshl_b32 s74, s73, 3
v_mov_b32 v20, s28
v_mov_b32 v21, s29
v_mov_b32 v22, 16384
s_mov_b64 exec, 1
buffer_store_dwordx2 v[20:21], v22, s[56:59], s74 offen sc1
s_mov_b64 exec, -1
s_barrier
s_barrier
s_barrier
s_barrier
s_endpgm
p5_keep:
v_and_b32 v10, 15, v1
v_lshrrev_b32 v11, 4, v1
v_and_b32 v13, 1, v11
v_lshl_add_u32 v12, v13, 4, v10
v_lshlrev_b32 v12, 11, v12
v_lshrrev_b32 v13, 1, v11
v_lshl_add_u32 v12, v13, 4, v12
s_lshl_b32 s70, s4, 7
s_lshl_b32 s71, s6, 6
s_add_u32 s70, s70, s71
s_lshl_b32 s70, s70, 11
s_lshl_b32 s71, s5, 8
s_add_u32 s70, s70, s71
s_lshl_b32 s71, s7, 7
s_add_u32 s70, s70, s71
s_waitcnt vmcnt(16)
v_lshlrev_b32 v80, 16, v176
v_and_b32 v81, 0xffff0000, v176
v_lshlrev_b32 v82, 16, v177
v_and_b32 v83, 0xffff0000, v177
v_lshlrev_b32 v84, 16, v178
v_and_b32 v85, 0xffff0000, v178
v_lshlrev_b32 v86, 16, v179
v_and_b32 v87, 0xffff0000, v179
v_lshlrev_b32 v88, 16, v180
v_and_b32 v89, 0xffff0000, v180
v_lshlrev_b32 v90, 16, v181
v_and_b32 v91, 0xffff0000, v181
v_lshlrev_b32 v92, 16, v182
v_and_b32 v93, 0xffff0000, v182
v_lshlrev_b32 v94, 16, v183
v_and_b32 v95, 0xffff0000, v183
v_lshlrev_b32 v112, 16, v144
v_and_b32 v113, 0xffff0000, v144
v_pk_add_f32 v[16:17], v[16:17], v[80:81]
v_pk_add_f32 v[16:17], v[16:17], v[112:113]
v_lshlrev_b32 v114, 16, v145
v_and_b32 v115, 0xffff0000, v145
v_pk_add_f32 v[18:19], v[18:19], v[82:83]
v_pk_add_f32 v[18:19], v[18:19], v[114:115]
v_lshlrev_b32 v116, 16, v146
v_and_b32 v117, 0xffff0000, v146
v_pk_add_f32 v[20:21], v[20:21], v[84:85]
v_pk_add_f32 v[20:21], v[20:21], v[116:117]
v_lshlrev_b32 v118, 16, v147
v_and_b32 v119, 0xffff0000, v147
v_pk_add_f32 v[22:23], v[22:23], v[86:87]
v_pk_add_f32 v[22:23], v[22:23], v[118:119]
v_lshlrev_b32 v120, 16, v148
v_and_b32 v121, 0xffff0000, v148
v_pk_add_f32 v[24:25], v[24:25], v[88:89]
v_pk_add_f32 v[24:25], v[24:25], v[120:121]
v_lshlrev_b32 v122, 16, v149
v_and_b32 v123, 0xffff0000, v149
v_pk_add_f32 v[26:27], v[26:27], v[90:91]
v_pk_add_f32 v[26:27], v[26:27], v[122:123]
v_lshlrev_b32 v124, 16, v150
v_and_b32 v125, 0xffff0000, v150
v_pk_add_f32 v[28:29], v[28:29], v[92:93]
v_pk_add_f32 v[28:29], v[28:29], v[124:125]
v_lshlrev_b32 v126, 16, v151
v_and_b32 v127, 0xffff0000, v151
v_pk_add_f32 v[30:31], v[30:31], v[94:95]
v_pk_add_f32 v[30:31], v[30:31], v[126:127]
v_lshlrev_b32 v112, 16, v152
v_and_b32 v113, 0xffff0000, v152
v_pk_add_f32 v[32:33], v[32:33], v[80:81]
v_pk_add_f32 v[32:33], v[32:33], v[112:113]
v_lshlrev_b32 v114, 16, v153
v_and_b32 v115, 0xffff0000, v153
v_pk_add_f32 v[34:35], v[34:35], v[82:83]
v_pk_add_f32 v[34:35], v[34:35], v[114:115]
v_lshlrev_b32 v116, 16, v154
v_and_b32 v117, 0xffff0000, v154
v_pk_add_f32 v[36:37], v[36:37], v[84:85]
v_pk_add_f32 v[36:37], v[36:37], v[116:117]
v_lshlrev_b32 v118, 16, v155
v_and_b32 v119, 0xffff0000, v155
v_pk_add_f32 v[38:39], v[38:39], v[86:87]
v_pk_add_f32 v[38:39], v[38:39], v[118:119]
v_lshlrev_b32 v120, 16, v156
v_and_b32 v121, 0xffff0000, v156
v_pk_add_f32 v[40:41], v[40:41], v[88:89]
v_pk_add_f32 v[40:41], v[40:41], v[120:121]
v_lshlrev_b32 v122, 16, v157
v_and_b32 v123, 0xffff0000, v157
v_pk_add_f32 v[42:43], v[42:43], v[90:91]
v_pk_add_f32 v[42:43], v[42:43], v[122:123]
v_lshlrev_b32 v124, 16, v158
v_and_b32 v125, 0xffff0000, v158
v_pk_add_f32 v[44:45], v[44:45], v[92:93]
v_pk_add_f32 v[44:45], v[44:45], v[124:125]
v_lshlrev_b32 v126, 16, v159
v_and_b32 v127, 0xffff0000, v159
v_pk_add_f32 v[46:47], v[46:47], v[94:95]
v_pk_add_f32 v[46:47], v[46:47], v[126:127]
v_lshlrev_b32 v112, 16, v160
v_and_b32 v113, 0xffff0000, v160
v_pk_add_f32 v[48:49], v[48:49], v[80:81]
v_pk_add_f32 v[48:49], v[48:49], v[112:113]
v_lshlrev_b32 v114, 16, v161
v_and_b32 v115, 0xffff0000, v161
v_pk_add_f32 v[50:51], v[50:51], v[82:83]
v_pk_add_f32 v[50:51], v[50:51], v[114:115]
v_lshlrev_b32 v116, 16, v162
v_and_b32 v117, 0xffff0000, v162
v_pk_add_f32 v[52:53], v[52:53], v[84:85]
v_pk_add_f32 v[52:53], v[52:53], v[116:117]
v_lshlrev_b32 v118, 16, v163
v_and_b32 v119, 0xffff0000, v163
v_pk_add_f32 v[54:55], v[54:55], v[86:87]
v_pk_add_f32 v[54:55], v[54:55], v[118:119]
v_lshlrev_b32 v120, 16, v164
v_and_b32 v121, 0xffff0000, v164
v_pk_add_f32 v[56:57], v[56:57], v[88:89]
v_pk_add_f32 v[56:57], v[56:57], v[120:121]
v_lshlrev_b32 v122, 16, v165
v_and_b32 v123, 0xffff0000, v165
v_pk_add_f32 v[58:59], v[58:59], v[90:91]
v_pk_add_f32 v[58:59], v[58:59], v[122:123]
v_lshlrev_b32 v124, 16, v166
v_and_b32 v125, 0xffff0000, v166
v_pk_add_f32 v[60:61], v[60:61], v[92:93]
v_pk_add_f32 v[60:61], v[60:61], v[124:125]
v_lshlrev_b32 v126, 16, v167
v_and_b32 v127, 0xffff0000, v167
v_pk_add_f32 v[62:63], v[62:63], v[94:95]
v_pk_add_f32 v[62:63], v[62:63], v[126:127]
v_lshlrev_b32 v112, 16, v168
v_and_b32 v113, 0xffff0000, v168
v_pk_add_f32 v[64:65], v[64:65], v[80:81]
v_pk_add_f32 v[64:65], v[64:65], v[112:113]
v_lshlrev_b32 v114, 16, v169
v_and_b32 v115, 0xffff0000, v169
v_pk_add_f32 v[66:67], v[66:67], v[82:83]
v_pk_add_f32 v[66:67], v[66:67], v[114:115]
v_lshlrev_b32 v116, 16, v170
v_and_b32 v117, 0xffff0000, v170
v_pk_add_f32 v[68:69], v[68:69], v[84:85]
v_pk_add_f32 v[68:69], v[68:69], v[116:117]
v_lshlrev_b32 v118, 16, v171
v_and_b32 v119, 0xffff0000, v171
v_pk_add_f32 v[70:71], v[70:71], v[86:87]
v_pk_add_f32 v[70:71], v[70:71], v[118:119]
v_lshlrev_b32 v120, 16, v172
v_and_b32 v121, 0xffff0000, v172
v_pk_add_f32 v[72:73], v[72:73], v[88:89]
v_pk_add_f32 v[72:73], v[72:73], v[120:121]
v_lshlrev_b32 v122, 16, v173
v_and_b32 v123, 0xffff0000, v173
v_pk_add_f32 v[74:75], v[74:75], v[90:91]
v_pk_add_f32 v[74:75], v[74:75], v[122:123]
v_lshlrev_b32 v124, 16, v174
v_and_b32 v125, 0xffff0000, v174
v_pk_add_f32 v[76:77], v[76:77], v[92:93]
v_pk_add_f32 v[76:77], v[76:77], v[124:125]
v_lshlrev_b32 v126, 16, v175
v_and_b32 v127, 0xffff0000, v175
v_pk_add_f32 v[78:79], v[78:79], v[94:95]
v_pk_add_f32 v[78:79], v[78:79], v[126:127]
s_waitcnt vmcnt(0)
v_pk_add_f32 v[16:17], v[16:17], v[184:185]
v_pk_add_f32 v[18:19], v[18:19], v[186:187]
v_pk_add_f32 v[20:21], v[20:21], v[188:189]
v_pk_add_f32 v[22:23], v[22:23], v[190:191]
v_pk_add_f32 v[24:25], v[24:25], v[192:193]
v_pk_add_f32 v[26:27], v[26:27], v[194:195]
v_pk_add_f32 v[28:29], v[28:29], v[196:197]
v_pk_add_f32 v[30:31], v[30:31], v[198:199]
v_pk_add_f32 v[32:33], v[32:33], v[200:201]
v_pk_add_f32 v[34:35], v[34:35], v[202:203]
v_pk_add_f32 v[36:37], v[36:37], v[204:205]
v_pk_add_f32 v[38:39], v[38:39], v[206:207]
v_pk_add_f32 v[40:41], v[40:41], v[208:209]
v_pk_add_f32 v[42:43], v[42:43], v[210:211]
v_pk_add_f32 v[44:45], v[44:45], v[212:213]
v_pk_add_f32 v[46:47], v[46:47], v[214:215]
v_pk_add_f32 v[48:49], v[48:49], v[216:217]
v_pk_add_f32 v[50:51], v[50:51], v[218:219]
v_pk_add_f32 v[52:53], v[52:53], v[220:221]
v_pk_add_f32 v[54:55], v[54:55], v[222:223]
v_pk_add_f32 v[56:57], v[56:57], v[224:225]
v_pk_add_f32 v[58:59], v[58:59], v[226:227]
v_pk_add_f32 v[60:61], v[60:61], v[228:229]
v_pk_add_f32 v[62:63], v[62:63], v[230:231]
v_pk_add_f32 v[64:65], v[64:65], v[232:233]
v_pk_add_f32 v[66:67], v[66:67], v[234:235]
v_pk_add_f32 v[68:69], v[68:69], v[236:237]
v_pk_add_f32 v[70:71], v[70:71], v[238:239]
v_pk_add_f32 v[72:73], v[72:73], v[240:241]
v_pk_add_f32 v[74:75], v[74:75], v[242:243]
v_pk_add_f32 v[76:77], v[76:77], v[244:245]
v_pk_add_f32 v[78:79], v[78:79], v[246:247]
v_cvt_pk_bf16_f32 v96, v16, v17
v_cvt_pk_bf16_f32 v97, v18, v19
v_cvt_pk_bf16_f32 v98, v32, v33
v_cvt_pk_bf16_f32 v99, v34, v35
s_nop 0
v_permlane16_swap_b32 v96, v98
v_permlane16_swap_b32 v97, v99
buffer_store_dwordx4 v[96:99], v12, s[52:55], s70 offen offset:0
v_cvt_pk_bf16_f32 v100, v20, v21
v_cvt_pk_bf16_f32 v101, v22, v23
v_cvt_pk_bf16_f32 v102, v36, v37
v_cvt_pk_bf16_f32 v103, v38, v39
s_nop 0
v_permlane16_swap_b32 v100, v102
v_permlane16_swap_b32 v101, v103
buffer_store_dwordx4 v[100:103], v12, s[52:55], s70 offen offset:32
v_cvt_pk_bf16_f32 v96, v24, v25
v_cvt_pk_bf16_f32 v97, v26, v27
v_cvt_pk_bf16_f32 v98, v40, v41
v_cvt_pk_bf16_f32 v99, v42, v43
s_nop 0
v_permlane16_swap_b32 v96, v98
v_permlane16_swap_b32 v97, v99
buffer_store_dwordx4 v[96:99], v12, s[52:55], s70 offen offset:64
v_cvt_pk_bf16_f32 v100, v28, v29
v_cvt_pk_bf16_f32 v101, v30, v31
v_cvt_pk_bf16_f32 v102, v44, v45
v_cvt_pk_bf16_f32 v103, v46, v47
s_nop 0
v_permlane16_swap_b32 v100, v102
v_permlane16_swap_b32 v101, v103
buffer_store_dwordx4 v[100:103], v12, s[52:55], s70 offen offset:96
s_add_u32 s70, s70, 65536
v_cvt_pk_bf16_f32 v104, v48, v49
v_cvt_pk_bf16_f32 v105, v50, v51
v_cvt_pk_bf16_f32 v106, v64, v65
v_cvt_pk_bf16_f32 v107, v66, v67
s_nop 0
v_permlane16_swap_b32 v104, v106
v_permlane16_swap_b32 v105, v107
buffer_store_dwordx4 v[104:107], v12, s[52:55], s70 offen offset:0
v_cvt_pk_bf16_f32 v108, v52, v53
v_cvt_pk_bf16_f32 v109, v54, v55
v_cvt_pk_bf16_f32 v110, v68, v69
v_cvt_pk_bf16_f32 v111, v70, v71
s_nop 0
v_permlane16_swap_b32 v108, v110
v_permlane16_swap_b32 v109, v111
buffer_store_dwordx4 v[108:111], v12, s[52:55], s70 offen offset:32
v_cvt_pk_bf16_f32 v104, v56, v57
v_cvt_pk_bf16_f32 v105, v58, v59
v_cvt_pk_bf16_f32 v106, v72, v73
v_cvt_pk_bf16_f32 v107, v74, v75
s_nop 0
v_permlane16_swap_b32 v104, v106
v_permlane16_swap_b32 v105, v107
buffer_store_dwordx4 v[104:107], v12, s[52:55], s70 offen offset:64
v_cvt_pk_bf16_f32 v108, v60, v61
v_cvt_pk_bf16_f32 v109, v62, v63
v_cvt_pk_bf16_f32 v110, v76, v77
v_cvt_pk_bf16_f32 v111, v78, v79
s_nop 0
v_permlane16_swap_b32 v108, v110
v_permlane16_swap_b32 v109, v111
buffer_store_dwordx4 v[108:111], v12, s[52:55], s70 offen offset:96
s_endpgm
kp_helper:
s_sub_u32 s7, s3, 6
s_add_u32 s56, s8, 0x1200000
s_addc_u32 s57, s9, 0
s_mov_b32 s58, 0x8000
s_mov_b32 s59, 0x20000
v_mov_b32 v20, 0
v_lshlrev_b32 v21, 2, v1
v_add_u32 v21, 163792, v21
s_mov_b64 exec, 0xff
ds_write_b32 v21, v20
s_mov_b64 exec, -1
s_waitcnt lgkmcnt(0)
s_and_b32 s4, s30, 1
s_lshr_b32 s5, s30, 1
s_mul_i32 s4, s4, 8
s_mul_i32 s5, s5, 4
s_and_b32 s64, s31, 7
s_add_u32 s4, s4, s64
s_lshr_b32 s64, s31, 3
s_add_u32 s5, s5, s64
s_cmp_lg_u32 s7, 1
s_cbranch_scc1 h_nocpf
s_getpc_b64 s[72:73]
kp_pc1:
s_sub_u32 s72, s72, kp_pc1-kp_kernel
s_subb_u32 s73, s73, 0
v_lshlrev_b32 v30, 7, v1
s_mov_b32 s75, kp_codeend-kp_kernel
v_cmp_gt_u32 vcc, s75, v30
s_nop 1
v_cndmask_b32 v31, 0, v30, vcc
global_load_dword v32, v31, s[72:73]
v_add_u32 v30, 8192, v30
v_cmp_gt_u32 vcc, s75, v30
s_nop 1
v_cndmask_b32 v31, 0, v30, vcc
global_load_dword v32, v31, s[72:73]
v_add_u32 v30, 8192, v30
v_cmp_gt_u32 vcc, s75, v30
s_nop 1
v_cndmask_b32 v31, 0, v30, vcc
global_load_dword v32, v31, s[72:73]
v_add_u32 v30, 8192, v30
v_cmp_gt_u32 vcc, s75, v30
s_nop 1
v_cndmask_b32 v31, 0, v30, vcc
global_load_dword v32, v31, s[72:73]
v_add_u32 v30, 8192, v30
v_cmp_gt_u32 vcc, s75, v30
s_nop 1
v_cndmask_b32 v31, 0, v30, vcc
global_load_dword v32, v31, s[72:73]
v_add_u32 v30, 8192, v30
v_cmp_gt_u32 vcc, s75, v30
s_nop 1
v_cndmask_b32 v31, 0, v30, vcc
global_load_dword v32, v31, s[72:73]
v_add_u32 v30, 8192, v30
v_cmp_gt_u32 vcc, s75, v30
s_nop 1
v_cndmask_b32 v31, 0, v30, vcc
global_load_dword v32, v31, s[72:73]
v_add_u32 v30, 8192, v30
v_cmp_gt_u32 vcc, s75, v30
s_nop 1
v_cndmask_b32 v31, 0, v30, vcc
global_load_dword v32, v31, s[72:73]
h_nocpf:
s_mov_b32 s32, s84
s_mov_b32 s33, s85
s_mov_b32 s34, 0x100
s_mov_b32 s35, 0x20000
s_or_b32 s70, s2, s7
s_cmp_lg_u32 s70, 0
s_cbranch_scc1 h_nononce
s_memrealtime s[70:71]
s_waitcnt lgkmcnt(0)
s_or_b32 s70, s70, 1
s_xor_b32 s71, s71, 0x5bd1e995
v_mov_b32 v20, s70
v_mov_b32 v21, s71
v_mov_b32 v22, 0
s_mov_b64 exec, 1
buffer_store_dwordx2 v[20:21], v22, s[32:35], 0 offen sc1
s_mov_b64 exec, -1
h_nononce:
v_mov_b32 v22, 0
s_barrier
buffer_load_dwordx2 v[20:21], v22, s[32:35], 0 offen sc1
s_barrier
s_barrier
s_mov_b32 s80, 0
h_npoll:
s_waitcnt vmcnt(0)
v_readfirstlane_b32 s28, v20
v_readfirstlane_b32 s29, v21
s_nop 2
s_cmp_lg_u32 s28, 0
s_cbranch_scc1 h_nok
buffer_load_dwordx2 v[20:21], v22, s[32:35], 0 offen sc1
s_add_u32 s80, s80, 1
s_cmp_lt_u32 s80, 0x40000
s_cbranch_scc1 h_npoll
h_nok:
v_mov_b32 v22, 163776
ds_write_b64 v22, v[20:21]
s_waitcnt lgkmcnt(0)
s_barrier
s_barrier
s_barrier
s_barrier
s_cmp_lg_u32 s7, 0
s_cbranch_scc1 h1_path
s_add_u32 s48, s8, 0x80000
s_addc_u32 s49, s9, 0
s_mov_b32 s50, 0x80000
s_mov_b32 s51, 0x20000
v_lshlrev_b32 v18, 4, v1
v_add_u32 v19, 135424, v18
ds_read_b128 v[24:27], v19
v_lshlrev_b32 v17, 5, v1
s_lshl_b32 s70, s5, 11
s_lshl_b32 s71, s4, 7
s_add_u32 s70, s70, s71
s_lshl_b32 s70, s70, 4
s_waitcnt lgkmcnt(0)
v_mov_b32 v28, v24
v_mov_b32 v29, v25
v_mov_b32 v30, s28
v_mov_b32 v31, s28
v_mov_b32 v24, v26
v_mov_b32 v25, v27
v_mov_b32 v26, s28
v_mov_b32 v27, s28
buffer_store_dwordx4 v[28:31], v17, s[48:51], s70 offen sc1
buffer_store_dwordx4 v[24:27], v17, s[48:51], s70 offen offset:16 sc1
s_barrier
s_barrier
s_barrier
s_lshl_b32 s70, s4, 11
s_add_u32 s70, s70, 0
buffer_load_dwordx4 v[32:35], v17, s[48:51], s70 offen sc1
buffer_load_dwordx4 v[36:39], v17, s[48:51], s70 offen offset:16 sc1
s_lshl_b32 s70, s4, 11
s_add_u32 s70, s70, 32768
buffer_load_dwordx4 v[40:43], v17, s[48:51], s70 offen sc1
buffer_load_dwordx4 v[44:47], v17, s[48:51], s70 offen offset:16 sc1
s_lshl_b32 s70, s4, 11
s_add_u32 s70, s70, 65536
buffer_load_dwordx4 v[48:51], v17, s[48:51], s70 offen sc1
buffer_load_dwordx4 v[52:55], v17, s[48:51], s70 offen offset:16 sc1
s_lshl_b32 s70, s4, 11
s_add_u32 s70, s70, 98304
buffer_load_dwordx4 v[56:59], v17, s[48:51], s70 offen sc1
buffer_load_dwordx4 v[60:63], v17, s[48:51], s70 offen offset:16 sc1
s_lshl_b32 s70, s4, 11
s_add_u32 s70, s70, 131072
buffer_load_dwordx4 v[64:67], v17, s[48:51], s70 offen sc1
buffer_load_dwordx4 v[68:71], v17, s[48:51], s70 offen offset:16 sc1
s_lshl_b32 s70, s4, 11
s_add_u32 s70, s70, 163840
buffer_load_dwordx4 v[72:75], v17, s[48:51], s70 offen sc1
buffer_load_dwordx4 v[76:79], v17, s[48:51], s70 offen offset:16 sc1
s_lshl_b32 s70, s4, 11
s_add_u32 s70, s70, 196608
buffer_load_dwordx4 v[80:83], v17, s[48:51], s70 offen sc1
buffer_load_dwordx4 v[84:87], v17, s[48:51], s70 offen offset:16 sc1
s_lshl_b32 s70, s4, 11
s_add_u32 s70, s70, 229376
buffer_load_dwordx4 v[88:91], v17, s[48:51], s70 offen sc1
buffer_load_dwordx4 v[92:95], v17, s[48:51], s70 offen offset:16 sc1
s_lshl_b32 s70, s4, 11
s_add_u32 s70, s70, 262144
buffer_load_dwordx4 v[96:99], v17, s[48:51], s70 offen sc1
buffer_load_dwordx4 v[100:103], v17, s[48:51], s70 offen offset:16 sc1
s_lshl_b32 s70, s4, 11
s_add_u32 s70, s70, 294912
buffer_load_dwordx4 v[104:107], v17, s[48:51], s70 offen sc1
buffer_load_dwordx4 v[108:111], v17, s[48:51], s70 offen offset:16 sc1
s_lshl_b32 s70, s4, 11
s_add_u32 s70, s70, 327680
buffer_load_dwordx4 v[112:115], v17, s[48:51], s70 offen sc1
buffer_load_dwordx4 v[116:119], v17, s[48:51], s70 offen offset:16 sc1
s_lshl_b32 s70, s4, 11
s_add_u32 s70, s70, 360448
buffer_load_dwordx4 v[120:123], v17, s[48:51], s70 offen sc1
buffer_load_dwordx4 v[124:127], v17, s[48:51], s70 offen offset:16 sc1
s_lshl_b32 s70, s4, 11
s_add_u32 s70, s70, 393216
buffer_load_dwordx4 v[128:131], v17, s[48:51], s70 offen sc1
buffer_load_dwordx4 v[132:135], v17, s[48:51], s70 offen offset:16 sc1
s_lshl_b32 s70, s4, 11
s_add_u32 s70, s70, 425984
buffer_load_dwordx4 v[136:139], v17, s[48:51], s70 offen sc1
buffer_load_dwordx4 v[140:143], v17, s[48:51], s70 offen offset:16 sc1
s_lshl_b32 s70, s4, 11
s_add_u32 s70, s70, 458752
buffer_load_dwordx4 v[144:147], v17, s[48:51], s70 offen sc1
buffer_load_dwordx4 v[148:151], v17, s[48:51], s70 offen offset:16 sc1
s_lshl_b32 s70, s4, 11
s_add_u32 s70, s70, 491520
buffer_load_dwordx4 v[152:155], v17, s[48:51], s70 offen sc1
buffer_load_dwordx4 v[156:159], v17, s[48:51], s70 offen offset:16 sc1
s_barrier
s_barrier
s_barrier
s_barrier
s_barrier
s_mov_b32 s80, 0
rs_retry:
s_waitcnt vmcnt(0)
v_min3_u32 v160, v34, v38, v42
v_max3_u32 v161, v34, v38, v42
v_min3_u32 v160, v160, v46, v50
v_max3_u32 v161, v161, v46, v50
v_min3_u32 v160, v160, v54, v58
v_max3_u32 v161, v161, v54, v58
v_min3_u32 v160, v160, v62, v66
v_max3_u32 v161, v161, v62, v66
v_min3_u32 v160, v160, v70, v74
v_max3_u32 v161, v161, v70, v74
v_min3_u32 v160, v160, v78, v82
v_max3_u32 v161, v161, v78, v82
v_min3_u32 v160, v160, v86, v90
v_max3_u32 v161, v161, v86, v90
v_min3_u32 v160, v160, v94, v98
v_max3_u32 v161, v161, v94, v98
v_min3_u32 v160, v160, v102, v106
v_max3_u32 v161, v161, v102, v106
v_min3_u32 v160, v160, v110, v114
v_max3_u32 v161, v161, v110, v114
v_min3_u32 v160, v160, v118, v122
v_max3_u32 v161, v161, v118, v122
v_min3_u32 v160, v160, v126, v130
v_max3_u32 v161, v161, v126, v130
v_min3_u32 v160, v160, v134, v138
v_max3_u32 v161, v161, v134, v138
v_min3_u32 v160, v160, v142, v146
v_max3_u32 v161, v161, v142, v146
v_min3_u32 v160, v160, v150, v154
v_max3_u32 v161, v161, v150, v154
v_min3_u32 v160, v160, v158, v158
v_max3_u32 v161, v161, v158, v158
v_cmp_ne_u32 vcc, s28, v160
v_cmp_ne_u32 s[78:79], s28, v161
s_nop 3
s_or_b64 s[78:79], vcc, s[78:79]
s_cmp_eq_u64 s[78:79], 0
s_cbranch_scc1 rs_ok
s_lshl_b32 s70, s4, 11
s_add_u32 s70, s70, 0
buffer_load_dwordx4 v[32:35], v17, s[48:51], s70 offen sc1
buffer_load_dwordx4 v[36:39], v17, s[48:51], s70 offen offset:16 sc1
s_lshl_b32 s70, s4, 11
s_add_u32 s70, s70, 32768
buffer_load_dwordx4 v[40:43], v17, s[48:51], s70 offen sc1
buffer_load_dwordx4 v[44:47], v17, s[48:51], s70 offen offset:16 sc1
s_lshl_b32 s70, s4, 11
s_add_u32 s70, s70, 65536
buffer_load_dwordx4 v[48:51], v17, s[48:51], s70 offen sc1
buffer_load_dwordx4 v[52:55], v17, s[48:51], s70 offen offset:16 sc1
s_lshl_b32 s70, s4, 11
s_add_u32 s70, s70, 98304
buffer_load_dwordx4 v[56:59], v17, s[48:51], s70 offen sc1
buffer_load_dwordx4 v[60:63], v17, s[48:51], s70 offen offset:16 sc1
s_lshl_b32 s70, s4, 11
s_add_u32 s70, s70, 131072
buffer_load_dwordx4 v[64:67], v17, s[48:51], s70 offen sc1
buffer_load_dwordx4 v[68:71], v17, s[48:51], s70 offen offset:16 sc1
s_lshl_b32 s70, s4, 11
s_add_u32 s70, s70, 163840
buffer_load_dwordx4 v[72:75], v17, s[48:51], s70 offen sc1
buffer_load_dwordx4 v[76:79], v17, s[48:51], s70 offen offset:16 sc1
s_lshl_b32 s70, s4, 11
s_add_u32 s70, s70, 196608
buffer_load_dwordx4 v[80:83], v17, s[48:51], s70 offen sc1
buffer_load_dwordx4 v[84:87], v17, s[48:51], s70 offen offset:16 sc1
s_lshl_b32 s70, s4, 11
s_add_u32 s70, s70, 229376
buffer_load_dwordx4 v[88:91], v17, s[48:51], s70 offen sc1
buffer_load_dwordx4 v[92:95], v17, s[48:51], s70 offen offset:16 sc1
s_lshl_b32 s70, s4, 11
s_add_u32 s70, s70, 262144
buffer_load_dwordx4 v[96:99], v17, s[48:51], s70 offen sc1
buffer_load_dwordx4 v[100:103], v17, s[48:51], s70 offen offset:16 sc1
s_lshl_b32 s70, s4, 11
s_add_u32 s70, s70, 294912
buffer_load_dwordx4 v[104:107], v17, s[48:51], s70 offen sc1
buffer_load_dwordx4 v[108:111], v17, s[48:51], s70 offen offset:16 sc1
s_lshl_b32 s70, s4, 11
s_add_u32 s70, s70, 327680
buffer_load_dwordx4 v[112:115], v17, s[48:51], s70 offen sc1
buffer_load_dwordx4 v[116:119], v17, s[48:51], s70 offen offset:16 sc1
s_lshl_b32 s70, s4, 11
s_add_u32 s70, s70, 360448
buffer_load_dwordx4 v[120:123], v17, s[48:51], s70 offen sc1
buffer_load_dwordx4 v[124:127], v17, s[48:51], s70 offen offset:16 sc1
s_lshl_b32 s70, s4, 11
s_add_u32 s70, s70, 393216
buffer_load_dwordx4 v[128:131], v17, s[48:51], s70 offen sc1
buffer_load_dwordx4 v[132:135], v17, s[48:51], s70 offen offset:16 sc1
s_lshl_b32 s70, s4, 11
s_add_u32 s70, s70, 425984
buffer_load_dwordx4 v[136:139], v17, s[48:51], s70 offen sc1
buffer_load_dwordx4 v[140:143], v17, s[48:51], s70 offen offset:16 sc1
s_lshl_b32 s70, s4, 11
s_add_u32 s70, s70, 458752
buffer_load_dwordx4 v[144:147], v17, s[48:51], s70 offen sc1
buffer_load_dwordx4 v[148:151], v17, s[48:51], s70 offen offset:16 sc1
s_lshl_b32 s70, s4, 11
s_add_u32 s70, s70, 491520
buffer_load_dwordx4 v[152:155], v17, s[48:51], s70 offen sc1
buffer_load_dwordx4 v[156:159], v17, s[48:51], s70 offen offset:16 sc1
s_add_u32 s80, s80, 1
s_cmp_lt_u32 s80, 0x20000
s_cbranch_scc1 rs_retry
rs_ok:
v_pk_add_f32 v[32:33], v[32:33], v[40:41]
v_pk_add_f32 v[36:37], v[36:37], v[44:45]
v_pk_add_f32 v[32:33], v[32:33], v[48:49]
v_pk_add_f32 v[36:37], v[36:37], v[52:53]
v_pk_add_f32 v[32:33], v[32:33], v[56:57]
v_pk_add_f32 v[36:37], v[36:37], v[60:61]
v_pk_add_f32 v[32:33], v[32:33], v[64:65]
v_pk_add_f32 v[36:37], v[36:37], v[68:69]
v_pk_add_f32 v[32:33], v[32:33], v[72:73]
v_pk_add_f32 v[36:37], v[36:37], v[76:77]
v_pk_add_f32 v[32:33], v[32:33], v[80:81]
v_pk_add_f32 v[36:37], v[36:37], v[84:85]
v_pk_add_f32 v[32:33], v[32:33], v[88:89]
v_pk_add_f32 v[36:37], v[36:37], v[92:93]
v_pk_add_f32 v[32:33], v[32:33], v[96:97]
v_pk_add_f32 v[36:37], v[36:37], v[100:101]
v_pk_add_f32 v[32:33], v[32:33], v[104:105]
v_pk_add_f32 v[36:37], v[36:37], v[108:109]
v_pk_add_f32 v[32:33], v[32:33], v[112:113]
v_pk_add_f32 v[36:37], v[36:37], v[116:117]
v_pk_add_f32 v[32:33], v[32:33], v[120:121]
v_pk_add_f32 v[36:37], v[36:37], v[124:125]
v_pk_add_f32 v[32:33], v[32:33], v[128:129]
v_pk_add_f32 v[36:37], v[36:37], v[132:133]
v_pk_add_f32 v[32:33], v[32:33], v[136:137]
v_pk_add_f32 v[36:37], v[36:37], v[140:141]
v_pk_add_f32 v[32:33], v[32:33], v[144:145]
v_pk_add_f32 v[36:37], v[36:37], v[148:149]
v_pk_add_f32 v[32:33], v[32:33], v[152:153]
v_pk_add_f32 v[36:37], v[36:37], v[156:157]
s_barrier
v_mul_f32 v32, 0x3a800000, v32
v_mul_f32 v33, 0x3a800000, v33
v_fma_f32 v33, -v32, v32, v33
v_max_f32 v33, 0, v33
v_add_f32 v33, 0x3727c5ac, v33
v_mul_f32 v36, 0x3a800000, v36
v_mul_f32 v37, 0x3a800000, v37
v_fma_f32 v37, -v36, v36, v37
v_max_f32 v37, 0, v37
v_add_f32 v37, 0x3727c5ac, v37
v_rsq_f32 v40, v33
v_rsq_f32 v42, v37
v_mul_f32 v41, v32, v40
v_mul_f32 v43, v36, v42
v_sub_f32 v41, 0, v41
v_sub_f32 v43, 0, v43
ds_write_b128 v19, v[40:43]
s_waitcnt lgkmcnt(0)
s_barrier
s_branch h_p1done
h1_path:
s_add_u32 s52, s8, 0x10000
s_addc_u32 s53, s9, 0
s_mov_b32 s54, 0x40000
s_mov_b32 s55, 0x20000
v_mul_u32_u24 v19, 12, v1
v_add_u32 v19, 137216, v19
ds_read_b32 v24, v19 offset:0
ds_read_b32 v25, v19 offset:4
ds_read_b32 v26, v19 offset:8
v_mov_b32 v27, s28
v_lshlrev_b32 v18, 4, v1
s_lshl_b32 s70, s4, 4
s_add_u32 s70, s70, s5
s_lshl_b32 s70, s70, 10
s_waitcnt lgkmcnt(0)
buffer_store_dwordx4 v[24:27], v18, s[52:55], s70 offen sc1
s_barrier
s_barrier
s_barrier
s_lshl_b32 s70, s5, 10
s_add_u32 s70, s70, 0
buffer_load_dwordx4 v[32:35], v18, s[52:55], s70 offen sc1
s_lshl_b32 s70, s5, 10
s_add_u32 s70, s70, 16384
buffer_load_dwordx4 v[36:39], v18, s[52:55], s70 offen sc1
s_lshl_b32 s70, s5, 10
s_add_u32 s70, s70, 32768
buffer_load_dwordx4 v[40:43], v18, s[52:55], s70 offen sc1
s_lshl_b32 s70, s5, 10
s_add_u32 s70, s70, 49152
buffer_load_dwordx4 v[44:47], v18, s[52:55], s70 offen sc1
s_lshl_b32 s70, s5, 10
s_add_u32 s70, s70, 65536
buffer_load_dwordx4 v[48:51], v18, s[52:55], s70 offen sc1
s_lshl_b32 s70, s5, 10
s_add_u32 s70, s70, 81920
buffer_load_dwordx4 v[52:55], v18, s[52:55], s70 offen sc1
s_lshl_b32 s70, s5, 10
s_add_u32 s70, s70, 98304
buffer_load_dwordx4 v[56:59], v18, s[52:55], s70 offen sc1
s_lshl_b32 s70, s5, 10
s_add_u32 s70, s70, 114688
buffer_load_dwordx4 v[60:63], v18, s[52:55], s70 offen sc1
s_lshl_b32 s70, s5, 10
s_add_u32 s70, s70, 131072
buffer_load_dwordx4 v[64:67], v18, s[52:55], s70 offen sc1
s_lshl_b32 s70, s5, 10
s_add_u32 s70, s70, 147456
buffer_load_dwordx4 v[68:71], v18, s[52:55], s70 offen sc1
s_lshl_b32 s70, s5, 10
s_add_u32 s70, s70, 163840
buffer_load_dwordx4 v[72:75], v18, s[52:55], s70 offen sc1
s_lshl_b32 s70, s5, 10
s_add_u32 s70, s70, 180224
buffer_load_dwordx4 v[76:79], v18, s[52:55], s70 offen sc1
s_lshl_b32 s70, s5, 10
s_add_u32 s70, s70, 196608
buffer_load_dwordx4 v[80:83], v18, s[52:55], s70 offen sc1
s_lshl_b32 s70, s5, 10
s_add_u32 s70, s70, 212992
buffer_load_dwordx4 v[84:87], v18, s[52:55], s70 offen sc1
s_lshl_b32 s70, s5, 10
s_add_u32 s70, s70, 229376
buffer_load_dwordx4 v[88:91], v18, s[52:55], s70 offen sc1
s_lshl_b32 s70, s5, 10
s_add_u32 s70, s70, 245760
buffer_load_dwordx4 v[92:95], v18, s[52:55], s70 offen sc1
s_barrier
s_barrier
s_barrier
s_barrier
s_barrier
s_mov_b32 s80, 0
cs_retry:
s_waitcnt vmcnt(0)
v_min3_u32 v160, v35, v39, v43
v_max3_u32 v161, v35, v39, v43
v_min3_u32 v160, v160, v47, v51
v_max3_u32 v161, v161, v47, v51
v_min3_u32 v160, v160, v55, v59
v_max3_u32 v161, v161, v55, v59
v_min3_u32 v160, v160, v63, v67
v_max3_u32 v161, v161, v63, v67
v_min3_u32 v160, v160, v71, v75
v_max3_u32 v161, v161, v71, v75
v_min3_u32 v160, v160, v79, v83
v_max3_u32 v161, v161, v79, v83
v_min3_u32 v160, v160, v87, v91
v_max3_u32 v161, v161, v87, v91
v_min3_u32 v160, v160, v95, v95
v_max3_u32 v161, v161, v95, v95
v_cmp_ne_u32 vcc, s28, v160
v_cmp_ne_u32 s[78:79], s28, v161
s_nop 3
s_or_b64 s[78:79], vcc, s[78:79]
s_cmp_eq_u64 s[78:79], 0
s_cbranch_scc1 cs_ok
s_lshl_b32 s70, s5, 10
s_add_u32 s70, s70, 0
buffer_load_dwordx4 v[32:35], v18, s[52:55], s70 offen sc1
s_lshl_b32 s70, s5, 10
s_add_u32 s70, s70, 16384
buffer_load_dwordx4 v[36:39], v18, s[52:55], s70 offen sc1
s_lshl_b32 s70, s5, 10
s_add_u32 s70, s70, 32768
buffer_load_dwordx4 v[40:43], v18, s[52:55], s70 offen sc1
s_lshl_b32 s70, s5, 10
s_add_u32 s70, s70, 49152
buffer_load_dwordx4 v[44:47], v18, s[52:55], s70 offen sc1
s_lshl_b32 s70, s5, 10
s_add_u32 s70, s70, 65536
buffer_load_dwordx4 v[48:51], v18, s[52:55], s70 offen sc1
s_lshl_b32 s70, s5, 10
s_add_u32 s70, s70, 81920
buffer_load_dwordx4 v[52:55], v18, s[52:55], s70 offen sc1
s_lshl_b32 s70, s5, 10
s_add_u32 s70, s70, 98304
buffer_load_dwordx4 v[56:59], v18, s[52:55], s70 offen sc1
s_lshl_b32 s70, s5, 10
s_add_u32 s70, s70, 114688
buffer_load_dwordx4 v[60:63], v18, s[52:55], s70 offen sc1
s_lshl_b32 s70, s5, 10
s_add_u32 s70, s70, 131072
buffer_load_dwordx4 v[64:67], v18, s[52:55], s70 offen sc1
s_lshl_b32 s70, s5, 10
s_add_u32 s70, s70, 147456
buffer_load_dwordx4 v[68:71], v18, s[52:55], s70 offen sc1
s_lshl_b32 s70, s5, 10
s_add_u32 s70, s70, 163840
buffer_load_dwordx4 v[72:75], v18, s[52:55], s70 offen sc1
s_lshl_b32 s70, s5, 10
s_add_u32 s70, s70, 180224
buffer_load_dwordx4 v[76:79], v18, s[52:55], s70 offen sc1
s_lshl_b32 s70, s5, 10
s_add_u32 s70, s70, 196608
buffer_load_dwordx4 v[80:83], v18, s[52:55], s70 offen sc1
s_lshl_b32 s70, s5, 10
s_add_u32 s70, s70, 212992
buffer_load_dwordx4 v[84:87], v18, s[52:55], s70 offen sc1
s_lshl_b32 s70, s5, 10
s_add_u32 s70, s70, 229376
buffer_load_dwordx4 v[88:91], v18, s[52:55], s70 offen sc1
s_lshl_b32 s70, s5, 10
s_add_u32 s70, s70, 245760
buffer_load_dwordx4 v[92:95], v18, s[52:55], s70 offen sc1
s_add_u32 s80, s80, 1
s_cmp_lt_u32 s80, 0x20000
s_cbranch_scc1 cs_retry
cs_ok:
v_pk_add_f32 v[32:33], v[32:33], v[36:37]
v_add_f32 v34, v34, v38
v_pk_add_f32 v[32:33], v[32:33], v[40:41]
v_add_f32 v34, v34, v42
v_pk_add_f32 v[32:33], v[32:33], v[44:45]
v_add_f32 v34, v34, v46
v_pk_add_f32 v[32:33], v[32:33], v[48:49]
v_add_f32 v34, v34, v50
v_pk_add_f32 v[32:33], v[32:33], v[52:53]
v_add_f32 v34, v34, v54
v_pk_add_f32 v[32:33], v[32:33], v[56:57]
v_add_f32 v34, v34, v58
v_pk_add_f32 v[32:33], v[32:33], v[60:61]
v_add_f32 v34, v34, v62
v_pk_add_f32 v[32:33], v[32:33], v[64:65]
v_add_f32 v34, v34, v66
v_pk_add_f32 v[32:33], v[32:33], v[68:69]
v_add_f32 v34, v34, v70
v_pk_add_f32 v[32:33], v[32:33], v[72:73]
v_add_f32 v34, v34, v74
v_pk_add_f32 v[32:33], v[32:33], v[76:77]
v_add_f32 v34, v34, v78
v_pk_add_f32 v[32:33], v[32:33], v[80:81]
v_add_f32 v34, v34, v82
v_pk_add_f32 v[32:33], v[32:33], v[84:85]
v_add_f32 v34, v34, v86
v_pk_add_f32 v[32:33], v[32:33], v[88:89]
v_add_f32 v34, v34, v90
v_pk_add_f32 v[32:33], v[32:33], v[92:93]
v_add_f32 v34, v34, v94
v_mul_u32_u24 v19, 12, v1
v_add_u32 v19, 136448, v19
ds_write_b32 v19, v32 offset:0
ds_write_b32 v19, v33 offset:4
ds_write_b32 v19, v34 offset:8
s_waitcnt lgkmcnt(0)
s_barrier
s_barrier
h_p1done:
s_barrier
s_sub_u32 s77, s3, 4
s_and_b32 s93, s77, 1
s_lshr_b32 s92, s77, 1
v_lshlrev_b32 v5, 4, v1
s_lshl_b32 s70, s77, 13
s_add_u32 s70, s70, 65536
v_add_u32 v5, s70, v5
ds_read_b128 v[160:163], v5 offset:0
ds_read_b128 v[164:167], v5 offset:1024
v_lshrrev_b32 v11, 4, v1
v_bfe_u32 v12, v1, 2, 2
v_and_b32 v13, 3, v1
v_lshlrev_b32 v14, 8, v11
v_lshl_add_u32 v14, v12, 6, v14
v_lshl_add_u32 v14, v13, 3, v14
s_lshl_b32 s70, s93, 11
s_add_u32 s70, s70, 122880
v_add_u32 v14, s70, v14
ds_read_b64_tr_b16 v[112:113], v14 offset:0
ds_read_b64_tr_b16 v[114:115], v14 offset:1024
ds_read_b64_tr_b16 v[116:117], v14 offset:32
ds_read_b64_tr_b16 v[118:119], v14 offset:1056
s_mov_b32 s94, 0x3fb8aa3b
s_mov_b32 s95, 0x3fb8aa3b
v_and_b32 v10, 15, v1
s_lshl_b32 s70, s77, 13
v_bfe_u32 v14, v10, 1, 2
v_bfe_u32 v15, v10, 2, 1
v_lshl_or_b32 v14, v15, 2, v14
v_xor_b32 v14, v14, v11
v_lshlrev_b32 v15, 6, v10
v_lshl_add_u32 v15, v14, 3, v15
v_add_u32 v8, s70, v15
v_xor_b32 v9, 32, v8
s_waitcnt lgkmcnt(0)
v_mfma_f32_16x16x32_bf16 v[16:19], v[112:115], v[160:163], 0
v_mfma_f32_16x16x32_bf16 v[20:23], v[116:119], v[160:163], 0
v_mfma_f32_16x16x32_bf16 v[48:51], v[112:115], v[164:167], 0
v_mfma_f32_16x16x32_bf16 v[52:55], v[116:119], v[164:167], 0
s_nop 4
v_max3_f32 v32, v16, v17, v18
s_nop 0
v_max3_f32 v64, v48, v49, v50
v_min3_f32 v34, v16, v17, v18
v_min3_f32 v66, v48, v49, v50
v_max3_f32 v32, v32, v19, v20
v_max3_f32 v64, v64, v51, v52
v_min3_f32 v34, v34, v19, v20
v_min3_f32 v66, v66, v51, v52
v_max3_f32 v32, v32, v21, v22
v_max3_f32 v64, v64, v53, v54
v_min3_f32 v34, v34, v21, v22
v_min3_f32 v66, v66, v53, v54
v_max_f32 v32, v32, v23
v_max_f32 v64, v64, v55
v_min_f32 v34, v34, v23
v_min_f32 v66, v66, v55
v_mov_b32 v36, v32
v_mov_b32 v68, v64
v_mov_b32 v37, v34
v_mov_b32 v69, v66
v_permlane16_swap_b32 v32, v36
v_permlane16_swap_b32 v64, v68
v_permlane16_swap_b32 v34, v37
v_permlane16_swap_b32 v66, v69
v_max_f32 v32, v32, v36
v_max_f32 v64, v64, v68
v_min_f32 v34, v34, v37
v_min_f32 v66, v66, v69
v_mov_b32 v36, v32
v_mov_b32 v68, v64
v_mov_b32 v37, v34
v_mov_b32 v69, v66
v_permlane32_swap_b32 v32, v36
v_permlane32_swap_b32 v64, v68
v_permlane32_swap_b32 v34, v37
v_permlane32_swap_b32 v66, v69
v_max_f32 v32, v32, v36
v_max_f32 v64, v64, v68
v_min_f32 v34, v34, v37
v_min_f32 v66, v66, v69
v_mul_f32 v32, s94, v32
v_mul_f32 v64, s94, v64
v_mul_f32 v34, s94, v34
v_mul_f32 v66, s94, v66
v_pk_fma_f32 v[24:25], v[16:17], s[94:95], v[32:33] op_sel_hi:[1,1,0] neg_lo:[0,0,1] neg_hi:[0,0,1]
v_pk_fma_f32 v[56:57], v[48:49], s[94:95], v[64:65] op_sel_hi:[1,1,0] neg_lo:[0,0,1] neg_hi:[0,0,1]
v_pk_fma_f32 v[16:17], v[16:17], s[94:95], v[34:35] op_sel_hi:[1,1,0] neg_lo:[1,0,0] neg_hi:[1,0,0]
v_pk_fma_f32 v[48:49], v[48:49], s[94:95], v[66:67] op_sel_hi:[1,1,0] neg_lo:[1,0,0] neg_hi:[1,0,0]
v_pk_fma_f32 v[26:27], v[18:19], s[94:95], v[32:33] op_sel_hi:[1,1,0] neg_lo:[0,0,1] neg_hi:[0,0,1]
v_pk_fma_f32 v[58:59], v[50:51], s[94:95], v[64:65] op_sel_hi:[1,1,0] neg_lo:[0,0,1] neg_hi:[0,0,1]
v_pk_fma_f32 v[18:19], v[18:19], s[94:95], v[34:35] op_sel_hi:[1,1,0] neg_lo:[1,0,0] neg_hi:[1,0,0]
v_pk_fma_f32 v[50:51], v[50:51], s[94:95], v[66:67] op_sel_hi:[1,1,0] neg_lo:[1,0,0] neg_hi:[1,0,0]
v_pk_fma_f32 v[28:29], v[20:21], s[94:95], v[32:33] op_sel_hi:[1,1,0] neg_lo:[0,0,1] neg_hi:[0,0,1]
v_pk_fma_f32 v[60:61], v[52:53], s[94:95], v[64:65] op_sel_hi:[1,1,0] neg_lo:[0,0,1] neg_hi:[0,0,1]
v_pk_fma_f32 v[20:21], v[20:21], s[94:95], v[34:35] op_sel_hi:[1,1,0] neg_lo:[1,0,0] neg_hi:[1,0,0]
v_pk_fma_f32 v[52:53], v[52:53], s[94:95], v[66:67] op_sel_hi:[1,1,0] neg_lo:[1,0,0] neg_hi:[1,0,0]
v_pk_fma_f32 v[30:31], v[22:23], s[94:95], v[32:33] op_sel_hi:[1,1,0] neg_lo:[0,0,1] neg_hi:[0,0,1]
v_pk_fma_f32 v[62:63], v[54:55], s[94:95], v[64:65] op_sel_hi:[1,1,0] neg_lo:[0,0,1] neg_hi:[0,0,1]
v_pk_fma_f32 v[22:23], v[22:23], s[94:95], v[34:35] op_sel_hi:[1,1,0] neg_lo:[1,0,0] neg_hi:[1,0,0]
v_pk_fma_f32 v[54:55], v[54:55], s[94:95], v[66:67] op_sel_hi:[1,1,0] neg_lo:[1,0,0] neg_hi:[1,0,0]
v_exp_f32 v24, v24
v_exp_f32 v56, v56
v_exp_f32 v16, v16
v_exp_f32 v48, v48
v_exp_f32 v25, v25
v_exp_f32 v57, v57
v_exp_f32 v17, v17
v_exp_f32 v49, v49
v_exp_f32 v26, v26
v_exp_f32 v58, v58
v_exp_f32 v18, v18
v_exp_f32 v50, v50
v_exp_f32 v27, v27
v_exp_f32 v59, v59
v_exp_f32 v19, v19
v_exp_f32 v51, v51
v_exp_f32 v28, v28
v_exp_f32 v60, v60
v_exp_f32 v20, v20
v_exp_f32 v52, v52
v_exp_f32 v29, v29
v_exp_f32 v61, v61
v_exp_f32 v21, v21
v_exp_f32 v53, v53
v_exp_f32 v30, v30
v_exp_f32 v62, v62
v_exp_f32 v22, v22
v_exp_f32 v54, v54
v_exp_f32 v31, v31
v_exp_f32 v63, v63
v_exp_f32 v23, v23
v_exp_f32 v55, v55
v_pk_add_f32 v[32:33], v[24:25], v[26:27]
v_pk_add_f32 v[64:65], v[56:57], v[58:59]
v_pk_add_f32 v[34:35], v[16:17], v[18:19]
v_pk_add_f32 v[66:67], v[48:49], v[50:51]
v_pk_add_f32 v[32:33], v[32:33], v[28:29]
v_pk_add_f32 v[64:65], v[64:65], v[60:61]
v_pk_add_f32 v[34:35], v[34:35], v[20:21]
v_pk_add_f32 v[66:67], v[66:67], v[52:53]
v_pk_add_f32 v[32:33], v[32:33], v[30:31]
v_pk_add_f32 v[64:65], v[64:65], v[62:63]
v_pk_add_f32 v[34:35], v[34:35], v[22:23]
v_pk_add_f32 v[66:67], v[66:67], v[54:55]
v_add_f32 v38, v32, v33
v_add_f32 v70, v64, v65
v_add_f32 v39, v34, v35
v_add_f32 v71, v66, v67
v_mov_b32 v36, v38
v_mov_b32 v68, v70
v_mov_b32 v37, v39
v_mov_b32 v69, v71
v_permlane16_swap_b32 v38, v36
v_permlane16_swap_b32 v70, v68
v_permlane16_swap_b32 v39, v37
v_permlane16_swap_b32 v71, v69
v_add_f32 v38, v38, v36
v_add_f32 v70, v70, v68
v_add_f32 v39, v39, v37
v_add_f32 v71, v71, v69
v_mov_b32 v36, v38
v_mov_b32 v68, v70
v_mov_b32 v37, v39
v_mov_b32 v69, v71
v_permlane32_swap_b32 v38, v36
v_permlane32_swap_b32 v70, v68
v_permlane32_swap_b32 v39, v37
v_permlane32_swap_b32 v71, v69
v_add_f32 v38, v38, v36
v_add_f32 v70, v70, v68
v_add_f32 v39, v39, v37
v_add_f32 v71, v71, v69
v_rcp_f32 v32, v38
v_rcp_f32 v64, v70
v_rcp_f32 v34, v39
v_rcp_f32 v66, v71
v_pk_mul_f32 v[24:25], v[24:25], v[32:33] op_sel_hi:[1,0]
v_pk_mul_f32 v[56:57], v[56:57], v[64:65] op_sel_hi:[1,0]
v_pk_mul_f32 v[16:17], v[16:17], v[34:35] op_sel_hi:[1,0]
v_pk_mul_f32 v[48:49], v[48:49], v[66:67] op_sel_hi:[1,0]
v_pk_mul_f32 v[26:27], v[26:27], v[32:33] op_sel_hi:[1,0]
v_pk_mul_f32 v[58:59], v[58:59], v[64:65] op_sel_hi:[1,0]
v_pk_mul_f32 v[18:19], v[18:19], v[34:35] op_sel_hi:[1,0]
v_pk_mul_f32 v[50:51], v[50:51], v[66:67] op_sel_hi:[1,0]
v_pk_mul_f32 v[28:29], v[28:29], v[32:33] op_sel_hi:[1,0]
v_pk_mul_f32 v[60:61], v[60:61], v[64:65] op_sel_hi:[1,0]
v_pk_mul_f32 v[20:21], v[20:21], v[34:35] op_sel_hi:[1,0]
v_pk_mul_f32 v[52:53], v[52:53], v[66:67] op_sel_hi:[1,0]
v_pk_mul_f32 v[30:31], v[30:31], v[32:33] op_sel_hi:[1,0]
v_pk_mul_f32 v[62:63], v[62:63], v[64:65] op_sel_hi:[1,0]
v_pk_mul_f32 v[22:23], v[22:23], v[34:35] op_sel_hi:[1,0]
v_pk_mul_f32 v[54:55], v[54:55], v[66:67] op_sel_hi:[1,0]
v_cvt_pk_bf16_f32 v144, v24, v25
v_cvt_pk_bf16_f32 v152, v56, v57
v_cvt_pk_bf16_f32 v145, v26, v27
v_cvt_pk_bf16_f32 v153, v58, v59
v_cvt_pk_bf16_f32 v146, v28, v29
v_cvt_pk_bf16_f32 v154, v60, v61
v_cvt_pk_bf16_f32 v147, v30, v31
v_cvt_pk_bf16_f32 v155, v62, v63
v_cvt_pk_bf16_f32 v148, v16, v17
v_cvt_pk_bf16_f32 v156, v48, v49
v_cvt_pk_bf16_f32 v149, v18, v19
v_cvt_pk_bf16_f32 v157, v50, v51
v_cvt_pk_bf16_f32 v150, v20, v21
v_cvt_pk_bf16_f32 v158, v52, v53
v_cvt_pk_bf16_f32 v151, v22, v23
v_cvt_pk_bf16_f32 v159, v54, v55
ds_write_b64 v8, v[144:145] offset:2048
ds_write_b64 v9, v[146:147] offset:2048
ds_write_b64 v8, v[148:149] offset:6144
ds_write_b64 v9, v[150:151] offset:6144
ds_write_b64 v8, v[152:153] offset:3072
ds_write_b64 v9, v[154:155] offset:3072
ds_write_b64 v8, v[156:157] offset:7168
ds_write_b64 v9, v[158:159] offset:7168
ds_read_b128 v[80:83], v5 offset:2048
ds_read_b128 v[84:87], v5 offset:3072
ds_read_b128 v[88:91], v5 offset:4096
ds_read_b128 v[92:95], v5 offset:5120
s_lshl_b32 s70, s92, 9
s_add_u32 s70, s70, 135424
v_lshlrev_b32 v14, 3, v10
v_add_u32 v14, s70, v14
ds_read_b64 v[96:97], v14 offset:256
ds_read_b64 v[98:99], v14 offset:384
s_lshl_b32 s71, s93, 7
s_add_u32 s71, s71, 136448
v_lshlrev_b32 v14, 4, v11
v_add_u32 v14, s71, v14
ds_read_b128 v[104:107], v14 offset:0
ds_read_b128 v[108:111], v14 offset:64
v_mov_b32 v14, 163776
ds_read_b64 v[6:7], v14
s_waitcnt lgkmcnt(0)
s_barrier
s_barrier
v_readfirstlane_b32 s28, v6
v_readfirstlane_b32 s29, v7
v_pk_mul_f32 v[100:101], v[104:105], v[96:97] op_sel:[0,1] op_sel_hi:[1,1]
v_pk_mul_f32 v[102:103], v[106:107], v[96:97] op_sel:[0,1] op_sel_hi:[1,1]
v_pk_fma_f32 v[80:81], v[80:81], v[96:97], v[100:101] op_sel:[0,0,0] op_sel_hi:[1,0,1]
v_pk_fma_f32 v[82:83], v[82:83], v[96:97], v[102:103] op_sel:[0,0,0] op_sel_hi:[1,0,1]
v_pk_mul_f32 v[100:101], v[108:109], v[96:97] op_sel:[0,1] op_sel_hi:[1,1]
v_pk_mul_f32 v[102:103], v[110:111], v[96:97] op_sel:[0,1] op_sel_hi:[1,1]
v_pk_fma_f32 v[84:85], v[84:85], v[96:97], v[100:101] op_sel:[0,0,0] op_sel_hi:[1,0,1]
v_pk_fma_f32 v[86:87], v[86:87], v[96:97], v[102:103] op_sel:[0,0,0] op_sel_hi:[1,0,1]
v_cvt_pk_bf16_f32 v160, v80, v81
v_cvt_pk_bf16_f32 v161, v82, v83
v_cvt_pk_bf16_f32 v162, v84, v85
v_cvt_pk_bf16_f32 v163, v86, v87
v_pk_mul_f32 v[100:101], v[104:105], v[98:99] op_sel:[0,1] op_sel_hi:[1,1]
v_pk_mul_f32 v[102:103], v[106:107], v[98:99] op_sel:[0,1] op_sel_hi:[1,1]
v_pk_fma_f32 v[88:89], v[88:89], v[98:99], v[100:101] op_sel:[0,0,0] op_sel_hi:[1,0,1]
v_pk_fma_f32 v[90:91], v[90:91], v[98:99], v[102:103] op_sel:[0,0,0] op_sel_hi:[1,0,1]
v_pk_mul_f32 v[100:101], v[108:109], v[98:99] op_sel:[0,1] op_sel_hi:[1,1]
v_pk_mul_f32 v[102:103], v[110:111], v[98:99] op_sel:[0,1] op_sel_hi:[1,1]
v_pk_fma_f32 v[92:93], v[92:93], v[98:99], v[100:101] op_sel:[0,0,0] op_sel_hi:[1,0,1]
v_pk_fma_f32 v[94:95], v[94:95], v[98:99], v[102:103] op_sel:[0,0,0] op_sel_hi:[1,0,1]
v_cvt_pk_bf16_f32 v164, v88, v89
v_cvt_pk_bf16_f32 v165, v90, v91
v_cvt_pk_bf16_f32 v166, v92, v93
v_cvt_pk_bf16_f32 v167, v94, v95
v_mfma_f32_16x16x32_bf16 v[16:19], v[112:115], v[160:163], 0
v_mfma_f32_16x16x32_bf16 v[20:23], v[116:119], v[160:163], 0
v_mfma_f32_16x16x32_bf16 v[48:51], v[112:115], v[164:167], 0
v_mfma_f32_16x16x32_bf16 v[52:55], v[116:119], v[164:167], 0
s_nop 4
v_max3_f32 v32, v16, v17, v18
s_nop 0
v_max3_f32 v64, v48, v49, v50
v_min3_f32 v34, v16, v17, v18
v_min3_f32 v66, v48, v49, v50
v_max3_f32 v32, v32, v19, v20
v_max3_f32 v64, v64, v51, v52
v_min3_f32 v34, v34, v19, v20
v_min3_f32 v66, v66, v51, v52
v_max3_f32 v32, v32, v21, v22
v_max3_f32 v64, v64, v53, v54
v_min3_f32 v34, v34, v21, v22
v_min3_f32 v66, v66, v53, v54
v_max_f32 v32, v32, v23
v_max_f32 v64, v64, v55
v_min_f32 v34, v34, v23
v_min_f32 v66, v66, v55
v_mov_b32 v36, v32
v_mov_b32 v68, v64
v_mov_b32 v37, v34
v_mov_b32 v69, v66
v_permlane16_swap_b32 v32, v36
v_permlane16_swap_b32 v64, v68
v_permlane16_swap_b32 v34, v37
v_permlane16_swap_b32 v66, v69
v_max_f32 v32, v32, v36
v_max_f32 v64, v64, v68
v_min_f32 v34, v34, v37
v_min_f32 v66, v66, v69
v_mov_b32 v36, v32
v_mov_b32 v68, v64
v_mov_b32 v37, v34
v_mov_b32 v69, v66
v_permlane32_swap_b32 v32, v36
v_permlane32_swap_b32 v64, v68
v_permlane32_swap_b32 v34, v37
v_permlane32_swap_b32 v66, v69
v_max_f32 v32, v32, v36
v_max_f32 v64, v64, v68
v_min_f32 v34, v34, v37
v_min_f32 v66, v66, v69
v_mul_f32 v32, s94, v32
v_mul_f32 v64, s94, v64
v_mul_f32 v34, s94, v34
v_mul_f32 v66, s94, v66
v_pk_fma_f32 v[24:25], v[16:17], s[94:95], v[32:33] op_sel_hi:[1,1,0] neg_lo:[0,0,1] neg_hi:[0,0,1]
v_pk_fma_f32 v[56:57], v[48:49], s[94:95], v[64:65] op_sel_hi:[1,1,0] neg_lo:[0,0,1] neg_hi:[0,0,1]
v_pk_fma_f32 v[16:17], v[16:17], s[94:95], v[34:35] op_sel_hi:[1,1,0] neg_lo:[1,0,0] neg_hi:[1,0,0]
v_pk_fma_f32 v[48:49], v[48:49], s[94:95], v[66:67] op_sel_hi:[1,1,0] neg_lo:[1,0,0] neg_hi:[1,0,0]
v_pk_fma_f32 v[26:27], v[18:19], s[94:95], v[32:33] op_sel_hi:[1,1,0] neg_lo:[0,0,1] neg_hi:[0,0,1]
v_pk_fma_f32 v[58:59], v[50:51], s[94:95], v[64:65] op_sel_hi:[1,1,0] neg_lo:[0,0,1] neg_hi:[0,0,1]
v_pk_fma_f32 v[18:19], v[18:19], s[94:95], v[34:35] op_sel_hi:[1,1,0] neg_lo:[1,0,0] neg_hi:[1,0,0]
v_pk_fma_f32 v[50:51], v[50:51], s[94:95], v[66:67] op_sel_hi:[1,1,0] neg_lo:[1,0,0] neg_hi:[1,0,0]
v_pk_fma_f32 v[28:29], v[20:21], s[94:95], v[32:33] op_sel_hi:[1,1,0] neg_lo:[0,0,1] neg_hi:[0,0,1]
v_pk_fma_f32 v[60:61], v[52:53], s[94:95], v[64:65] op_sel_hi:[1,1,0] neg_lo:[0,0,1] neg_hi:[0,0,1]
v_pk_fma_f32 v[20:21], v[20:21], s[94:95], v[34:35] op_sel_hi:[1,1,0] neg_lo:[1,0,0] neg_hi:[1,0,0]
v_pk_fma_f32 v[52:53], v[52:53], s[94:95], v[66:67] op_sel_hi:[1,1,0] neg_lo:[1,0,0] neg_hi:[1,0,0]
v_pk_fma_f32 v[30:31], v[22:23], s[94:95], v[32:33] op_sel_hi:[1,1,0] neg_lo:[0,0,1] neg_hi:[0,0,1]
v_pk_fma_f32 v[62:63], v[54:55], s[94:95], v[64:65] op_sel_hi:[1,1,0] neg_lo:[0,0,1] neg_hi:[0,0,1]
v_pk_fma_f32 v[22:23], v[22:23], s[94:95], v[34:35] op_sel_hi:[1,1,0] neg_lo:[1,0,0] neg_hi:[1,0,0]
v_pk_fma_f32 v[54:55], v[54:55], s[94:95], v[66:67] op_sel_hi:[1,1,0] neg_lo:[1,0,0] neg_hi:[1,0,0]
v_exp_f32 v24, v24
v_exp_f32 v56, v56
v_exp_f32 v16, v16
v_exp_f32 v48, v48
v_exp_f32 v25, v25
v_exp_f32 v57, v57
v_exp_f32 v17, v17
v_exp_f32 v49, v49
v_exp_f32 v26, v26
v_exp_f32 v58, v58
v_exp_f32 v18, v18
v_exp_f32 v50, v50
v_exp_f32 v27, v27
v_exp_f32 v59, v59
v_exp_f32 v19, v19
v_exp_f32 v51, v51
v_exp_f32 v28, v28
v_exp_f32 v60, v60
v_exp_f32 v20, v20
v_exp_f32 v52, v52
v_exp_f32 v29, v29
v_exp_f32 v61, v61
v_exp_f32 v21, v21
v_exp_f32 v53, v53
v_exp_f32 v30, v30
v_exp_f32 v62, v62
v_exp_f32 v22, v22
v_exp_f32 v54, v54
v_exp_f32 v31, v31
v_exp_f32 v63, v63
v_exp_f32 v23, v23
v_exp_f32 v55, v55
v_pk_add_f32 v[32:33], v[24:25], v[26:27]
v_pk_add_f32 v[64:65], v[56:57], v[58:59]
v_pk_add_f32 v[34:35], v[16:17], v[18:19]
v_pk_add_f32 v[66:67], v[48:49], v[50:51]
v_pk_add_f32 v[32:33], v[32:33], v[28:29]
v_pk_add_f32 v[64:65], v[64:65], v[60:61]
v_pk_add_f32 v[34:35], v[34:35], v[20:21]
v_pk_add_f32 v[66:67], v[66:67], v[52:53]
v_pk_add_f32 v[32:33], v[32:33], v[30:31]
v_pk_add_f32 v[64:65], v[64:65], v[62:63]
v_pk_add_f32 v[34:35], v[34:35], v[22:23]
v_pk_add_f32 v[66:67], v[66:67], v[54:55]
v_add_f32 v38, v32, v33
v_add_f32 v70, v64, v65
v_add_f32 v39, v34, v35
v_add_f32 v71, v66, v67
v_mov_b32 v36, v38
v_mov_b32 v68, v70
v_mov_b32 v37, v39
v_mov_b32 v69, v71
v_permlane16_swap_b32 v38, v36
v_permlane16_swap_b32 v70, v68
v_permlane16_swap_b32 v39, v37
v_permlane16_swap_b32 v71, v69
v_add_f32 v38, v38, v36
v_add_f32 v70, v70, v68
v_add_f32 v39, v39, v37
v_add_f32 v71, v71, v69
v_mov_b32 v36, v38
v_mov_b32 v68, v70
v_mov_b32 v37, v39
v_mov_b32 v69, v71
v_permlane32_swap_b32 v38, v36
v_permlane32_swap_b32 v70, v68
v_permlane32_swap_b32 v39, v37
v_permlane32_swap_b32 v71, v69
v_add_f32 v38, v38, v36
v_add_f32 v70, v70, v68
v_add_f32 v39, v39, v37
v_add_f32 v71, v71, v69
v_rcp_f32 v32, v38
v_rcp_f32 v64, v70
v_rcp_f32 v34, v39
v_rcp_f32 v66, v71
v_pk_mul_f32 v[24:25], v[24:25], v[32:33] op_sel_hi:[1,0]
v_pk_mul_f32 v[56:57], v[56:57], v[64:65] op_sel_hi:[1,0]
v_pk_mul_f32 v[16:17], v[16:17], v[34:35] op_sel_hi:[1,0]
v_pk_mul_f32 v[48:49], v[48:49], v[66:67] op_sel_hi:[1,0]
v_pk_mul_f32 v[26:27], v[26:27], v[32:33] op_sel_hi:[1,0]
v_pk_mul_f32 v[58:59], v[58:59], v[64:65] op_sel_hi:[1,0]
v_pk_mul_f32 v[18:19], v[18:19], v[34:35] op_sel_hi:[1,0]
v_pk_mul_f32 v[50:51], v[50:51], v[66:67] op_sel_hi:[1,0]
v_pk_mul_f32 v[28:29], v[28:29], v[32:33] op_sel_hi:[1,0]
v_pk_mul_f32 v[60:61], v[60:61], v[64:65] op_sel_hi:[1,0]
v_pk_mul_f32 v[20:21], v[20:21], v[34:35] op_sel_hi:[1,0]
v_pk_mul_f32 v[52:53], v[52:53], v[66:67] op_sel_hi:[1,0]
v_pk_mul_f32 v[30:31], v[30:31], v[32:33] op_sel_hi:[1,0]
v_pk_mul_f32 v[62:63], v[62:63], v[64:65] op_sel_hi:[1,0]
v_pk_mul_f32 v[22:23], v[22:23], v[34:35] op_sel_hi:[1,0]
v_pk_mul_f32 v[54:55], v[54:55], v[66:67] op_sel_hi:[1,0]
v_cvt_pk_bf16_f32 v128, v24, v25
v_cvt_pk_bf16_f32 v136, v56, v57
v_cvt_pk_bf16_f32 v129, v26, v27
v_cvt_pk_bf16_f32 v137, v58, v59
v_cvt_pk_bf16_f32 v130, v28, v29
v_cvt_pk_bf16_f32 v138, v60, v61
v_cvt_pk_bf16_f32 v131, v30, v31
v_cvt_pk_bf16_f32 v139, v62, v63
v_cvt_pk_bf16_f32 v132, v16, v17
v_cvt_pk_bf16_f32 v140, v48, v49
v_cvt_pk_bf16_f32 v133, v18, v19
v_cvt_pk_bf16_f32 v141, v50, v51
v_cvt_pk_bf16_f32 v134, v20, v21
v_cvt_pk_bf16_f32 v142, v52, v53
v_cvt_pk_bf16_f32 v135, v22, v23
v_cvt_pk_bf16_f32 v143, v54, v55
s_cmp_lg_u32 s7, 0
s_cbranch_scc1 h_a_skip
s_lshl_b32 s70, s5, 7
v_lshlrev_b32 v22, 3, v1
v_add_u32 v22, 0, v22
s_mov_b64 exec, 0xffff
s_mov_b32 s80, 0
poll7:
buffer_load_dwordx2 v[20:21], v22, s[56:59], s70 offen sc1
s_waitcnt vmcnt(0)
v_cmp_ne_u32 vcc, s28, v20
v_cmp_ne_u32 s[78:79], s29, v21
s_nop 3
s_or_b64 s[78:79], vcc, s[78:79]
s_cmp_eq_u64 s[78:79], 0
s_cbranch_scc1 poll7_ok
s_sleep 2
s_add_u32 s80, s80, 1
s_cmp_lt_u32 s80, 0x40000
s_cbranch_scc1 poll7
poll7_ok:
s_mov_b64 exec, -1
h_a_skip:
s_barrier
s_add_u32 s40, s8, 0x400000
s_addc_u32 s41, s9, 0
s_mov_b32 s42, 0x200000
s_mov_b32 s43, 0x20000
v_lshlrev_b32 v8, 4, v1
s_lshl_b32 s70, s5, 17
s_lshl_b32 s71, s3, 10
s_add_u32 s70, s70, s71
buffer_load_dwordx4 v[32:35], v8, s[40:43], s70 offen sc1
s_add_u32 s70, s70, 8192
buffer_load_dwordx4 v[36:39], v8, s[40:43], s70 offen sc1
s_add_u32 s70, s70, 8192
buffer_load_dwordx4 v[40:43], v8, s[40:43], s70 offen sc1
s_add_u32 s70, s70, 8192
buffer_load_dwordx4 v[44:47], v8, s[40:43], s70 offen sc1
s_add_u32 s70, s70, 8192
buffer_load_dwordx4 v[48:51], v8, s[40:43], s70 offen sc1
s_add_u32 s70, s70, 8192
buffer_load_dwordx4 v[52:55], v8, s[40:43], s70 offen sc1
s_add_u32 s70, s70, 8192
buffer_load_dwordx4 v[56:59], v8, s[40:43], s70 offen sc1
s_add_u32 s70, s70, 8192
buffer_load_dwordx4 v[60:63], v8, s[40:43], s70 offen sc1
s_add_u32 s70, s70, 8192
buffer_load_dwordx4 v[64:67], v8, s[40:43], s70 offen sc1
s_add_u32 s70, s70, 8192
buffer_load_dwordx4 v[68:71], v8, s[40:43], s70 offen sc1
s_add_u32 s70, s70, 8192
buffer_load_dwordx4 v[72:75], v8, s[40:43], s70 offen sc1
s_add_u32 s70, s70, 8192
buffer_load_dwordx4 v[76:79], v8, s[40:43], s70 offen sc1
s_add_u32 s70, s70, 8192
buffer_load_dwordx4 v[80:83], v8, s[40:43], s70 offen sc1
s_add_u32 s70, s70, 8192
buffer_load_dwordx4 v[84:87], v8, s[40:43], s70 offen sc1
s_add_u32 s70, s70, 8192
buffer_load_dwordx4 v[88:91], v8, s[40:43], s70 offen sc1
s_add_u32 s70, s70, 8192
buffer_load_dwordx4 v[92:95], v8, s[40:43], s70 offen sc1
s_add_u32 s44, s8, 0x700000
s_addc_u32 s45, s9, 0
s_mov_b32 s46, 0x20000
s_mov_b32 s47, 0x20000
v_lshlrev_b32 v9, 2, v1
s_lshl_b32 s72, s5, 13
s_sub_u32 s73, s3, 6
s_lshl_b32 s73, s73, 8
s_add_u32 s72, s72, s73
buffer_load_dword v96, v9, s[44:47], s72 offen sc1
s_add_u32 s72, s72, 512
buffer_load_dword v97, v9, s[44:47], s72 offen sc1
s_add_u32 s72, s72, 512
buffer_load_dword v98, v9, s[44:47], s72 offen sc1
s_add_u32 s72, s72, 512
buffer_load_dword v99, v9, s[44:47], s72 offen sc1
s_add_u32 s72, s72, 512
buffer_load_dword v100, v9, s[44:47], s72 offen sc1
s_add_u32 s72, s72, 512
buffer_load_dword v101, v9, s[44:47], s72 offen sc1
s_add_u32 s72, s72, 512
buffer_load_dword v102, v9, s[44:47], s72 offen sc1
s_add_u32 s72, s72, 512
buffer_load_dword v103, v9, s[44:47], s72 offen sc1
s_add_u32 s72, s72, 512
buffer_load_dword v104, v9, s[44:47], s72 offen sc1
s_add_u32 s72, s72, 512
buffer_load_dword v105, v9, s[44:47], s72 offen sc1
s_add_u32 s72, s72, 512
buffer_load_dword v106, v9, s[44:47], s72 offen sc1
s_add_u32 s72, s72, 512
buffer_load_dword v107, v9, s[44:47], s72 offen sc1
s_add_u32 s72, s72, 512
buffer_load_dword v108, v9, s[44:47], s72 offen sc1
s_add_u32 s72, s72, 512
buffer_load_dword v109, v9, s[44:47], s72 offen sc1
s_add_u32 s72, s72, 512
buffer_load_dword v110, v9, s[44:47], s72 offen sc1
s_add_u32 s72, s72, 512
buffer_load_dword v111, v9, s[44:47], s72 offen sc1
s_mov_b32 s74, 0x00003f80
s_mov_b32 s75, 0x3f800000
v_mov_b32 v16, 0
v_mov_b32 v17, 0
v_mov_b32 v18, 0
v_mov_b32 v19, 0
v_mov_b32 v20, 0
v_mov_b32 v21, 0
v_mov_b32 v22, 0
v_mov_b32 v23, 0
v_mov_b32 v24, s74
v_mov_b32 v25, s75
s_waitcnt vmcnt(16)
v_dot2c_f32_bf16 v16, v32, v24
v_dot2c_f32_bf16 v17, v32, v25
v_dot2c_f32_bf16 v18, v33, v24
v_dot2c_f32_bf16 v19, v33, v25
v_dot2c_f32_bf16 v20, v34, v24
v_dot2c_f32_bf16 v21, v34, v25
v_dot2c_f32_bf16 v22, v35, v24
v_dot2c_f32_bf16 v23, v35, v25
v_dot2c_f32_bf16 v16, v36, v24
v_dot2c_f32_bf16 v17, v36, v25
v_dot2c_f32_bf16 v18, v37, v24
v_dot2c_f32_bf16 v19, v37, v25
v_dot2c_f32_bf16 v20, v38, v24
v_dot2c_f32_bf16 v21, v38, v25
v_dot2c_f32_bf16 v22, v39, v24
v_dot2c_f32_bf16 v23, v39, v25
v_dot2c_f32_bf16 v16, v40, v24
v_dot2c_f32_bf16 v17, v40, v25
v_dot2c_f32_bf16 v18, v41, v24
v_dot2c_f32_bf16 v19, v41, v25
v_dot2c_f32_bf16 v20, v42, v24
v_dot2c_f32_bf16 v21, v42, v25
v_dot2c_f32_bf16 v22, v43, v24
v_dot2c_f32_bf16 v23, v43, v25
v_dot2c_f32_bf16 v16, v44, v24
v_dot2c_f32_bf16 v17, v44, v25
v_dot2c_f32_bf16 v18, v45, v24
v_dot2c_f32_bf16 v19, v45, v25
v_dot2c_f32_bf16 v20, v46, v24
v_dot2c_f32_bf16 v21, v46, v25
v_dot2c_f32_bf16 v22, v47, v24
v_dot2c_f32_bf16 v23, v47, v25
v_dot2c_f32_bf16 v16, v48, v24
v_dot2c_f32_bf16 v17, v48, v25
v_dot2c_f32_bf16 v18, v49, v24
v_dot2c_f32_bf16 v19, v49, v25
v_dot2c_f32_bf16 v20, v50, v24
v_dot2c_f32_bf16 v21, v50, v25
v_dot2c_f32_bf16 v22, v51, v24
v_dot2c_f32_bf16 v23, v51, v25
v_dot2c_f32_bf16 v16, v52, v24
v_dot2c_f32_bf16 v17, v52, v25
v_dot2c_f32_bf16 v18, v53, v24
v_dot2c_f32_bf16 v19, v53, v25
v_dot2c_f32_bf16 v20, v54, v24
v_dot2c_f32_bf16 v21, v54, v25
v_dot2c_f32_bf16 v22, v55, v24
v_dot2c_f32_bf16 v23, v55, v25
v_dot2c_f32_bf16 v16, v56, v24
v_dot2c_f32_bf16 v17, v56, v25
v_dot2c_f32_bf16 v18, v57, v24
v_dot2c_f32_bf16 v19, v57, v25
v_dot2c_f32_bf16 v20, v58, v24
v_dot2c_f32_bf16 v21, v58, v25
v_dot2c_f32_bf16 v22, v59, v24
v_dot2c_f32_bf16 v23, v59, v25
v_dot2c_f32_bf16 v16, v60, v24
v_dot2c_f32_bf16 v17, v60, v25
v_dot2c_f32_bf16 v18, v61, v24
v_dot2c_f32_bf16 v19, v61, v25
v_dot2c_f32_bf16 v20, v62, v24
v_dot2c_f32_bf16 v21, v62, v25
v_dot2c_f32_bf16 v22, v63, v24
v_dot2c_f32_bf16 v23, v63, v25
v_dot2c_f32_bf16 v16, v64, v24
v_dot2c_f32_bf16 v17, v64, v25
v_dot2c_f32_bf16 v18, v65, v24
v_dot2c_f32_bf16 v19, v65, v25
v_dot2c_f32_bf16 v20, v66, v24
v_dot2c_f32_bf16 v21, v66, v25
v_dot2c_f32_bf16 v22, v67, v24
v_dot2c_f32_bf16 v23, v67, v25
v_dot2c_f32_bf16 v16, v68, v24
v_dot2c_f32_bf16 v17, v68, v25
v_dot2c_f32_bf16 v18, v69, v24
v_dot2c_f32_bf16 v19, v69, v25
v_dot2c_f32_bf16 v20, v70, v24
v_dot2c_f32_bf16 v21, v70, v25
v_dot2c_f32_bf16 v22, v71, v24
v_dot2c_f32_bf16 v23, v71, v25
v_dot2c_f32_bf16 v16, v72, v24
v_dot2c_f32_bf16 v17, v72, v25
v_dot2c_f32_bf16 v18, v73, v24
v_dot2c_f32_bf16 v19, v73, v25
v_dot2c_f32_bf16 v20, v74, v24
v_dot2c_f32_bf16 v21, v74, v25
v_dot2c_f32_bf16 v22, v75, v24
v_dot2c_f32_bf16 v23, v75, v25
v_dot2c_f32_bf16 v16, v76, v24
v_dot2c_f32_bf16 v17, v76, v25
v_dot2c_f32_bf16 v18, v77, v24
v_dot2c_f32_bf16 v19, v77, v25
v_dot2c_f32_bf16 v20, v78, v24
v_dot2c_f32_bf16 v21, v78, v25
v_dot2c_f32_bf16 v22, v79, v24
v_dot2c_f32_bf16 v23, v79, v25
v_dot2c_f32_bf16 v16, v80, v24
v_dot2c_f32_bf16 v17, v80, v25
v_dot2c_f32_bf16 v18, v81, v24
v_dot2c_f32_bf16 v19, v81, v25
v_dot2c_f32_bf16 v20, v82, v24
v_dot2c_f32_bf16 v21, v82, v25
v_dot2c_f32_bf16 v22, v83, v24
v_dot2c_f32_bf16 v23, v83, v25
v_dot2c_f32_bf16 v16, v84, v24
v_dot2c_f32_bf16 v17, v84, v25
v_dot2c_f32_bf16 v18, v85, v24
v_dot2c_f32_bf16 v19, v85, v25
v_dot2c_f32_bf16 v20, v86, v24
v_dot2c_f32_bf16 v21, v86, v25
v_dot2c_f32_bf16 v22, v87, v24
v_dot2c_f32_bf16 v23, v87, v25
v_dot2c_f32_bf16 v16, v88, v24
v_dot2c_f32_bf16 v17, v88, v25
v_dot2c_f32_bf16 v18, v89, v24
v_dot2c_f32_bf16 v19, v89, v25
v_dot2c_f32_bf16 v20, v90, v24
v_dot2c_f32_bf16 v21, v90, v25
v_dot2c_f32_bf16 v22, v91, v24
v_dot2c_f32_bf16 v23, v91, v25
v_dot2c_f32_bf16 v16, v92, v24
v_dot2c_f32_bf16 v17, v92, v25
v_dot2c_f32_bf16 v18, v93, v24
v_dot2c_f32_bf16 v19, v93, v25
v_dot2c_f32_bf16 v20, v94, v24
v_dot2c_f32_bf16 v21, v94, v25
v_dot2c_f32_bf16 v22, v95, v24
v_dot2c_f32_bf16 v23, v95, v25
v_cvt_pk_bf16_f32 v28, v16, v17
v_cvt_pk_bf16_f32 v29, v18, v19
v_cvt_pk_bf16_f32 v30, v20, v21
v_cvt_pk_bf16_f32 v31, v22, v23
s_lshl_b32 s71, s3, 10
s_add_u32 s71, s71, 126976
v_add_u32 v8, s71, v8
ds_write_b128 v8, v[28:31]
s_waitcnt vmcnt(0)
v_add_f32 v96, v96, v97
v_add_f32 v96, v96, v98
v_add_f32 v96, v96, v99
v_add_f32 v96, v96, v100
v_add_f32 v96, v96, v101
v_add_f32 v96, v96, v102
v_add_f32 v96, v96, v103
v_add_f32 v96, v96, v104
v_add_f32 v96, v96, v105
v_add_f32 v96, v96, v106
v_add_f32 v96, v96, v107
v_add_f32 v96, v96, v108
v_add_f32 v96, v96, v109
v_add_f32 v96, v96, v110
v_add_f32 v96, v96, v111
v_cvt_pk_bf16_f32 v96, v96, v96
v_lshlrev_b32 v9, 1, v1
s_sub_u32 s73, s3, 6
s_lshl_b32 s73, s73, 7
s_add_u32 s73, s73, 135168
v_add_u32 v9, s73, v9
ds_write_b16 v9, v96
s_waitcnt lgkmcnt(0)
s_barrier
s_add_u32 s48, s8, 0x800000
s_addc_u32 s49, s9, 0
s_mov_b32 s50, 0x400000
s_mov_b32 s51, 0x20000
v_lshrrev_b32 v11, 4, v1
v_lshlrev_b32 v12, 4, v1
s_lshl_b32 s70, s93, 12
s_add_u32 s70, s70, 126976
v_add_u32 v13, s70, v12
ds_read_b128 v[112:115], v13 offset:0
ds_read_b128 v[116:119], v13 offset:1024
ds_read_b128 v[120:123], v13 offset:2048
ds_read_b128 v[124:127], v13 offset:3072
s_lshl_b32 s70, s93, 7
s_add_u32 s70, s70, 135168
v_lshlrev_b32 v14, 4, v11
v_add_u32 v14, s70, v14
ds_read_b128 v[160:163], v14 offset:0
ds_read_b128 v[164:167], v14 offset:64
s_lshl_b32 s70, s4, 2
s_lshl_b32 s71, s92, 1
s_add_u32 s70, s70, s71
s_add_u32 s70, s70, 1
s_lshl_b32 s70, s70, 7
s_lshl_b32 s71, s5, 3
s_add_u32 s70, s70, s71
s_lshl_b32 s71, s93, 2
s_add_u32 s70, s70, s71
s_lshl_b32 s70, s70, 9
s_lshl_b32 s88, s4, 7
s_lshl_b32 s71, s5, 3
s_add_u32 s88, s88, s71
s_waitcnt lgkmcnt(0)
v_mfma_f32_16x16x32_bf16 v[48:51], v[160:163], v[128:131], 0
v_mfma_f32_16x16x32_bf16 v[48:51], v[164:167], v[132:135], v[48:51]
v_mfma_f32_16x16x32_bf16 v[52:55], v[160:163], v[136:139], 0
v_mfma_f32_16x16x32_bf16 v[52:55], v[164:167], v[140:143], v[52:55]
v_mfma_f32_16x16x32_bf16 v[16:19], v[112:115], v[128:131], 0
v_mfma_f32_16x16x32_bf16 v[16:19], v[120:123], v[132:135], v[16:19]
v_mfma_f32_16x16x32_bf16 v[20:23], v[116:119], v[128:131], 0
v_mfma_f32_16x16x32_bf16 v[20:23], v[124:127], v[132:135], v[20:23]
v_mfma_f32_16x16x32_bf16 v[24:27], v[112:115], v[136:139], 0
v_mfma_f32_16x16x32_bf16 v[24:27], v[120:123], v[140:143], v[24:27]
v_mfma_f32_16x16x32_bf16 v[28:31], v[116:119], v[136:139], 0
v_mfma_f32_16x16x32_bf16 v[28:31], v[124:127], v[140:143], v[28:31]
v_add_f32 v64, 0x358637bd, v48
v_add_f32 v66, 0x358637bd, v52
v_rcp_f32 v64, v64
v_rcp_f32 v66, v66
v_pk_mul_f32 v[16:17], v[16:17], v[64:65] op_sel_hi:[1,0]
v_pk_mul_f32 v[18:19], v[18:19], v[64:65] op_sel_hi:[1,0]
v_pk_mul_f32 v[20:21], v[20:21], v[64:65] op_sel_hi:[1,0]
v_pk_mul_f32 v[22:23], v[22:23], v[64:65] op_sel_hi:[1,0]
v_pk_mul_f32 v[24:25], v[24:25], v[66:67] op_sel_hi:[1,0]
v_pk_mul_f32 v[26:27], v[26:27], v[66:67] op_sel_hi:[1,0]
v_pk_mul_f32 v[28:29], v[28:29], v[66:67] op_sel_hi:[1,0]
v_pk_mul_f32 v[30:31], v[30:31], v[66:67] op_sel_hi:[1,0]
v_cvt_pk_bf16_f32 v72, v16, v17
v_cvt_pk_bf16_f32 v73, v18, v19
v_cvt_pk_bf16_f32 v74, v24, v25
v_cvt_pk_bf16_f32 v75, v26, v27
s_nop 0
v_permlane16_swap_b32 v72, v74
v_permlane16_swap_b32 v73, v75
buffer_store_dwordx4 v[72:75], v12, s[48:51], s70 offen offset:0 sc1
v_cvt_pk_bf16_f32 v76, v20, v21
v_cvt_pk_bf16_f32 v77, v22, v23
v_cvt_pk_bf16_f32 v78, v28, v29
v_cvt_pk_bf16_f32 v79, v30, v31
s_nop 0
v_permlane16_swap_b32 v76, v78
v_permlane16_swap_b32 v77, v79
buffer_store_dwordx4 v[76:79], v12, s[48:51], s70 offen offset:1024 sc1
s_barrier
s_waitcnt vmcnt(0)
v_mov_b32 v8, 163796
v_mov_b32 v9, 1
s_mov_b64 exec, 1
ds_add_rtn_u32 v9, v8, v9
s_waitcnt lgkmcnt(0)
s_nop 1
v_readfirstlane_b32 s72, v9
s_mov_b64 exec, -1
s_nop 2
s_cmp_lg_u32 s72, 7
s_cbranch_scc1 pub8
s_add_u32 s56, s8, 0x1200000
s_addc_u32 s57, s9, 0
s_mov_b32 s58, 0x8000
s_mov_b32 s59, 0x20000
s_mov_b32 s71, s88
v_mov_b32 v8, s28
v_mov_b32 v9, s29
v_mov_b32 v10, 4096
s_mov_b64 exec, 1
buffer_store_dwordx2 v[8:9], v10, s[56:59], s71 offen sc1
s_mov_b64 exec, -1
pub8:
s_and_b32 s4, s30, 3
s_lshr_b32 s5, s30, 2
s_mul_i32 s4, s4, 4
s_mul_i32 s5, s5, 8
s_and_b32 s64, s31, 3
s_add_u32 s4, s4, s64
s_lshr_b32 s64, s31, 2
s_add_u32 s5, s5, s64
s_mov_b32 s81, 0
s_cmp_lg_u32 s7, 0
s_cbranch_scc1 h_b_0
s_lshl_b32 s70, s4, 7
s_mov_b32 s76, 0x3
s_mov_b32 s80, 0
v_lshlrev_b32 v22, 3, v1
v_add_u32 v22, 4096, v22
pm9:
s_and_b32 s77, s81, s76
s_cmp_eq_u32 s77, s76
s_cbranch_scc1 pm9_ok
s_mov_b64 exec, 0xffff
buffer_load_dwordx2 v[20:21], v22, s[56:59], s70 offen sc1
s_waitcnt vmcnt(0)
v_cmp_eq_u32 vcc, s28, v20
v_cmp_eq_u32 s[78:79], s29, v21
s_mov_b64 exec, -1
s_nop 2
s_and_b64 s[78:79], vcc, s[78:79]
s_mov_b32 s81, s78
s_add_u32 s80, s80, 1
s_cmp_lt_u32 s80, 0x40000
s_cbranch_scc1 pm9
pm9_ok:
h_b_0:
s_barrier
s_cmp_lg_u32 s7, 0
s_cbranch_scc1 h_b_1
s_lshl_b32 s70, s4, 7
s_mov_b32 s76, 0x1f
s_mov_b32 s80, 0
v_lshlrev_b32 v22, 3, v1
v_add_u32 v22, 4096, v22
pm10:
s_and_b32 s77, s81, s76
s_cmp_eq_u32 s77, s76
s_cbranch_scc1 pm10_ok
s_mov_b64 exec, 0xffff
buffer_load_dwordx2 v[20:21], v22, s[56:59], s70 offen sc1
s_waitcnt vmcnt(0)
v_cmp_eq_u32 vcc, s28, v20
v_cmp_eq_u32 s[78:79], s29, v21
s_mov_b64 exec, -1
s_nop 2
s_and_b64 s[78:79], vcc, s[78:79]
s_mov_b32 s81, s78
s_add_u32 s80, s80, 1
s_cmp_lt_u32 s80, 0x40000
s_cbranch_scc1 pm10
pm10_ok:
h_b_1:
s_barrier
s_cmp_lg_u32 s7, 0
s_cbranch_scc1 h_b_2
s_lshl_b32 s70, s4, 7
s_mov_b32 s76, 0xffff
s_mov_b32 s80, 0
v_lshlrev_b32 v22, 3, v1
v_add_u32 v22, 4096, v22
pm11:
s_and_b32 s77, s81, s76
s_cmp_eq_u32 s77, s76
s_cbranch_scc1 pm11_ok
s_mov_b64 exec, 0xffff
buffer_load_dwordx2 v[20:21], v22, s[56:59], s70 offen sc1
s_waitcnt vmcnt(0)
v_cmp_eq_u32 vcc, s28, v20
v_cmp_eq_u32 s[78:79], s29, v21
s_mov_b64 exec, -1
s_nop 2
s_and_b64 s[78:79], vcc, s[78:79]
s_mov_b32 s81, s78
s_add_u32 s80, s80, 1
s_cmp_lt_u32 s80, 0x40000
s_cbranch_scc1 pm11
pm11_ok:
h_b_2:
s_barrier
s_mov_b32 s65, 0
h3_loop:
s_barrier
s_add_u32 s65, s65, 1
s_cmp_lt_u32 s65, 15
s_cbranch_scc1 h3_loop
s_barrier
s_and_b32 s4, s30, 1
s_lshr_b32 s5, s30, 1
s_mul_i32 s4, s4, 8
s_mul_i32 s5, s5, 4
s_and_b32 s64, s31, 7
s_add_u32 s4, s4, s64
s_lshr_b32 s64, s31, 3
s_add_u32 s5, s5, s64
s_mov_b32 s81, 0
s_cmp_lg_u32 s7, 0
s_cbranch_scc1 h_c_0
s_lshl_b32 s70, s4, 7
s_lshl_b32 s76, 1, s4
s_or_b32 s76, s76, 0x3
s_mov_b32 s80, 0
v_lshlrev_b32 v22, 3, v1
v_add_u32 v22, 8192, v22
pm12:
s_and_b32 s77, s81, s76
s_cmp_eq_u32 s77, s76
s_cbranch_scc1 pm12_ok
s_mov_b64 exec, 0xffff
buffer_load_dwordx2 v[20:21], v22, s[56:59], s70 offen sc1
s_waitcnt vmcnt(0)
v_cmp_eq_u32 vcc, s28, v20
v_cmp_eq_u32 s[78:79], s29, v21
s_mov_b64 exec, -1
s_nop 2
s_and_b64 s[78:79], vcc, s[78:79]
s_mov_b32 s81, s78
s_add_u32 s80, s80, 1
s_cmp_lt_u32 s80, 0x40000
s_cbranch_scc1 pm12
pm12_ok:
h_c_0:
s_barrier
s_cmp_lg_u32 s7, 0
s_cbranch_scc1 h_c_1
s_lshl_b32 s70, s4, 7
s_lshl_b32 s76, 1, s4
s_or_b32 s76, s76, 0x7
s_mov_b32 s80, 0
v_lshlrev_b32 v22, 3, v1
v_add_u32 v22, 8192, v22
pm13:
s_and_b32 s77, s81, s76
s_cmp_eq_u32 s77, s76
s_cbranch_scc1 pm13_ok
s_mov_b64 exec, 0xffff
buffer_load_dwordx2 v[20:21], v22, s[56:59], s70 offen sc1
s_waitcnt vmcnt(0)
v_cmp_eq_u32 vcc, s28, v20
v_cmp_eq_u32 s[78:79], s29, v21
s_mov_b64 exec, -1
s_nop 2
s_and_b64 s[78:79], vcc, s[78:79]
s_mov_b32 s81, s78
s_add_u32 s80, s80, 1
s_cmp_lt_u32 s80, 0x40000
s_cbranch_scc1 pm13
pm13_ok:
h_c_1:
s_barrier
s_cmp_lg_u32 s7, 0
s_cbranch_scc1 h_c_2
s_lshl_b32 s70, s4, 7
s_mov_b32 s76, 0xffff
s_mov_b32 s80, 0
v_lshlrev_b32 v22, 3, v1
v_add_u32 v22, 8192, v22
pm14:
s_and_b32 s77, s81, s76
s_cmp_eq_u32 s77, s76
s_cbranch_scc1 pm14_ok
s_mov_b64 exec, 0xffff
buffer_load_dwordx2 v[20:21], v22, s[56:59], s70 offen sc1
s_waitcnt vmcnt(0)
v_cmp_eq_u32 vcc, s28, v20
v_cmp_eq_u32 s[78:79], s29, v21
s_mov_b64 exec, -1
s_nop 2
s_and_b64 s[78:79], vcc, s[78:79]
s_mov_b32 s81, s78
s_add_u32 s80, s80, 1
s_cmp_lt_u32 s80, 0x40000
s_cbranch_scc1 pm14
pm14_ok:
h_c_2:
s_barrier
s_add_u32 s40, s8, 0x1000000
s_addc_u32 s41, s9, 0
s_mov_b32 s42, 0x80000
s_mov_b32 s43, 0x20000
s_add_u32 s44, s8, 0x100000
s_addc_u32 s45, s9, 0
s_mov_b32 s46, 0x80000
s_mov_b32 s47, 0x20000
s_mov_b32 s48, s20
s_mov_b32 s49, s21
s_mov_b32 s50, 0x1c00
s_mov_b32 s51, 0x20000
v_lshlrev_b32 v16, 3, v1
s_lshl_b32 s70, s4, 7
s_lshl_b32 s71, s7, 6
s_add_u32 s70, s70, s71
s_lshl_b32 s70, s70, 3
buffer_load_dwordx2 v[32:33], v16, s[40:43], s70 offen sc1
s_add_u32 s70, s70, 16384
buffer_load_dwordx2 v[34:35], v16, s[40:43], s70 offen sc1
s_add_u32 s70, s70, 16384
buffer_load_dwordx2 v[36:37], v16, s[40:43], s70 offen sc1
s_add_u32 s70, s70, 16384
buffer_load_dwordx2 v[38:39], v16, s[40:43], s70 offen sc1
s_add_u32 s70, s70, 16384
buffer_load_dwordx2 v[40:41], v16, s[40:43], s70 offen sc1
s_add_u32 s70, s70, 16384
buffer_load_dwordx2 v[42:43], v16, s[40:43], s70 offen sc1
s_add_u32 s70, s70, 16384
buffer_load_dwordx2 v[44:45], v16, s[40:43], s70 offen sc1
s_add_u32 s70, s70, 16384
buffer_load_dwordx2 v[46:47], v16, s[40:43], s70 offen sc1
s_add_u32 s70, s70, 16384
buffer_load_dwordx2 v[48:49], v16, s[40:43], s70 offen sc1
s_add_u32 s70, s70, 16384
buffer_load_dwordx2 v[50:51], v16, s[40:43], s70 offen sc1
s_add_u32 s70, s70, 16384
buffer_load_dwordx2 v[52:53], v16, s[40:43], s70 offen sc1
s_add_u32 s70, s70, 16384
buffer_load_dwordx2 v[54:55], v16, s[40:43], s70 offen sc1
s_add_u32 s70, s70, 16384
buffer_load_dwordx2 v[56:57], v16, s[40:43], s70 offen sc1
s_add_u32 s70, s70, 16384
buffer_load_dwordx2 v[58:59], v16, s[40:43], s70 offen sc1
s_add_u32 s70, s70, 16384
buffer_load_dwordx2 v[60:61], v16, s[40:43], s70 offen sc1
s_add_u32 s70, s70, 16384
buffer_load_dwordx2 v[62:63], v16, s[40:43], s70 offen sc1
s_add_u32 s70, s70, 16384
buffer_load_dwordx2 v[64:65], v16, s[40:43], s70 offen sc1
s_add_u32 s70, s70, 16384
buffer_load_dwordx2 v[66:67], v16, s[40:43], s70 offen sc1
s_add_u32 s70, s70, 16384
buffer_load_dwordx2 v[68:69], v16, s[40:43], s70 offen sc1
s_add_u32 s70, s70, 16384
buffer_load_dwordx2 v[70:71], v16, s[40:43], s70 offen sc1
s_add_u32 s70, s70, 16384
buffer_load_dwordx2 v[72:73], v16, s[40:43], s70 offen sc1
s_add_u32 s70, s70, 16384
buffer_load_dwordx2 v[74:75], v16, s[40:43], s70 offen sc1
s_add_u32 s70, s70, 16384
buffer_load_dwordx2 v[76:77], v16, s[40:43], s70 offen sc1
s_add_u32 s70, s70, 16384
buffer_load_dwordx2 v[78:79], v16, s[40:43], s70 offen sc1
s_add_u32 s70, s70, 16384
buffer_load_dwordx2 v[80:81], v16, s[40:43], s70 offen sc1
s_add_u32 s70, s70, 16384
buffer_load_dwordx2 v[82:83], v16, s[40:43], s70 offen sc1
s_add_u32 s70, s70, 16384
buffer_load_dwordx2 v[84:85], v16, s[40:43], s70 offen sc1
s_add_u32 s70, s70, 16384
buffer_load_dwordx2 v[86:87], v16, s[40:43], s70 offen sc1
s_add_u32 s70, s70, 16384
buffer_load_dwordx2 v[88:89], v16, s[40:43], s70 offen sc1
s_add_u32 s70, s70, 16384
buffer_load_dwordx2 v[90:91], v16, s[40:43], s70 offen sc1
s_add_u32 s70, s70, 16384
buffer_load_dwordx2 v[92:93], v16, s[40:43], s70 offen sc1
s_add_u32 s70, s70, 16384
buffer_load_dwordx2 v[94:95], v16, s[40:43], s70 offen sc1
v_lshlrev_b32 v17, 2, v1
s_mul_i32 s72, s5, 448
s_mul_i32 s73, s7, 224
s_add_u32 s72, s72, s73
buffer_load_dword v100, v17, s[48:51], s72 offen
s_barrier
v_mul_u32_u24 v19, 12, v1
s_mul_i32 s70, s7, 448
s_add_u32 s70, s70, 138240
v_add_u32 v19, s70, v19
ds_read_b32 v24, v19 offset:0
ds_read_b32 v25, v19 offset:4
ds_read_b32 v26, v19 offset:8
v_mov_b32 v27, s28
v_lshlrev_b32 v18, 4, v1
s_lshl_b32 s70, s4, 4
s_add_u32 s70, s70, s5
s_lshl_b32 s70, s70, 1
s_add_u32 s70, s70, s7
s_lshl_b32 s70, s70, 10
s_waitcnt lgkmcnt(0)
buffer_store_dwordx4 v[24:27], v18, s[44:47], s70 offen sc1
s_barrier
s_barrier
s_barrier
s_barrier
s_waitcnt vmcnt(1)
v_pk_add_f32 v[32:33], v[32:33], v[34:35]
v_pk_add_f32 v[32:33], v[32:33], v[36:37]
v_pk_add_f32 v[32:33], v[32:33], v[38:39]
v_pk_add_f32 v[32:33], v[32:33], v[40:41]
v_pk_add_f32 v[32:33], v[32:33], v[42:43]
v_pk_add_f32 v[32:33], v[32:33], v[44:45]
v_pk_add_f32 v[32:33], v[32:33], v[46:47]
v_pk_add_f32 v[32:33], v[32:33], v[48:49]
v_pk_add_f32 v[32:33], v[32:33], v[50:51]
v_pk_add_f32 v[32:33], v[32:33], v[52:53]
v_pk_add_f32 v[32:33], v[32:33], v[54:55]
v_pk_add_f32 v[32:33], v[32:33], v[56:57]
v_pk_add_f32 v[32:33], v[32:33], v[58:59]
v_pk_add_f32 v[32:33], v[32:33], v[60:61]
v_pk_add_f32 v[32:33], v[32:33], v[62:63]
v_pk_add_f32 v[32:33], v[32:33], v[64:65]
v_pk_add_f32 v[32:33], v[32:33], v[66:67]
v_pk_add_f32 v[32:33], v[32:33], v[68:69]
v_pk_add_f32 v[32:33], v[32:33], v[70:71]
v_pk_add_f32 v[32:33], v[32:33], v[72:73]
v_pk_add_f32 v[32:33], v[32:33], v[74:75]
v_pk_add_f32 v[32:33], v[32:33], v[76:77]
v_pk_add_f32 v[32:33], v[32:33], v[78:79]
v_pk_add_f32 v[32:33], v[32:33], v[80:81]
v_pk_add_f32 v[32:33], v[32:33], v[82:83]
v_pk_add_f32 v[32:33], v[32:33], v[84:85]
v_pk_add_f32 v[32:33], v[32:33], v[86:87]
v_pk_add_f32 v[32:33], v[32:33], v[88:89]
v_pk_add_f32 v[32:33], v[32:33], v[90:91]
v_pk_add_f32 v[32:33], v[32:33], v[92:93]
v_pk_add_f32 v[32:33], v[32:33], v[94:95]
s_barrier
v_mul_f32 v32, 0x3a800000, v32
v_mul_f32 v33, 0x3a800000, v33
v_fma_f32 v33, -v32, v32, v33
v_max_f32 v33, 0, v33
v_add_f32 v33, 0x3727c5ac, v33
v_rsq_f32 v34, v33
s_nop 0
v_mul_f32 v35, v32, v34
v_sub_f32 v35, 0, v35
s_lshl_b32 s70, s7, 9
s_add_u32 s70, s70, 137216
v_add_u32 v20, s70, v16
ds_write_b64 v20, v[34:35]
v_lshlrev_b32 v102, 16, v100
v_and_b32 v103, 0xffff0000, v100
s_mul_i32 s70, s7, 448
s_add_u32 s70, s70, 136192
v_add_u32 v20, s70, v16
s_mov_b32 exec_lo, -1
s_mov_b32 exec_hi, 0x00ffffff
ds_write_b64 v20, v[102:103]
s_mov_b64 exec, -1
s_barrier
s_lshl_b32 s70, s5, 1
s_add_u32 s70, s70, s7
s_lshl_b32 s70, s70, 10
s_add_u32 s70, s70, 0
buffer_load_dwordx4 v[32:35], v18, s[44:47], s70 offen sc1
s_lshl_b32 s70, s5, 1
s_add_u32 s70, s70, s7
s_lshl_b32 s70, s70, 10
s_add_u32 s70, s70, 32768
buffer_load_dwordx4 v[36:39], v18, s[44:47], s70 offen sc1
s_lshl_b32 s70, s5, 1
s_add_u32 s70, s70, s7
s_lshl_b32 s70, s70, 10
s_add_u32 s70, s70, 65536
buffer_load_dwordx4 v[40:43], v18, s[44:47], s70 offen sc1
s_lshl_b32 s70, s5, 1
s_add_u32 s70, s70, s7
s_lshl_b32 s70, s70, 10
s_add_u32 s70, s70, 98304
buffer_load_dwordx4 v[44:47], v18, s[44:47], s70 offen sc1
s_lshl_b32 s70, s5, 1
s_add_u32 s70, s70, s7
s_lshl_b32 s70, s70, 10
s_add_u32 s70, s70, 131072
buffer_load_dwordx4 v[48:51], v18, s[44:47], s70 offen sc1
s_lshl_b32 s70, s5, 1
s_add_u32 s70, s70, s7
s_lshl_b32 s70, s70, 10
s_add_u32 s70, s70, 163840
buffer_load_dwordx4 v[52:55], v18, s[44:47], s70 offen sc1
s_lshl_b32 s70, s5, 1
s_add_u32 s70, s70, s7
s_lshl_b32 s70, s70, 10
s_add_u32 s70, s70, 196608
buffer_load_dwordx4 v[56:59], v18, s[44:47], s70 offen sc1
s_lshl_b32 s70, s5, 1
s_add_u32 s70, s70, s7
s_lshl_b32 s70, s70, 10
s_add_u32 s70, s70, 229376
buffer_load_dwordx4 v[60:63], v18, s[44:47], s70 offen sc1
s_lshl_b32 s70, s5, 1
s_add_u32 s70, s70, s7
s_lshl_b32 s70, s70, 10
s_add_u32 s70, s70, 262144
buffer_load_dwordx4 v[64:67], v18, s[44:47], s70 offen sc1
s_lshl_b32 s70, s5, 1
s_add_u32 s70, s70, s7
s_lshl_b32 s70, s70, 10
s_add_u32 s70, s70, 294912
buffer_load_dwordx4 v[68:71], v18, s[44:47], s70 offen sc1
s_lshl_b32 s70, s5, 1
s_add_u32 s70, s70, s7
s_lshl_b32 s70, s70, 10
s_add_u32 s70, s70, 327680
buffer_load_dwordx4 v[72:75], v18, s[44:47], s70 offen sc1
s_lshl_b32 s70, s5, 1
s_add_u32 s70, s70, s7
s_lshl_b32 s70, s70, 10
s_add_u32 s70, s70, 360448
buffer_load_dwordx4 v[76:79], v18, s[44:47], s70 offen sc1
s_lshl_b32 s70, s5, 1
s_add_u32 s70, s70, s7
s_lshl_b32 s70, s70, 10
s_add_u32 s70, s70, 393216
buffer_load_dwordx4 v[80:83], v18, s[44:47], s70 offen sc1
s_lshl_b32 s70, s5, 1
s_add_u32 s70, s70, s7
s_lshl_b32 s70, s70, 10
s_add_u32 s70, s70, 425984
buffer_load_dwordx4 v[84:87], v18, s[44:47], s70 offen sc1
s_lshl_b32 s70, s5, 1
s_add_u32 s70, s70, s7
s_lshl_b32 s70, s70, 10
s_add_u32 s70, s70, 458752
buffer_load_dwordx4 v[88:91], v18, s[44:47], s70 offen sc1
s_lshl_b32 s70, s5, 1
s_add_u32 s70, s70, s7
s_lshl_b32 s70, s70, 10
s_add_u32 s70, s70, 491520
buffer_load_dwordx4 v[92:95], v18, s[44:47], s70 offen sc1
s_barrier
s_barrier
s_barrier
s_barrier
s_mov_b32 s80, 0
cs4_retry:
s_waitcnt vmcnt(0)
v_min3_u32 v160, v35, v39, v43
v_max3_u32 v161, v35, v39, v43
v_min3_u32 v160, v160, v47, v51
v_max3_u32 v161, v161, v47, v51
v_min3_u32 v160, v160, v55, v59
v_max3_u32 v161, v161, v55, v59
v_min3_u32 v160, v160, v63, v67
v_max3_u32 v161, v161, v63, v67
v_min3_u32 v160, v160, v71, v75
v_max3_u32 v161, v161, v71, v75
v_min3_u32 v160, v160, v79, v83
v_max3_u32 v161, v161, v79, v83
v_min3_u32 v160, v160, v87, v91
v_max3_u32 v161, v161, v87, v91
v_min3_u32 v160, v160, v95, v95
v_max3_u32 v161, v161, v95, v95
v_cmp_ne_u32 vcc, s28, v160
v_cmp_ne_u32 s[78:79], s28, v161
s_nop 3
s_or_b64 s[78:79], vcc, s[78:79]
s_cmp_eq_u64 s[78:79], 0
s_cbranch_scc1 cs4_ok
s_lshl_b32 s70, s5, 1
s_add_u32 s70, s70, s7
s_lshl_b32 s70, s70, 10
s_add_u32 s70, s70, 0
buffer_load_dwordx4 v[32:35], v18, s[44:47], s70 offen sc1
s_lshl_b32 s70, s5, 1
s_add_u32 s70, s70, s7
s_lshl_b32 s70, s70, 10
s_add_u32 s70, s70, 32768
buffer_load_dwordx4 v[36:39], v18, s[44:47], s70 offen sc1
s_lshl_b32 s70, s5, 1
s_add_u32 s70, s70, s7
s_lshl_b32 s70, s70, 10
s_add_u32 s70, s70, 65536
buffer_load_dwordx4 v[40:43], v18, s[44:47], s70 offen sc1
s_lshl_b32 s70, s5, 1
s_add_u32 s70, s70, s7
s_lshl_b32 s70, s70, 10
s_add_u32 s70, s70, 98304
buffer_load_dwordx4 v[44:47], v18, s[44:47], s70 offen sc1
s_lshl_b32 s70, s5, 1
s_add_u32 s70, s70, s7
s_lshl_b32 s70, s70, 10
s_add_u32 s70, s70, 131072
buffer_load_dwordx4 v[48:51], v18, s[44:47], s70 offen sc1
s_lshl_b32 s70, s5, 1
s_add_u32 s70, s70, s7
s_lshl_b32 s70, s70, 10
s_add_u32 s70, s70, 163840
buffer_load_dwordx4 v[52:55], v18, s[44:47], s70 offen sc1
s_lshl_b32 s70, s5, 1
s_add_u32 s70, s70, s7
s_lshl_b32 s70, s70, 10
s_add_u32 s70, s70, 196608
buffer_load_dwordx4 v[56:59], v18, s[44:47], s70 offen sc1
s_lshl_b32 s70, s5, 1
s_add_u32 s70, s70, s7
s_lshl_b32 s70, s70, 10
s_add_u32 s70, s70, 229376
buffer_load_dwordx4 v[60:63], v18, s[44:47], s70 offen sc1
s_lshl_b32 s70, s5, 1
s_add_u32 s70, s70, s7
s_lshl_b32 s70, s70, 10
s_add_u32 s70, s70, 262144
buffer_load_dwordx4 v[64:67], v18, s[44:47], s70 offen sc1
s_lshl_b32 s70, s5, 1
s_add_u32 s70, s70, s7
s_lshl_b32 s70, s70, 10
s_add_u32 s70, s70, 294912
buffer_load_dwordx4 v[68:71], v18, s[44:47], s70 offen sc1
s_lshl_b32 s70, s5, 1
s_add_u32 s70, s70, s7
s_lshl_b32 s70, s70, 10
s_add_u32 s70, s70, 327680
buffer_load_dwordx4 v[72:75], v18, s[44:47], s70 offen sc1
s_lshl_b32 s70, s5, 1
s_add_u32 s70, s70, s7
s_lshl_b32 s70, s70, 10
s_add_u32 s70, s70, 360448
buffer_load_dwordx4 v[76:79], v18, s[44:47], s70 offen sc1
s_lshl_b32 s70, s5, 1
s_add_u32 s70, s70, s7
s_lshl_b32 s70, s70, 10
s_add_u32 s70, s70, 393216
buffer_load_dwordx4 v[80:83], v18, s[44:47], s70 offen sc1
s_lshl_b32 s70, s5, 1
s_add_u32 s70, s70, s7
s_lshl_b32 s70, s70, 10
s_add_u32 s70, s70, 425984
buffer_load_dwordx4 v[84:87], v18, s[44:47], s70 offen sc1
s_lshl_b32 s70, s5, 1
s_add_u32 s70, s70, s7
s_lshl_b32 s70, s70, 10
s_add_u32 s70, s70, 458752
buffer_load_dwordx4 v[88:91], v18, s[44:47], s70 offen sc1
s_lshl_b32 s70, s5, 1
s_add_u32 s70, s70, s7
s_lshl_b32 s70, s70, 10
s_add_u32 s70, s70, 491520
buffer_load_dwordx4 v[92:95], v18, s[44:47], s70 offen sc1
s_add_u32 s80, s80, 1
s_cmp_lt_u32 s80, 0x20000
s_cbranch_scc1 cs4_retry
cs4_ok:
v_pk_add_f32 v[32:33], v[32:33], v[36:37]
v_add_f32 v34, v34, v38
v_pk_add_f32 v[32:33], v[32:33], v[40:41]
v_add_f32 v34, v34, v42
v_pk_add_f32 v[32:33], v[32:33], v[44:45]
v_add_f32 v34, v34, v46
v_pk_add_f32 v[32:33], v[32:33], v[48:49]
v_add_f32 v34, v34, v50
v_pk_add_f32 v[32:33], v[32:33], v[52:53]
v_add_f32 v34, v34, v54
v_pk_add_f32 v[32:33], v[32:33], v[56:57]
v_add_f32 v34, v34, v58
v_pk_add_f32 v[32:33], v[32:33], v[60:61]
v_add_f32 v34, v34, v62
v_pk_add_f32 v[32:33], v[32:33], v[64:65]
v_add_f32 v34, v34, v66
v_pk_add_f32 v[32:33], v[32:33], v[68:69]
v_add_f32 v34, v34, v70
v_pk_add_f32 v[32:33], v[32:33], v[72:73]
v_add_f32 v34, v34, v74
v_pk_add_f32 v[32:33], v[32:33], v[76:77]
v_add_f32 v34, v34, v78
v_pk_add_f32 v[32:33], v[32:33], v[80:81]
v_add_f32 v34, v34, v82
v_pk_add_f32 v[32:33], v[32:33], v[84:85]
v_add_f32 v34, v34, v86
v_pk_add_f32 v[32:33], v[32:33], v[88:89]
v_add_f32 v34, v34, v90
v_pk_add_f32 v[32:33], v[32:33], v[92:93]
v_add_f32 v34, v34, v94
v_mul_u32_u24 v19, 12, v1
s_mul_i32 s70, s7, 448
s_add_u32 s70, s70, 135168
v_add_u32 v19, s70, v19
s_mov_b32 exec_lo, -1
s_mov_b32 exec_hi, 0x1f
ds_write_b32 v19, v32 offset:0
ds_write_b32 v19, v33 offset:4
ds_write_b32 v19, v34 offset:8
s_mov_b32 exec_lo, 0
s_mov_b32 exec_hi, 0x20
ds_write_b32 v19, v32
s_mov_b64 exec, -1
s_waitcnt lgkmcnt(0)
s_barrier
s_barrier
s_barrier
s_barrier
s_barrier
s_and_b32 s82, s30, 1
s_lshr_b32 s4, s30, 1
s_lshl_b32 s4, s4, 2
s_and_b32 s64, s31, 3
s_add_u32 s4, s4, s64
s_lshr_b32 s5, s31, 2
s_mov_b32 s81, 0
s_cmp_lg_u32 s7, 0
s_cbranch_scc1 h_d_0
s_lshl_b32 s70, s4, 7
s_cmp_eq_u32 s82, 0
s_mov_b32 s76, 0x1
s_cmp_eq_u32 s82, 0
s_cbranch_scc1 m5_1
s_mov_b32 s76, 0x200
m5_1:
s_mov_b32 s80, 0
v_lshlrev_b32 v22, 3, v1
v_add_u32 v22, 12288, v22
pm15:
s_and_b32 s77, s81, s76
s_cmp_eq_u32 s77, s76
s_cbranch_scc1 pm15_ok
s_mov_b64 exec, 0xffff
buffer_load_dwordx2 v[20:21], v22, s[56:59], s70 offen sc1
s_waitcnt vmcnt(0)
v_cmp_eq_u32 vcc, s28, v20
v_cmp_eq_u32 s[78:79], s29, v21
s_mov_b64 exec, -1
s_nop 2
s_and_b64 s[78:79], vcc, s[78:79]
s_mov_b32 s81, s78
s_add_u32 s80, s80, 1
s_cmp_lt_u32 s80, 0x40000
s_cbranch_scc1 pm15
pm15_ok:
h_d_0:
s_barrier
s_cmp_lg_u32 s7, 0
s_cbranch_scc1 h_d_1
s_lshl_b32 s70, s4, 7
s_cmp_eq_u32 s82, 0
s_mov_b32 s76, 0x3
s_cmp_eq_u32 s82, 0
s_cbranch_scc1 m5_3
s_mov_b32 s76, 0x600
m5_3:
s_mov_b32 s80, 0
v_lshlrev_b32 v22, 3, v1
v_add_u32 v22, 12288, v22
pm16:
s_and_b32 s77, s81, s76
s_cmp_eq_u32 s77, s76
s_cbranch_scc1 pm16_ok
s_mov_b64 exec, 0xffff
buffer_load_dwordx2 v[20:21], v22, s[56:59], s70 offen sc1
s_waitcnt vmcnt(0)
v_cmp_eq_u32 vcc, s28, v20
v_cmp_eq_u32 s[78:79], s29, v21
s_mov_b64 exec, -1
s_nop 2
s_and_b64 s[78:79], vcc, s[78:79]
s_mov_b32 s81, s78
s_add_u32 s80, s80, 1
s_cmp_lt_u32 s80, 0x40000
s_cbranch_scc1 pm16
pm16_ok:
h_d_1:
s_barrier
s_cmp_lg_u32 s7, 0
s_cbranch_scc1 h_d_2
s_lshl_b32 s70, s4, 7
s_mov_b32 s76, 0xffff
s_mov_b32 s80, 0
v_lshlrev_b32 v22, 3, v1
v_add_u32 v22, 12288, v22
pm17:
s_and_b32 s77, s81, s76
s_cmp_eq_u32 s77, s76
s_cbranch_scc1 pm17_ok
s_mov_b64 exec, 0xffff
buffer_load_dwordx2 v[20:21], v22, s[56:59], s70 offen sc1
s_waitcnt vmcnt(0)
v_cmp_eq_u32 vcc, s28, v20
v_cmp_eq_u32 s[78:79], s29, v21
s_mov_b64 exec, -1
s_nop 2
s_and_b64 s[78:79], vcc, s[78:79]
s_mov_b32 s81, s78
s_add_u32 s80, s80, 1
s_cmp_lt_u32 s80, 0x40000
s_cbranch_scc1 pm17
pm17_ok:
h_d_2:
s_barrier
s_endpgm
kp_end:
s_endpgm
kp_codeend:
.section .rodata,"a"
.p2align 6
.amdhsa_kernel kp_kernel
  .amdhsa_next_free_vgpr 256
  .amdhsa_next_free_sgpr 102
  .amdhsa_accum_offset 256
  .amdhsa_group_segment_fixed_size 0
  .amdhsa_kernarg_size 96
  .amdhsa_user_sgpr_count 2
  .amdhsa_user_sgpr_kernarg_segment_ptr 1
  .amdhsa_system_sgpr_workgroup_id_x 1
  .amdhsa_float_denorm_mode_32 3
  .amdhsa_float_denorm_mode_16_64 3
.end_amdhsa_kernel
```
